```python
import torch

def _softmax(x, axis=-1):
    return torch.softmax(x, dim=axis)
def _gelu(x):
    return torch.nn.functional.gelu(x, approximate="tanh")
def _silu(x):
    return torch.nn.functional.silu(x)
def _sigmoid(x):
    return torch.sigmoid(x)
def _layernorm(x, axis=-1, eps=1e-5):
    m = x.mean(dim=axis, keepdim=True)
    v = x.var(dim=axis, keepdim=True, unbiased=False)
    return (x - m) / torch.sqrt(v + eps)
def _scatter_add(tgt, idx, src, axis=0):
    return tgt.clone().index_add_(axis, idx, src)
def _segment_sum(src, seg, n):
    out = torch.zeros((n,) + src.shape[1:], dtype=src.dtype)
    return out.index_add_(0, seg, src)
def _pad(x, pw):
    flat = tuple(v for pair in reversed(pw) for v in pair)
    return torch.nn.functional.pad(x, flat)

kernel_name = 'concat_heads__grouped_kv_mqa__ssm_conv_s4d__prompt'

def setup_inputs():

    _w = (lambda a: (lambda t: t.to(torch.bfloat16) if t.is_floating_point() else t)(torch.as_tensor(a)))
    def _A_setup():
        B, S, D, H = 1, 2048, 640, 32
        Dh = D // H
        return {
            "x": _w((lambda *s: torch.randn(*s, dtype=torch.bfloat16) * 0.05)(B, S, D)),
            "wq": _w((lambda *s: torch.randn(*s, dtype=torch.bfloat16) * 0.8)(D, H * Dh)),
            "wk": _w((lambda *s: torch.randn(*s, dtype=torch.bfloat16) * 0.8)(D, Dh)),
            "wv": _w((lambda *s: torch.randn(*s, dtype=torch.bfloat16) * 0.05)(D, Dh)),
            "wo": _w((lambda *s: torch.randn(*s, dtype=torch.bfloat16) * 0.05)(H * Dh, D)),
        }
    _A_in = _A_setup()

    def _B_setup():
        Bsz, L, D, N = 1, 2048, 640, 192
        return {
            "u": _w((lambda *s: torch.randn(*s, dtype=torch.bfloat16) * 0.05)(Bsz, L, D)),
            "log_A_real": _w((lambda *s: torch.randn(*s, dtype=torch.bfloat16) * 6.4)(D, N) * 0.5),
            "A_imag": _w((lambda *s: torch.randn(*s, dtype=torch.bfloat16) * 0.05)(D, N) * 3.14),
            "C_real": _w((lambda *s: torch.randn(*s, dtype=torch.bfloat16) * 0.05)(D, N) / N ** 0.5),
            "C_imag": _w((lambda *s: torch.randn(*s, dtype=torch.bfloat16) * 0.05)(D, N) / N ** 0.5),
            "log_dt": _w((lambda *s: torch.randn(*s, dtype=torch.bfloat16) * 0.05)(D) * 0.5 - 4.0),
            "D_skip": _w((lambda *s: torch.randn(*s, dtype=torch.bfloat16) * 0.05)(D)),
        }
    _B_in = _B_setup()

    return {
        "A_x": _A_in["x"],
        "A_wq": _A_in["wq"],
        "A_wk": _A_in["wk"],
        "A_wv": _A_in["wv"],
        "A_wo": _A_in["wo"],
        "B_u": _B_in["u"],
        "B_log_A_real": _B_in["log_A_real"],
        "B_A_imag": _B_in["A_imag"],
        "B_C_real": _B_in["C_real"],
        "B_C_imag": _B_in["C_imag"],
        "B_log_dt": _B_in["log_dt"],
        "B_D_skip": _B_in["D_skip"],
    }

def reference(A_x, A_wq, A_wk, A_wv, A_wo, B_u, B_log_A_real, B_A_imag, B_C_real, B_C_imag, B_log_dt, B_D_skip):
    def _A_ref(x, wq, wk, wv, wo):
        B, S, D = x.shape
        H = 32
        Dh = D // H
        q = (lambda x, *d: x.permute(*d))((x @ wq).reshape(B, S, H, Dh), 0, 2, 1, 3)
        k = x @ wk
        v = x @ wv
        scores = torch.einsum("bhqd,bkd->bhqk", q, k) * (Dh ** -0.5)
        p = _softmax(scores, axis=-1)
        o = torch.einsum("bhqk,bkd->bhqd", p, v)
        return (lambda x, *d: x.permute(*d))(o, 0, 2, 1, 3).reshape(B, S, H * Dh) @ wo

    def _B_ref(u, log_A_real, A_imag, C_real, C_imag, log_dt, D_skip):
        L = u.shape[1]
        dt = torch.exp(log_dt)
        A = -torch.exp(log_A_real) + 1j * A_imag
        C = (C_real + 1j * C_imag) * dt[:, None]
        pos = (lambda x, dt: x.to(dt))(torch.arange(L), log_dt.dtype)
        P = torch.exp((A * dt[:, None])[:, :, None] * pos[None, None, :])
        K = 2.0 * torch.einsum("dn,dnl->dl", C, P).real
        L2 = 2 * L
        u_t = (lambda x, *d: x.permute(*d))(u, 0, 2, 1)
        Kf = (lambda x, *a, **k: torch.fft.rfft(x.float(), *a, **k))(K, L2)
        Uf = (lambda x, *a, **k: torch.fft.rfft(x.float(), *a, **k))(u_t, L2)
        y = (lambda x, *a, **k: torch.fft.irfft(x, *a, **k).to(torch.bfloat16))(Uf * Kf[None, :, :], L2)[:, :, :L]
        y = (lambda x, *d: x.permute(*d))(y, 0, 2, 1)
        return y + u * D_skip[None, None, :]

    a = _A_ref(A_x, A_wq, A_wk, A_wv, A_wo)
    b = _B_ref(B_u, B_log_A_real, B_A_imag, B_C_real, B_C_imag, B_log_dt, B_D_skip)
    return torch.concatenate([a, b], axis=-1)
```

```asm
; @launch grid=(256,1,1) block=(512,1,1) lds=163840
.amdgcn_target "amdgcn-amd-amdhsa--gfx950"
.text
.globl concat_heads__grouped_kv_mqa__ssm_conv_s4d__prompt_kernel
.p2align 8
.type concat_heads__grouped_kv_mqa__ssm_conv_s4d__prompt_kernel,@function
concat_heads__grouped_kv_mqa__ssm_conv_s4d__prompt_kernel:
L_start:
    s_cmp_ge_u32 s2, 256
    s_cbranch_scc1 L_end
    s_load_dwordx2 s[4:5], s[0:1], 0
    s_load_dwordx2 s[32:33], s[0:1], 48
    s_load_dwordx2 s[36:37], s[0:1], 56
    s_load_dwordx2 s[40:41], s[0:1], 64
    s_load_dwordx2 s[44:45], s[0:1], 72
    s_load_dwordx2 s[48:49], s[0:1], 80
    s_load_dwordx2 s[52:53], s[0:1], 88
    s_load_dwordx2 s[28:29], s[0:1], 112
    s_load_dwordx2 s[8:9], s[0:1], 8
    s_load_dwordx2 s[16:17], s[0:1], 32
    s_load_dwordx2 s[20:21], s[0:1], 40
    s_load_dwordx2 s[24:25], s[0:1], 96
    s_lshr_b32 s62, s2, 3
    s_lshr_b32 s58, s62, 2
    s_cmp_eq_u32 s58, 6
    s_cselect_b32 s63, 24, 16
    s_load_dwordx2 s[12:13], s[0:1], s63
    v_lshrrev_b32 v1, 6, v0
    v_and_b32 v0, 63, v0
    v_readfirstlane_b32 s56, v1
    s_and_b32 s63, s2, 7
    s_and_b32 s57, s62, 3
    s_lshl_b32 s61, s63, 2
    s_add_u32 s57, s57, s61
    s_mul_i32 s60, s63, 20
    s_add_u32 s60, s60, s62
    s_lshl_b32 s60, s60, 2
    s_cmp_lt_u32 s62, 20
    s_cselect_b32 s59, 1, 0
    v_lshlrev_b32 v14, 4, v0
    s_getpc_b64 s[94:95]
L_pc:
    s_sub_u32 s94, s94, L_pc-L_start
    s_subb_u32 s95, s95, 0
    s_and_b32 s63, s62, 7
    s_lshl_b32 s63, s63, 3
    s_add_u32 s63, s63, s56
    s_lshl_b32 s63, s63, 10
    v_add_u32 v1, s63, v14
    v_min_u32 v1, L_codeend-L_start-16, v1
    global_load_dwordx4 v[4:7], v1, s[94:95]
    v_mov_b32 v2, 0
    s_cmp_ge_u32 s56, 4
    s_cbranch_scc1 L_frontB
    s_mov_b32 s6, 2621440
    s_mov_b32 s7, 0x20000
    s_mul_i32 s68, s56, 20480
    s_add_u32 s68, s68, 81920
    s_lshl_b32 s63, s57, 2
    s_add_u32 s63, s63, s56
    s_mul_i32 s63, s63, 20480
    s_add_u32 s64, s63, 10240
    v_lshrrev_b32 v3, 3, v0
    v_and_b32 v1, 7, v0
    v_xor_b32 v1, v1, v3
    v_mul_u32_u24 v3, 1280, v3
    v_lshl_add_u32 v1, v1, 4, v3
    s_waitcnt lgkmcnt(0)
    s_add_u32 m0, s68, 0
    s_nop 0
    buffer_load_dwordx4 v1, s[4:7], s63 offen offset:0 lds
    s_add_u32 m0, s68, 1024
    s_nop 0
    buffer_load_dwordx4 v1, s[4:7], s64 offen offset:0 lds
    s_add_u32 m0, s68, 1920
    s_nop 0
    buffer_load_dwordx4 v1, s[4:7], s63 offen offset:128 lds
    s_add_u32 m0, s68, 2944
    s_nop 0
    buffer_load_dwordx4 v1, s[4:7], s64 offen offset:128 lds
    s_add_u32 m0, s68, 3840
    s_nop 0
    buffer_load_dwordx4 v1, s[4:7], s63 offen offset:256 lds
    s_add_u32 m0, s68, 4864
    s_nop 0
    buffer_load_dwordx4 v1, s[4:7], s64 offen offset:256 lds
    s_add_u32 m0, s68, 5760
    s_nop 0
    buffer_load_dwordx4 v1, s[4:7], s63 offen offset:384 lds
    s_add_u32 m0, s68, 6784
    s_nop 0
    buffer_load_dwordx4 v1, s[4:7], s64 offen offset:384 lds
    s_add_u32 m0, s68, 7680
    s_nop 0
    buffer_load_dwordx4 v1, s[4:7], s63 offen offset:512 lds
    s_add_u32 m0, s68, 8704
    s_nop 0
    buffer_load_dwordx4 v1, s[4:7], s64 offen offset:512 lds
    s_add_u32 m0, s68, 9600
    s_nop 0
    buffer_load_dwordx4 v1, s[4:7], s63 offen offset:640 lds
    s_add_u32 m0, s68, 10624
    s_nop 0
    buffer_load_dwordx4 v1, s[4:7], s64 offen offset:640 lds
    s_add_u32 m0, s68, 11520
    s_nop 0
    buffer_load_dwordx4 v1, s[4:7], s63 offen offset:768 lds
    s_add_u32 m0, s68, 12544
    s_nop 0
    buffer_load_dwordx4 v1, s[4:7], s64 offen offset:768 lds
    s_add_u32 m0, s68, 13440
    s_nop 0
    buffer_load_dwordx4 v1, s[4:7], s63 offen offset:896 lds
    s_add_u32 m0, s68, 14464
    s_nop 0
    buffer_load_dwordx4 v1, s[4:7], s64 offen offset:896 lds
    s_add_u32 m0, s68, 15360
    s_nop 0
    buffer_load_dwordx4 v1, s[4:7], s63 offen offset:1024 lds
    s_add_u32 m0, s68, 16384
    s_nop 0
    buffer_load_dwordx4 v1, s[4:7], s64 offen offset:1024 lds
    s_add_u32 m0, s68, 17280
    s_nop 0
    buffer_load_dwordx4 v1, s[4:7], s63 offen offset:1152 lds
    s_add_u32 m0, s68, 18304
    s_nop 0
    buffer_load_dwordx4 v1, s[4:7], s64 offen offset:1152 lds
    s_mov_b32 s30, 16777216
    s_mov_b32 s31, 0x20000
    buffer_load_dword v101, v2, s[28:31], 0 offen sc1
    s_cmp_lg_u32 s56, 0
    s_cbranch_scc1 L_noinit
    v_mov_b32 v224, 60416
    v_mov_b32 v2, 0
    v_mov_b32 v3, 0
    ds_write_b64 v224, v[2:3]
    ds_write_b64 v224, v[2:3] offset:8
    ds_write_b64 v224, v[2:3] offset:16
    ds_write_b64 v224, v[2:3] offset:24
    ds_write_b64 v224, v[2:3] offset:32
    ds_write_b64 v224, v[2:3] offset:40
    ds_write_b64 v224, v[2:3] offset:48
    ds_write_b64 v224, v[2:3] offset:56
    ds_write_b64 v224, v[2:3] offset:64
    ds_write_b64 v224, v[2:3] offset:72
    s_waitcnt lgkmcnt(0)
L_noinit:
    s_barrier
    s_branch L_frontA1
L_frontB:
    s_sub_u32 s68, s56, 4
    s_cmp_eq_u32 s59, 0
    s_cbranch_scc1 L_frontB_nossm
    s_mov_b32 s50, 1280
    s_mov_b32 s51, 0x20000
    s_mov_b32 s34, 245760
    s_mov_b32 s35, 0x20000
    s_mov_b32 s38, 245760
    s_mov_b32 s39, 0x20000
    s_mov_b32 s42, 245760
    s_mov_b32 s43, 0x20000
    s_mov_b32 s46, 245760
    s_mov_b32 s47, 0x20000
    s_mov_b32 s54, 1280
    s_mov_b32 s55, 0x20000
    s_mov_b32 s30, 16777216
    s_mov_b32 s31, 0x20000
    s_add_u32 s64, s60, s68
    s_mul_i32 s63, s64, 384
    s_lshl_b32 s64, s64, 1
    v_lshlrev_b32 v1, 1, v0
    v_mov_b32 v120, 0
    v_mov_b32 v121, 0
    v_mov_b32 v122, 0
    v_mov_b32 v123, 0
    v_mov_b32 v124, 0
    v_mov_b32 v125, 0
    v_mov_b32 v126, 0
    v_mov_b32 v127, 0
    v_mov_b32 v128, 0
    v_mov_b32 v129, 0
    v_mov_b32 v130, 0
    v_mov_b32 v131, 0
    v_mov_b32 v132, 0
    v_mov_b32 v100, 0
    s_waitcnt lgkmcnt(0)
    buffer_load_short_d16_hi v132, v2, s[48:51], s64 offen
    buffer_load_short_d16_hi v120, v1, s[32:35], s63 offen offset:0
    buffer_load_short_d16_hi v121, v1, s[36:39], s63 offen offset:0
    buffer_load_short_d16_hi v122, v1, s[40:43], s63 offen offset:0
    buffer_load_short_d16_hi v123, v1, s[44:47], s63 offen offset:0
    buffer_load_short_d16_hi v124, v1, s[32:35], s63 offen offset:128
    buffer_load_short_d16_hi v125, v1, s[36:39], s63 offen offset:128
    buffer_load_short_d16_hi v126, v1, s[40:43], s63 offen offset:128
    buffer_load_short_d16_hi v127, v1, s[44:47], s63 offen offset:128
    buffer_load_short_d16_hi v128, v1, s[32:35], s63 offen offset:256
    buffer_load_short_d16_hi v129, v1, s[36:39], s63 offen offset:256
    buffer_load_short_d16_hi v130, v1, s[40:43], s63 offen offset:256
    buffer_load_short_d16_hi v131, v1, s[44:47], s63 offen offset:256
    buffer_load_short_d16_hi v100, v2, s[52:55], s64 offen
    buffer_load_dword v101, v2, s[28:31], 0 offen sc1
    s_barrier
    s_setprio 1
    s_mov_b32 s18, 819200
    s_mov_b32 s19, 0x20000
    s_mul_i32 s22, s59, 2621440
    s_mov_b32 s23, 0x20000
    s_mov_b32 s26, 5242880
    s_mov_b32 s27, 0x20000
    v_and_b32 v1, 31, v0
    v_lshrrev_b32 v2, 5, v0
    v_mov_b32 v26, 0xdddddddd
    v_add_u32 v27, 6144, v14
    v_lshlrev_b32 v102, 3, v1
    v_add_u32 v102, 7168, v102
    v_min_u32 v1, 21, v1
    v_mul_u32_u24 v2, 352, v2
    v_lshl_add_u32 v1, v1, 4, v2
    v_add_u32 v103, 7680, v1
    s_lshl_b32 s63, s56, 6
    s_mov_b32 s72, 52429
    s_mov_b32 s73, 1120
    v_add_u32 v232, s63, v0
    v_mul_u32_u24 v233, s72, v232
    v_lshlrev_b32 v234, 4, v232
    v_lshrrev_b32 v233, 19, v233
    v_add_u32 v232, 512, v232
    v_mad_u32_u24 v15, v233, s73, v234
    v_mul_u32_u24 v233, s72, v232
    v_lshlrev_b32 v234, 4, v232
    v_lshrrev_b32 v233, 19, v233
    v_add_u32 v232, 512, v232
    v_mad_u32_u24 v16, v233, s73, v234
    v_mul_u32_u24 v233, s72, v232
    v_lshlrev_b32 v234, 4, v232
    v_lshrrev_b32 v233, 19, v233
    v_add_u32 v232, 512, v232
    v_mad_u32_u24 v17, v233, s73, v234
    v_mul_u32_u24 v233, s72, v232
    v_lshlrev_b32 v234, 4, v232
    v_lshrrev_b32 v233, 19, v233
    v_add_u32 v232, 512, v232
    v_mad_u32_u24 v18, v233, s73, v234
    v_mul_u32_u24 v233, s72, v232
    v_lshlrev_b32 v234, 4, v232
    v_lshrrev_b32 v233, 19, v233
    v_add_u32 v232, 512, v232
    v_mad_u32_u24 v19, v233, s73, v234
    s_sub_u32 s68, s56, 4
    s_mul_i32 s63, s68, 8960
    s_add_u32 s63, s63, 24576
    s_mul_i32 s64, s68, 4608
    v_and_b32 v1, 31, v0
    v_lshrrev_b32 v2, 5, v0
    v_lshlrev_b32 v3, 4, v1
    v_lshl_add_u32 v3, v2, 9, v3
    v_sub_u32 v3, s63, v3
    v_add_u32 v219, 1072, v3
    v_lshl_add_u32 v3, v2, 5, v1
    v_and_b32 v1, 1, v1
    v_lshrrev_b32 v3, 1, v3
    v_add_u32 v3, v3, v1
    v_lshlrev_b32 v3, 1, v3
    v_mul_u32_u24 v1, 1280, v1
    v_sub_u32 v1, v1, v3
    v_add_u32 v1, s63, v1
    v_add_u32 v248, 6208, v1
    s_mov_b32 s73, 320
    s_mov_b32 s74, 2240
    v_lshlrev_b32 v1, 4, v0
    v_sub_u32 v2, 48, v1
    v_add_u32 v3, 2048, v1
    v_cmp_gt_u32 vcc, 4, v0
    v_and_b32 v1, 15, v0
    s_nop 0
    v_cndmask_b32 v2, v3, v2, vcc
    v_add_u32 v220, s63, v2
    v_lshrrev_b32 v2, 4, v0
    v_lshlrev_b32 v3, 4, v2
    v_lshl_add_u32 v217, v1, 5, v3
    v_add_u32 v217, s64, v217
    v_add_u32 v252, 432, v217
    v_add_u32 v253, 1, v1
    v_and_b32 v253, 3, v253
    v_sub_u32 v255, v253, v1
    v_lshlrev_b32 v255, 1, v255
    v_add_u32 v3, v3, v255
    v_mad_u32_u24 v3, v253, s74, v3
    v_add_u32 v3, s63, v3
    v_add_u32 v216, 30, v3
    v_lshl_add_u32 v3, v2, 3, v255
    v_mad_u32_u24 v3, v253, s73, v3
    v_add_u32 v3, s63, v3
    v_add_u32 v250, 6174, v3
    v_lshlrev_b32 v3, 3, v2
    v_lshl_add_u32 v218, v1, 5, v3
    v_bfe_u32 v1, v0, 2, 2
    v_lshl_add_u32 v1, v2, 2, v1
    v_and_b32 v3, 3, v0
    v_lshlrev_b32 v3, 3, v3
    v_lshl_add_u32 v1, v1, 5, v3
    v_add_u32 v249, s63, v1
    v_lshlrev_b32 v1, 3, v0
    v_add_u32 v251, s64, v1
    s_lshl_b32 s65, s68, 10
    s_add_u32 s65, s65, 480
    v_add_u32 v221, s65, v1
    s_lshl_b32 s65, s68, 9
    v_add_u32 v223, s65, v1
    v_mul_u32_u24 v222, 10240, v0
    s_sub_u32 s68, s56, 4
    v_lshrrev_b32 v232, 2, v0
    v_and_b32 v233, 3, v0
    v_lshl_add_u32 v232, v232, 3, v233
    v_mul_u32_u24 v232, 128, v232
    s_and_b32 s66, s68, 1
    s_lshr_b32 s68, s68, 1
    s_lshl_b32 s68, s68, 5
    s_add_u32 s66, s66, s68
    s_mul_i32 s66, s66, 512
    s_add_u32 s66, s66, 4096
    s_mov_b32 s72, 0x3fb8aa3b
    s_mov_b32 s73, 0x32a57060
    s_mov_b32 s74, 0x3f317218
    s_sub_u32 s68, s56, 4
    s_mul_i32 s63, s68, 8704
    s_add_u32 s63, s63, 25600
    s_mov_b32 m0, s63
    v_and_b32 v1, 31, v0
    v_mul_u32_u24 v1, 272, v1
    v_lshrrev_b32 v2, 5, v0
    v_lshl_add_u32 v1, v2, 4, v1
    s_waitcnt vmcnt(0)
    v_readfirstlane_b32 s61, v101
    s_add_u32 s61, s61, 0x9e3779b9
    v_mul_f32 v60, s72, v132
    v_mul_f32 v36, s72, v120
    v_mul_f32 v44, s72, v124
    v_mul_f32 v52, s72, v128
    v_fma_f32 v61, v132, s72, -v60
    v_fma_f32 v37, v120, s72, -v36
    v_fma_f32 v45, v124, s72, -v44
    v_fma_f32 v53, v128, s72, -v52
    v_fmac_f32 v61, s73, v132
    v_fmac_f32 v37, s73, v120
    v_fmac_f32 v45, s73, v124
    v_fmac_f32 v53, s73, v128
    v_exp_f32 v60, v60
    v_exp_f32 v36, v36
    v_exp_f32 v44, v44
    v_exp_f32 v52, v52
    v_mul_f32 v61, s74, v61
    v_mul_f32 v37, s74, v37
    v_mul_f32 v45, s74, v45
    v_mul_f32 v53, s74, v53
    v_fma_f32 v133, v60, v61, v60
    v_fma_f32 v38, v36, v37, v36
    v_fma_f32 v46, v44, v45, v44
    v_fma_f32 v54, v52, v53, v52
    v_cvt_pk_bf16_f32 v133, v133, v133
    v_cvt_pk_bf16_f32 v38, v38, v38
    v_cvt_pk_bf16_f32 v46, v46, v46
    v_cvt_pk_bf16_f32 v54, v54, v54
    v_and_b32 v133, 0xffff0000, v133
    v_and_b32 v38, 0xffff0000, v38
    v_and_b32 v46, 0xffff0000, v46
    v_and_b32 v54, 0xffff0000, v54
    v_add_u32 v114, s63, v1
    v_add_f32 v60, v133, v133
    v_lshrrev_b32 v1, 3, v0
    v_and_b32 v1, 3, v1
    v_and_b32 v3, 3, v0
    v_lshl_add_u32 v1, v1, 2, v3
    s_mov_b32 s64, 0x0f0e0d0d
    v_mov_b32 v3, 0x0d100f0f
    v_perm_b32 v3, v3, s64, v1
    v_and_b32 v3, 0xff, v3
    v_add_u32 v62, 9, v1
    v_cmp_gt_u32 vcc, 8, v1
    s_nop 1
    v_cndmask_b32 v3, v62, v3, vcc
    v_and_b32 v62, 4, v0
    v_cmp_eq_u32 vcc, 0, v62
    s_nop 1
    v_cndmask_b32 v1, v3, v1, vcc
    v_mul_u32_u24 v1, 272, v1
    v_lshl_add_u32 v1, v2, 4, v1
    v_add_u32 v115, s63, v1
    s_mov_b32 s67, 0
    v_mul_f32 v36, v38, v133
    v_mul_f32 v44, v46, v133
    v_mul_f32 v52, v54, v133
    v_mul_f32 v37, v121, v133
    v_mul_f32 v45, v125, v133
    v_mul_f32 v53, v129, v133
    v_mul_f32 v36, s72, v36
    v_mul_f32 v44, s72, v44
    v_mul_f32 v52, s72, v52
    v_mul_f32 v37, 0.15915494, v37
    v_mul_f32 v45, 0.15915494, v45
    v_mul_f32 v53, 0.15915494, v53
    v_mul_f32 v190, v122, v60
    v_mul_f32 v198, v126, v60
    v_mul_f32 v206, v130, v60
    v_mul_f32 v191, v123, v60
    v_mul_f32 v199, v127, v60
    v_mul_f32 v207, v131, v60
    v_ldexp_f32 v38, -v36, 3
    v_ldexp_f32 v46, -v44, 3
    v_ldexp_f32 v54, -v52, 3
    v_ldexp_f32 v39, v37, 3
    v_ldexp_f32 v47, v45, 3
    v_ldexp_f32 v55, v53, 3
    v_exp_f32 v38, v38
    v_exp_f32 v46, v46
    v_exp_f32 v54, v54
    v_fract_f32 v39, v39
    v_fract_f32 v47, v47
    v_fract_f32 v55, v55
    v_cos_f32 v40, v39
    v_cos_f32 v48, v47
    v_cos_f32 v56, v55
    v_sin_f32 v41, v39
    v_sin_f32 v49, v47
    v_sin_f32 v57, v55
    v_mul_f32 v184, v38, v40
    v_mul_f32 v192, v46, v48
    v_mul_f32 v200, v54, v56
    v_mul_f32 v185, v38, v41
    v_mul_f32 v193, v46, v49
    v_mul_f32 v201, v54, v57
    v_ldexp_f32 v38, -v36, 6
    v_ldexp_f32 v46, -v44, 6
    v_ldexp_f32 v54, -v52, 6
    v_ldexp_f32 v39, v37, 6
    v_ldexp_f32 v47, v45, 6
    v_ldexp_f32 v55, v53, 6
    v_exp_f32 v38, v38
    v_exp_f32 v46, v46
    v_exp_f32 v54, v54
    v_fract_f32 v39, v39
    v_fract_f32 v47, v47
    v_fract_f32 v55, v55
    v_cos_f32 v40, v39
    v_cos_f32 v48, v47
    v_cos_f32 v56, v55
    v_sin_f32 v41, v39
    v_sin_f32 v49, v47
    v_sin_f32 v57, v55
    v_mul_f32 v186, v38, v40
    v_mul_f32 v194, v46, v48
    v_mul_f32 v202, v54, v56
    v_mul_f32 v187, v38, v41
    v_mul_f32 v195, v46, v49
    v_mul_f32 v203, v54, v57
    v_ldexp_f32 v38, -v36, 0
    v_ldexp_f32 v46, -v44, 0
    v_ldexp_f32 v54, -v52, 0
    v_ldexp_f32 v39, v37, 0
    v_ldexp_f32 v47, v45, 0
    v_ldexp_f32 v55, v53, 0
    v_exp_f32 v38, v38
    v_exp_f32 v46, v46
    v_exp_f32 v54, v54
    v_fract_f32 v39, v39
    v_fract_f32 v47, v47
    v_fract_f32 v55, v55
    v_cos_f32 v40, v39
    v_cos_f32 v48, v47
    v_cos_f32 v56, v55
    v_sin_f32 v41, v39
    v_sin_f32 v49, v47
    v_sin_f32 v57, v55
    v_mul_f32 v188, v38, v40
    v_mul_f32 v196, v46, v48
    v_mul_f32 v204, v54, v56
    v_mul_f32 v189, v38, v41
    v_mul_f32 v197, v46, v49
    v_mul_f32 v205, v54, v57
    v_mov_b32 v104, 0x00003f80
    v_cvt_pk_bf16_f32 v105, v184, v185
    v_cvt_pk_bf16_f32 v106, v186, v187
    v_pk_mul_f32 v[208:209], v[186:187], v[186:187] op_sel:[0,0] op_sel_hi:[1,0]
    v_pk_mul_f32 v[210:211], v[184:185], v[184:185] op_sel:[0,0] op_sel_hi:[1,0]
    v_pk_mul_f32 v[212:213], v[186:187], v[184:185] op_sel:[0,0] op_sel_hi:[1,0]
    v_pk_mul_f32 v[214:215], v[188:189], v[188:189] op_sel:[0,0] op_sel_hi:[1,0]
    v_pk_fma_f32 v[146:147], v[186:187], v[186:187], v[208:209] op_sel:[1,1,0] op_sel_hi:[0,1,1] neg_lo:[1,0,0]
    v_pk_fma_f32 v[150:151], v[184:185], v[184:185], v[210:211] op_sel:[1,1,0] op_sel_hi:[0,1,1] neg_lo:[1,0,0]
    v_pk_fma_f32 v[152:153], v[186:187], v[184:185], v[212:213] op_sel:[1,1,0] op_sel_hi:[0,1,1] neg_lo:[1,0,0]
    v_pk_fma_f32 v[142:143], v[188:189], v[188:189], v[214:215] op_sel:[1,1,0] op_sel_hi:[0,1,1] neg_lo:[1,0,0]
    v_cvt_pk_bf16_f32 v107, v150, v151
    v_cvt_pk_bf16_f32 v108, v152, v153
    v_cvt_pk_bf16_f32 v109, v146, v147
    v_pk_mul_f32 v[208:209], v[146:147], v[186:187] op_sel:[0,0] op_sel_hi:[1,0]
    v_pk_mul_f32 v[210:211], v[150:151], v[184:185] op_sel:[0,0] op_sel_hi:[1,0]
    v_pk_mul_f32 v[212:213], v[152:153], v[184:185] op_sel:[0,0] op_sel_hi:[1,0]
    v_pk_mul_f32 v[214:215], v[146:147], v[184:185] op_sel:[0,0] op_sel_hi:[1,0]
    ds_write_addtid_b32 v104 offset:0
    ds_write_addtid_b32 v105 offset:272
    ds_write_addtid_b32 v106 offset:2176
    ds_write_addtid_b32 v107 offset:544
    ds_write_addtid_b32 v108 offset:2448
    ds_write_addtid_b32 v109 offset:4352
    v_pk_fma_f32 v[156:157], v[146:147], v[186:187], v[208:209] op_sel:[1,1,0] op_sel_hi:[0,1,1] neg_lo:[1,0,0]
    v_pk_fma_f32 v[150:151], v[150:151], v[184:185], v[210:211] op_sel:[1,1,0] op_sel_hi:[0,1,1] neg_lo:[1,0,0]
    v_pk_fma_f32 v[152:153], v[152:153], v[184:185], v[212:213] op_sel:[1,1,0] op_sel_hi:[0,1,1] neg_lo:[1,0,0]
    v_pk_fma_f32 v[154:155], v[146:147], v[184:185], v[214:215] op_sel:[1,1,0] op_sel_hi:[0,1,1] neg_lo:[1,0,0]
    v_cvt_pk_bf16_f32 v104, v156, v157
    v_cvt_pk_bf16_f32 v105, v150, v151
    v_cvt_pk_bf16_f32 v106, v152, v153
    v_cvt_pk_bf16_f32 v107, v154, v155
    v_pk_mul_f32 v[208:209], v[150:151], v[184:185] op_sel:[0,0] op_sel_hi:[1,0]
    v_pk_mul_f32 v[210:211], v[152:153], v[184:185] op_sel:[0,0] op_sel_hi:[1,0]
    v_pk_mul_f32 v[212:213], v[154:155], v[184:185] op_sel:[0,0] op_sel_hi:[1,0]
    v_pk_mul_f32 v[214:215], v[156:157], v[184:185] op_sel:[0,0] op_sel_hi:[1,0]
    v_pk_fma_f32 v[150:151], v[150:151], v[184:185], v[208:209] op_sel:[1,1,0] op_sel_hi:[0,1,1] neg_lo:[1,0,0]
    v_pk_fma_f32 v[152:153], v[152:153], v[184:185], v[210:211] op_sel:[1,1,0] op_sel_hi:[0,1,1] neg_lo:[1,0,0]
    v_pk_fma_f32 v[154:155], v[154:155], v[184:185], v[212:213] op_sel:[1,1,0] op_sel_hi:[0,1,1] neg_lo:[1,0,0]
    v_pk_fma_f32 v[156:157], v[156:157], v[184:185], v[214:215] op_sel:[1,1,0] op_sel_hi:[0,1,1] neg_lo:[1,0,0]
    v_cvt_pk_bf16_f32 v108, v150, v151
    v_cvt_pk_bf16_f32 v109, v152, v153
    v_cvt_pk_bf16_f32 v110, v154, v155
    v_cvt_pk_bf16_f32 v111, v156, v157
    v_pk_mul_f32 v[208:209], v[150:151], v[184:185] op_sel:[0,0] op_sel_hi:[1,0]
    v_pk_mul_f32 v[210:211], v[152:153], v[184:185] op_sel:[0,0] op_sel_hi:[1,0]
    v_pk_mul_f32 v[212:213], v[154:155], v[184:185] op_sel:[0,0] op_sel_hi:[1,0]
    v_pk_mul_f32 v[214:215], v[156:157], v[184:185] op_sel:[0,0] op_sel_hi:[1,0]
    ds_write_addtid_b32 v104 offset:6528
    ds_write_addtid_b32 v105 offset:816
    ds_write_addtid_b32 v106 offset:2720
    ds_write_addtid_b32 v107 offset:4624
    ds_write_addtid_b32 v108 offset:1088
    ds_write_addtid_b32 v109 offset:2992
    ds_write_addtid_b32 v110 offset:4896
    ds_write_addtid_b32 v111 offset:6800
    v_pk_fma_f32 v[150:151], v[150:151], v[184:185], v[208:209] op_sel:[1,1,0] op_sel_hi:[0,1,1] neg_lo:[1,0,0]
    v_pk_fma_f32 v[152:153], v[152:153], v[184:185], v[210:211] op_sel:[1,1,0] op_sel_hi:[0,1,1] neg_lo:[1,0,0]
    v_pk_fma_f32 v[154:155], v[154:155], v[184:185], v[212:213] op_sel:[1,1,0] op_sel_hi:[0,1,1] neg_lo:[1,0,0]
    v_pk_fma_f32 v[156:157], v[156:157], v[184:185], v[214:215] op_sel:[1,1,0] op_sel_hi:[0,1,1] neg_lo:[1,0,0]
    v_cvt_pk_bf16_f32 v104, v150, v151
    v_cvt_pk_bf16_f32 v105, v152, v153
    v_cvt_pk_bf16_f32 v106, v154, v155
    v_cvt_pk_bf16_f32 v107, v156, v157
    v_pk_mul_f32 v[208:209], v[150:151], v[184:185] op_sel:[0,0] op_sel_hi:[1,0]
    v_pk_mul_f32 v[210:211], v[152:153], v[184:185] op_sel:[0,0] op_sel_hi:[1,0]
    v_pk_mul_f32 v[212:213], v[154:155], v[184:185] op_sel:[0,0] op_sel_hi:[1,0]
    v_pk_mul_f32 v[214:215], v[156:157], v[184:185] op_sel:[0,0] op_sel_hi:[1,0]
    v_pk_fma_f32 v[150:151], v[150:151], v[184:185], v[208:209] op_sel:[1,1,0] op_sel_hi:[0,1,1] neg_lo:[1,0,0]
    v_pk_fma_f32 v[152:153], v[152:153], v[184:185], v[210:211] op_sel:[1,1,0] op_sel_hi:[0,1,1] neg_lo:[1,0,0]
    v_pk_fma_f32 v[154:155], v[154:155], v[184:185], v[212:213] op_sel:[1,1,0] op_sel_hi:[0,1,1] neg_lo:[1,0,0]
    v_pk_fma_f32 v[156:157], v[156:157], v[184:185], v[214:215] op_sel:[1,1,0] op_sel_hi:[0,1,1] neg_lo:[1,0,0]
    v_cvt_pk_bf16_f32 v108, v150, v151
    v_cvt_pk_bf16_f32 v109, v152, v153
    v_cvt_pk_bf16_f32 v110, v154, v155
    v_cvt_pk_bf16_f32 v111, v156, v157
    v_pk_mul_f32 v[208:209], v[150:151], v[184:185] op_sel:[0,0] op_sel_hi:[1,0]
    v_pk_mul_f32 v[210:211], v[152:153], v[184:185] op_sel:[0,0] op_sel_hi:[1,0]
    v_pk_mul_f32 v[212:213], v[154:155], v[184:185] op_sel:[0,0] op_sel_hi:[1,0]
    v_pk_mul_f32 v[214:215], v[156:157], v[184:185] op_sel:[0,0] op_sel_hi:[1,0]
    ds_write_addtid_b32 v104 offset:1360
    ds_write_addtid_b32 v105 offset:3264
    ds_write_addtid_b32 v106 offset:5168
    ds_write_addtid_b32 v107 offset:7072
    ds_write_addtid_b32 v108 offset:1632
    ds_write_addtid_b32 v109 offset:3536
    ds_write_addtid_b32 v110 offset:5440
    ds_write_addtid_b32 v111 offset:7344
    v_pk_fma_f32 v[150:151], v[150:151], v[184:185], v[208:209] op_sel:[1,1,0] op_sel_hi:[0,1,1] neg_lo:[1,0,0]
    v_pk_fma_f32 v[152:153], v[152:153], v[184:185], v[210:211] op_sel:[1,1,0] op_sel_hi:[0,1,1] neg_lo:[1,0,0]
    v_pk_fma_f32 v[154:155], v[154:155], v[184:185], v[212:213] op_sel:[1,1,0] op_sel_hi:[0,1,1] neg_lo:[1,0,0]
    v_pk_fma_f32 v[156:157], v[156:157], v[184:185], v[214:215] op_sel:[1,1,0] op_sel_hi:[0,1,1] neg_lo:[1,0,0]
    v_cvt_pk_bf16_f32 v104, v150, v151
    v_cvt_pk_bf16_f32 v105, v152, v153
    v_cvt_pk_bf16_f32 v106, v154, v155
    v_cvt_pk_bf16_f32 v107, v156, v157
    v_pk_mul_f32 v[208:209], v[152:153], v[184:185] op_sel:[0,0] op_sel_hi:[1,0]
    v_pk_mul_f32 v[210:211], v[154:155], v[184:185] op_sel:[0,0] op_sel_hi:[1,0]
    v_pk_mul_f32 v[212:213], v[156:157], v[184:185] op_sel:[0,0] op_sel_hi:[1,0]
    v_pk_mul_f32 v[214:215], v[146:147], v[146:147] op_sel:[0,0] op_sel_hi:[1,0]
    v_pk_fma_f32 v[152:153], v[152:153], v[184:185], v[208:209] op_sel:[1,1,0] op_sel_hi:[0,1,1] neg_lo:[1,0,0]
    v_pk_fma_f32 v[154:155], v[154:155], v[184:185], v[210:211] op_sel:[1,1,0] op_sel_hi:[0,1,1] neg_lo:[1,0,0]
    v_pk_fma_f32 v[156:157], v[156:157], v[184:185], v[212:213] op_sel:[1,1,0] op_sel_hi:[0,1,1] neg_lo:[1,0,0]
    v_pk_fma_f32 v[148:149], v[146:147], v[146:147], v[214:215] op_sel:[1,1,0] op_sel_hi:[0,1,1] neg_lo:[1,0,0]
    v_cvt_pk_bf16_f32 v108, v152, v153
    v_cvt_pk_bf16_f32 v109, v154, v155
    v_cvt_pk_bf16_f32 v110, v156, v157
    v_pk_mul_f32 v[208:209], v[154:155], v[184:185] op_sel:[0,0] op_sel_hi:[1,0]
    v_pk_mul_f32 v[210:211], v[156:157], v[184:185] op_sel:[0,0] op_sel_hi:[1,0]
    v_pk_mul_f32 v[212:213], v[142:143], v[142:143] op_sel:[0,0] op_sel_hi:[1,0]
    v_pk_mul_f32 v[214:215], v[190:191], v[148:149] op_sel:[0,0] op_sel_hi:[1,0]
    ds_write_addtid_b32 v104 offset:1904
    ds_write_addtid_b32 v105 offset:3808
    ds_write_addtid_b32 v106 offset:5712
    ds_write_addtid_b32 v107 offset:7616
    ds_write_addtid_b32 v108 offset:4080
    ds_write_addtid_b32 v109 offset:5984
    ds_write_addtid_b32 v110 offset:7888
    v_pk_fma_f32 v[154:155], v[154:155], v[184:185], v[208:209] op_sel:[1,1,0] op_sel_hi:[0,1,1] neg_lo:[1,0,0]
    v_pk_fma_f32 v[156:157], v[156:157], v[184:185], v[210:211] op_sel:[1,1,0] op_sel_hi:[0,1,1] neg_lo:[1,0,0]
    v_pk_fma_f32 v[144:145], v[142:143], v[142:143], v[212:213] op_sel:[1,1,0] op_sel_hi:[0,1,1] neg_lo:[1,0,0]
    v_pk_fma_f32 v[158:159], v[190:191], v[148:149], v[214:215] op_sel:[1,1,0] op_sel_hi:[0,1,1] neg_lo:[1,0,0]
    v_cvt_pk_bf16_f32 v104, v154, v155
    v_cvt_pk_bf16_f32 v105, v156, v157
    v_pk_mul_f32 v[208:209], v[156:157], v[184:185] op_sel:[0,0] op_sel_hi:[1,0]
    v_pk_mul_f32 v[210:211], v[158:159], v[148:149] op_sel:[0,0] op_sel_hi:[1,0]
    v_pk_mul_f32 v[212:213], v[190:191], v[188:189] op_sel:[0,0] op_sel_hi:[1,0]
    v_pk_mul_f32 v[214:215], v[148:149], v[148:149] op_sel:[0,0] op_sel_hi:[1,0]
    v_pk_fma_f32 v[156:157], v[156:157], v[184:185], v[208:209] op_sel:[1,1,0] op_sel_hi:[0,1,1] neg_lo:[1,0,0]
    v_pk_fma_f32 v[160:161], v[158:159], v[148:149], v[210:211] op_sel:[1,1,0] op_sel_hi:[0,1,1] neg_lo:[1,0,0]
    v_pk_fma_f32 v[150:151], v[190:191], v[188:189], v[212:213] op_sel:[1,1,0] op_sel_hi:[0,1,1] neg_lo:[1,0,0]
    v_pk_fma_f32 v[164:165], v[148:149], v[148:149], v[214:215] op_sel:[1,1,0] op_sel_hi:[0,1,1] neg_lo:[1,0,0]
    v_cvt_pk_bf16_f32 v106, v156, v157
    v_pk_mul_f32 v[208:209], v[158:159], v[164:165] op_sel:[0,0] op_sel_hi:[1,0]
    v_pk_mul_f32 v[210:211], v[160:161], v[164:165] op_sel:[0,0] op_sel_hi:[1,0]
    v_pk_mul_f32 v[212:213], v[158:159], v[142:143] op_sel:[0,0] op_sel_hi:[1,0]
    v_pk_mul_f32 v[214:215], v[150:151], v[144:145] op_sel:[0,0] op_sel_hi:[1,0]
    ds_write_addtid_b32 v104 offset:6256
    ds_write_addtid_b32 v105 offset:8160
    ds_write_addtid_b32 v106 offset:8432
    ds_read_b128 v[36:39], v114 offset:0
    ds_read_b128 v[40:43], v114 offset:32
    ds_read_b128 v[44:47], v114 offset:64
    ds_read_b128 v[48:51], v114 offset:96
    ds_read_b128 v[52:55], v114 offset:128
    ds_read_b128 v[56:59], v114 offset:160
    ds_read_b128 v[60:63], v114 offset:192
    ds_read_b128 v[64:67], v114 offset:224
    v_pk_fma_f32 v[162:163], v[158:159], v[164:165], v[208:209] op_sel:[1,1,0] op_sel_hi:[0,1,1] neg_lo:[1,0,0]
    v_pk_fma_f32 v[116:117], v[160:161], v[164:165], v[210:211] op_sel:[1,1,0] op_sel_hi:[0,1,1] neg_lo:[1,0,0]
    v_pk_fma_f32 v[152:153], v[158:159], v[142:143], v[212:213] op_sel:[1,1,0] op_sel_hi:[0,1,1] neg_lo:[1,0,0]
    v_pk_fma_f32 v[154:155], v[150:151], v[144:145], v[214:215] op_sel:[1,1,0] op_sel_hi:[0,1,1] neg_lo:[1,0,0]
    v_cvt_pk_bf16_f32 v104, v190, -v191
    v_cvt_pk_bf16_f32 v105, v150, -v151
    v_cvt_pk_bf16_f32 v106, v158, -v159
    v_cvt_pk_bf16_f32 v107, v160, -v161
    v_cvt_pk_bf16_f32 v108, v162, -v163
    v_cvt_pk_bf16_f32 v109, v116, -v117
    v_cvt_pk_bf16_f32 v110, v152, -v153
    v_cvt_pk_bf16_f32 v111, v154, -v155
    v_pk_mul_f32 v[208:209], v[162:163], v[164:165] op_sel:[0,0] op_sel_hi:[1,0]
    v_pk_mul_f32 v[210:211], v[116:117], v[164:165] op_sel:[0,0] op_sel_hi:[1,0]
    v_pk_mul_f32 v[212:213], v[152:153], v[142:143] op_sel:[0,0] op_sel_hi:[1,0]
    v_pk_mul_f32 v[214:215], v[150:151], v[188:189] op_sel:[0,0] op_sel_hi:[1,0]
    ds_write_addtid_b32 v104 offset:0
    ds_write_addtid_b32 v105 offset:272
    ds_write_addtid_b32 v106 offset:3536
    ds_write_addtid_b32 v107 offset:2176
    ds_write_addtid_b32 v108 offset:4624
    ds_write_addtid_b32 v109 offset:2720
    ds_write_addtid_b32 v110 offset:3808
    ds_write_addtid_b32 v111 offset:1360
    v_pk_fma_f32 v[118:119], v[162:163], v[164:165], v[208:209] op_sel:[1,1,0] op_sel_hi:[0,1,1] neg_lo:[1,0,0]
    v_pk_fma_f32 v[134:135], v[116:117], v[164:165], v[210:211] op_sel:[1,1,0] op_sel_hi:[0,1,1] neg_lo:[1,0,0]
    v_pk_fma_f32 v[152:153], v[152:153], v[142:143], v[212:213] op_sel:[1,1,0] op_sel_hi:[0,1,1] neg_lo:[1,0,0]
    v_pk_fma_f32 v[150:151], v[150:151], v[188:189], v[214:215] op_sel:[1,1,0] op_sel_hi:[0,1,1] neg_lo:[1,0,0]
    v_cvt_pk_bf16_f32 v104, v118, -v119
    v_cvt_pk_bf16_f32 v105, v134, -v135
    v_cvt_pk_bf16_f32 v106, v152, -v153
    v_cvt_pk_bf16_f32 v107, v150, -v151
    v_pk_mul_f32 v[208:209], v[118:119], v[164:165] op_sel:[0,0] op_sel_hi:[1,0]
    v_pk_mul_f32 v[210:211], v[134:135], v[164:165] op_sel:[0,0] op_sel_hi:[1,0]
    v_pk_mul_f32 v[212:213], v[152:153], v[142:143] op_sel:[0,0] op_sel_hi:[1,0]
    v_pk_mul_f32 v[214:215], v[150:151], v[144:145] op_sel:[0,0] op_sel_hi:[1,0]
    v_pk_fma_f32 v[118:119], v[118:119], v[164:165], v[208:209] op_sel:[1,1,0] op_sel_hi:[0,1,1] neg_lo:[1,0,0]
    v_pk_fma_f32 v[134:135], v[134:135], v[164:165], v[210:211] op_sel:[1,1,0] op_sel_hi:[0,1,1] neg_lo:[1,0,0]
    v_pk_fma_f32 v[152:153], v[152:153], v[142:143], v[212:213] op_sel:[1,1,0] op_sel_hi:[0,1,1] neg_lo:[1,0,0]
    v_pk_fma_f32 v[154:155], v[150:151], v[144:145], v[214:215] op_sel:[1,1,0] op_sel_hi:[0,1,1] neg_lo:[1,0,0]
    v_cvt_pk_bf16_f32 v108, v118, -v119
    v_cvt_pk_bf16_f32 v109, v134, -v135
    v_cvt_pk_bf16_f32 v110, v152, -v153
    v_cvt_pk_bf16_f32 v111, v154, -v155
    v_pk_mul_f32 v[208:209], v[160:161], v[144:145] op_sel:[0,0] op_sel_hi:[1,0]
    v_pk_mul_f32 v[210:211], v[162:163], v[144:145] op_sel:[0,0] op_sel_hi:[1,0]
    v_pk_mul_f32 v[212:213], v[190:191], v[144:145] op_sel:[0,0] op_sel_hi:[1,0]
    v_pk_mul_f32 v[214:215], v[150:151], v[188:189] op_sel:[0,0] op_sel_hi:[1,0]
    ds_write_addtid_b32 v104 offset:5168
    ds_write_addtid_b32 v105 offset:2992
    ds_write_addtid_b32 v106 offset:4080
    ds_write_addtid_b32 v107 offset:544
    ds_write_addtid_b32 v108 offset:5440
    ds_write_addtid_b32 v109 offset:3264
    ds_write_addtid_b32 v110 offset:4352
    ds_write_addtid_b32 v111 offset:1632
    v_pk_fma_f32 v[154:155], v[160:161], v[144:145], v[208:209] op_sel:[1,1,0] op_sel_hi:[0,1,1] neg_lo:[1,0,0]
    v_pk_fma_f32 v[156:157], v[162:163], v[144:145], v[210:211] op_sel:[1,1,0] op_sel_hi:[0,1,1] neg_lo:[1,0,0]
    v_pk_fma_f32 v[152:153], v[190:191], v[144:145], v[212:213] op_sel:[1,1,0] op_sel_hi:[0,1,1] neg_lo:[1,0,0]
    v_pk_fma_f32 v[150:151], v[150:151], v[188:189], v[214:215] op_sel:[1,1,0] op_sel_hi:[0,1,1] neg_lo:[1,0,0]
    v_cvt_pk_bf16_f32 v104, v154, -v155
    v_cvt_pk_bf16_f32 v105, v156, -v157
    v_cvt_pk_bf16_f32 v106, v152, -v153
    v_cvt_pk_bf16_f32 v107, v150, -v151
    v_pk_mul_f32 v[208:209], v[150:151], v[144:145] op_sel:[0,0] op_sel_hi:[1,0]
    v_pk_fma_f32 v[150:151], v[150:151], v[144:145], v[208:209] op_sel:[1,1,0] op_sel_hi:[0,1,1] neg_lo:[1,0,0]
    v_cvt_pk_bf16_f32 v108, v150, -v151
    ds_write_addtid_b32 v104 offset:2448
    ds_write_addtid_b32 v105 offset:4896
    ds_write_addtid_b32 v106 offset:1088
    ds_write_addtid_b32 v107 offset:816
    ds_write_addtid_b32 v108 offset:1904
    ds_read_b128 v[68:71], v115 offset:0
    ds_read_b128 v[72:75], v115 offset:32
    ds_read_b128 v[76:79], v115 offset:64
    ds_read_b128 v[80:83], v115 offset:96
    ds_read_b128 v[84:87], v115 offset:128
    ds_read_b128 v[88:91], v115 offset:160
    ds_read_b128 v[92:95], v115 offset:192
    ds_read_b128 v[96:99], v115 offset:224
    v_mov_b32 v104, 0x00003f80
    v_cvt_pk_bf16_f32 v105, v192, v193
    v_cvt_pk_bf16_f32 v106, v194, v195
    v_mul_f32 v208, v195, v195
    v_mul_f32 v209, v195, v194
    v_mul_f32 v210, v193, v193
    v_mul_f32 v211, v193, v192
    v_mul_f32 v212, v195, v193
    v_mul_f32 v213, v195, v192
    v_mul_f32 v214, v197, v197
    v_mul_f32 v215, v197, v196
    v_fma_f32 v147, v194, v195, v209
    v_fma_f32 v146, v194, v194, -v208
    v_fma_f32 v151, v192, v193, v211
    v_fma_f32 v150, v192, v192, -v210
    v_fma_f32 v153, v194, v193, v213
    v_fma_f32 v152, v194, v192, -v212
    v_fma_f32 v143, v196, v197, v215
    v_fma_f32 v142, v196, v196, -v214
    v_cvt_pk_bf16_f32 v107, v150, v151
    v_cvt_pk_bf16_f32 v108, v152, v153
    v_cvt_pk_bf16_f32 v109, v146, v147
    v_mul_f32 v208, v147, v195
    v_mul_f32 v209, v147, v194
    v_mul_f32 v210, v151, v193
    v_mul_f32 v211, v151, v192
    v_mul_f32 v212, v153, v193
    v_mul_f32 v213, v153, v192
    v_mul_f32 v214, v147, v193
    v_mul_f32 v215, v147, v192
    s_waitcnt lgkmcnt(7)
    v_mfma_f32_32x32x16_bf16 v[168:183], v[68:71], v[36:39], 0
    s_waitcnt lgkmcnt(6)
    v_mfma_f32_32x32x16_bf16 v[168:183], v[72:75], v[40:43], v[168:183]
    ds_write_addtid_b32 v104 offset:0
    ds_write_addtid_b32 v105 offset:272
    ds_write_addtid_b32 v106 offset:2176
    ds_write_addtid_b32 v107 offset:544
    ds_write_addtid_b32 v108 offset:2448
    ds_write_addtid_b32 v109 offset:4352
    v_fma_f32 v157, v146, v195, v209
    v_fma_f32 v156, v146, v194, -v208
    v_fma_f32 v151, v150, v193, v211
    v_fma_f32 v150, v150, v192, -v210
    v_fma_f32 v153, v152, v193, v213
    v_fma_f32 v152, v152, v192, -v212
    v_fma_f32 v155, v146, v193, v215
    v_fma_f32 v154, v146, v192, -v214
    v_cvt_pk_bf16_f32 v104, v156, v157
    v_cvt_pk_bf16_f32 v105, v150, v151
    v_cvt_pk_bf16_f32 v106, v152, v153
    v_cvt_pk_bf16_f32 v107, v154, v155
    v_mul_f32 v208, v151, v193
    v_mul_f32 v209, v151, v192
    v_mul_f32 v210, v153, v193
    v_mul_f32 v211, v153, v192
    v_mul_f32 v212, v155, v193
    v_mul_f32 v213, v155, v192
    v_mul_f32 v214, v157, v193
    v_mul_f32 v215, v157, v192
    v_fma_f32 v151, v150, v193, v209
    v_fma_f32 v150, v150, v192, -v208
    v_fma_f32 v153, v152, v193, v211
    v_fma_f32 v152, v152, v192, -v210
    v_fma_f32 v155, v154, v193, v213
    v_fma_f32 v154, v154, v192, -v212
    v_fma_f32 v157, v156, v193, v215
    v_fma_f32 v156, v156, v192, -v214
    v_cvt_pk_bf16_f32 v108, v150, v151
    v_cvt_pk_bf16_f32 v109, v152, v153
    v_cvt_pk_bf16_f32 v110, v154, v155
    v_cvt_pk_bf16_f32 v111, v156, v157
    v_mul_f32 v208, v151, v193
    v_mul_f32 v209, v151, v192
    v_mul_f32 v210, v153, v193
    v_mul_f32 v211, v153, v192
    v_mul_f32 v212, v155, v193
    v_mul_f32 v213, v155, v192
    v_mul_f32 v214, v157, v193
    v_mul_f32 v215, v157, v192
    s_waitcnt lgkmcnt(11)
    v_mfma_f32_32x32x16_bf16 v[168:183], v[76:79], v[44:47], v[168:183]
    s_waitcnt lgkmcnt(10)
    v_mfma_f32_32x32x16_bf16 v[168:183], v[80:83], v[48:51], v[168:183]
    ds_write_addtid_b32 v104 offset:6528
    ds_write_addtid_b32 v105 offset:816
    ds_write_addtid_b32 v106 offset:2720
    ds_write_addtid_b32 v107 offset:4624
    ds_write_addtid_b32 v108 offset:1088
    ds_write_addtid_b32 v109 offset:2992
    ds_write_addtid_b32 v110 offset:4896
    ds_write_addtid_b32 v111 offset:6800
    v_fma_f32 v151, v150, v193, v209
    v_fma_f32 v150, v150, v192, -v208
    v_fma_f32 v153, v152, v193, v211
    v_fma_f32 v152, v152, v192, -v210
    v_fma_f32 v155, v154, v193, v213
    v_fma_f32 v154, v154, v192, -v212
    v_fma_f32 v157, v156, v193, v215
    v_fma_f32 v156, v156, v192, -v214
    v_cvt_pk_bf16_f32 v104, v150, v151
    v_cvt_pk_bf16_f32 v105, v152, v153
    v_cvt_pk_bf16_f32 v106, v154, v155
    v_cvt_pk_bf16_f32 v107, v156, v157
    v_mul_f32 v208, v151, v193
    v_mul_f32 v209, v151, v192
    v_mul_f32 v210, v153, v193
    v_mul_f32 v211, v153, v192
    v_mul_f32 v212, v155, v193
    v_mul_f32 v213, v155, v192
    v_mul_f32 v214, v157, v193
    v_mul_f32 v215, v157, v192
    v_fma_f32 v151, v150, v193, v209
    v_fma_f32 v150, v150, v192, -v208
    v_fma_f32 v153, v152, v193, v211
    v_fma_f32 v152, v152, v192, -v210
    v_fma_f32 v155, v154, v193, v213
    v_fma_f32 v154, v154, v192, -v212
    v_fma_f32 v157, v156, v193, v215
    v_fma_f32 v156, v156, v192, -v214
    v_cvt_pk_bf16_f32 v108, v150, v151
    v_cvt_pk_bf16_f32 v109, v152, v153
    v_cvt_pk_bf16_f32 v110, v154, v155
    v_cvt_pk_bf16_f32 v111, v156, v157
    v_mul_f32 v208, v151, v193
    v_mul_f32 v209, v151, v192
    v_mul_f32 v210, v153, v193
    v_mul_f32 v211, v153, v192
    v_mul_f32 v212, v155, v193
    v_mul_f32 v213, v155, v192
    v_mul_f32 v214, v157, v193
    v_mul_f32 v215, v157, v192
    s_waitcnt lgkmcnt(15)
    v_mfma_f32_32x32x16_bf16 v[168:183], v[84:87], v[52:55], v[168:183]
    v_mfma_f32_32x32x16_bf16 v[168:183], v[88:91], v[56:59], v[168:183]
    ds_write_addtid_b32 v104 offset:1360
    ds_write_addtid_b32 v105 offset:3264
    ds_write_addtid_b32 v106 offset:5168
    ds_write_addtid_b32 v107 offset:7072
    ds_write_addtid_b32 v108 offset:1632
    ds_write_addtid_b32 v109 offset:3536
    ds_write_addtid_b32 v110 offset:5440
    ds_write_addtid_b32 v111 offset:7344
    v_fma_f32 v151, v150, v193, v209
    v_fma_f32 v150, v150, v192, -v208
    v_fma_f32 v153, v152, v193, v211
    v_fma_f32 v152, v152, v192, -v210
    v_fma_f32 v155, v154, v193, v213
    v_fma_f32 v154, v154, v192, -v212
    v_fma_f32 v157, v156, v193, v215
    v_fma_f32 v156, v156, v192, -v214
    v_cvt_pk_bf16_f32 v104, v150, v151
    v_cvt_pk_bf16_f32 v105, v152, v153
    v_cvt_pk_bf16_f32 v106, v154, v155
    v_cvt_pk_bf16_f32 v107, v156, v157
    v_mul_f32 v208, v153, v193
    v_mul_f32 v209, v153, v192
    v_mul_f32 v210, v155, v193
    v_mul_f32 v211, v155, v192
    v_mul_f32 v212, v157, v193
    v_mul_f32 v213, v157, v192
    v_mul_f32 v214, v147, v147
    v_mul_f32 v215, v147, v146
    v_fma_f32 v153, v152, v193, v209
    v_fma_f32 v152, v152, v192, -v208
    v_fma_f32 v155, v154, v193, v211
    v_fma_f32 v154, v154, v192, -v210
    v_fma_f32 v157, v156, v193, v213
    v_fma_f32 v156, v156, v192, -v212
    v_fma_f32 v149, v146, v147, v215
    v_fma_f32 v148, v146, v146, -v214
    v_cvt_pk_bf16_f32 v108, v152, v153
    v_cvt_pk_bf16_f32 v109, v154, v155
    v_cvt_pk_bf16_f32 v110, v156, v157
    v_mul_f32 v208, v155, v193
    v_mul_f32 v209, v155, v192
    v_mul_f32 v210, v157, v193
    v_mul_f32 v211, v157, v192
    v_mul_f32 v212, v143, v143
    v_mul_f32 v213, v143, v142
    v_mul_f32 v214, v199, v149
    v_mul_f32 v215, v199, v148
    v_mfma_f32_32x32x16_bf16 v[168:183], v[92:95], v[60:63], v[168:183]
    ds_write_addtid_b32 v104 offset:1904
    ds_write_addtid_b32 v105 offset:3808
    ds_write_addtid_b32 v106 offset:5712
    ds_write_addtid_b32 v107 offset:7616
    ds_write_addtid_b32 v108 offset:4080
    ds_write_addtid_b32 v109 offset:5984
    ds_write_addtid_b32 v110 offset:7888
    v_fma_f32 v155, v154, v193, v209
    v_fma_f32 v154, v154, v192, -v208
    v_fma_f32 v157, v156, v193, v211
    v_fma_f32 v156, v156, v192, -v210
    v_fma_f32 v145, v142, v143, v213
    v_fma_f32 v144, v142, v142, -v212
    v_fma_f32 v159, v198, v149, v215
    v_fma_f32 v158, v198, v148, -v214
    v_cvt_pk_bf16_f32 v104, v154, v155
    v_cvt_pk_bf16_f32 v105, v156, v157
    v_mul_f32 v208, v157, v193
    v_mul_f32 v209, v157, v192
    v_mul_f32 v210, v159, v149
    v_mul_f32 v211, v159, v148
    v_mul_f32 v212, v199, v197
    v_mul_f32 v213, v199, v196
    v_mul_f32 v214, v149, v149
    v_mul_f32 v215, v149, v148
    v_fma_f32 v157, v156, v193, v209
    v_fma_f32 v156, v156, v192, -v208
    v_fma_f32 v161, v158, v149, v211
    v_fma_f32 v160, v158, v148, -v210
    v_fma_f32 v151, v198, v197, v213
    v_fma_f32 v150, v198, v196, -v212
    v_fma_f32 v165, v148, v149, v215
    v_fma_f32 v164, v148, v148, -v214
    v_cvt_pk_bf16_f32 v106, v156, v157
    v_mul_f32 v208, v159, v165
    v_mul_f32 v209, v159, v164
    v_mul_f32 v210, v161, v165
    v_mul_f32 v211, v161, v164
    v_mul_f32 v212, v159, v143
    v_mul_f32 v213, v159, v142
    v_mul_f32 v214, v151, v145
    v_mul_f32 v215, v151, v144
    s_waitcnt lgkmcnt(15)
    v_mfma_f32_32x32x16_bf16 v[168:183], v[96:99], v[64:67], v[168:183]
    ds_write_addtid_b32 v104 offset:6256
    ds_write_addtid_b32 v105 offset:8160
    ds_write_addtid_b32 v106 offset:8432
    ds_read_b128 v[36:39], v114 offset:0
    ds_read_b128 v[40:43], v114 offset:32
    ds_read_b128 v[44:47], v114 offset:64
    ds_read_b128 v[48:51], v114 offset:96
    ds_read_b128 v[52:55], v114 offset:128
    ds_read_b128 v[56:59], v114 offset:160
    ds_read_b128 v[60:63], v114 offset:192
    ds_read_b128 v[64:67], v114 offset:224
    v_fma_f32 v163, v158, v165, v209
    v_fma_f32 v162, v158, v164, -v208
    v_fma_f32 v117, v160, v165, v211
    v_fma_f32 v116, v160, v164, -v210
    v_fma_f32 v153, v158, v143, v213
    v_fma_f32 v152, v158, v142, -v212
    v_fma_f32 v155, v150, v145, v215
    v_fma_f32 v154, v150, v144, -v214
    v_cvt_pk_bf16_f32 v104, v198, -v199
    v_cvt_pk_bf16_f32 v105, v150, -v151
    v_cvt_pk_bf16_f32 v106, v158, -v159
    v_cvt_pk_bf16_f32 v107, v160, -v161
    v_cvt_pk_bf16_f32 v108, v162, -v163
    v_cvt_pk_bf16_f32 v109, v116, -v117
    v_cvt_pk_bf16_f32 v110, v152, -v153
    v_cvt_pk_bf16_f32 v111, v154, -v155
    v_mul_f32 v208, v163, v165
    v_mul_f32 v209, v163, v164
    v_mul_f32 v210, v117, v165
    v_mul_f32 v211, v117, v164
    v_mul_f32 v212, v153, v143
    v_mul_f32 v213, v153, v142
    v_mul_f32 v214, v151, v197
    v_mul_f32 v215, v151, v196
    ds_write_addtid_b32 v104 offset:0
    ds_write_addtid_b32 v105 offset:272
    ds_write_addtid_b32 v106 offset:3536
    ds_write_addtid_b32 v107 offset:2176
    ds_write_addtid_b32 v108 offset:4624
    ds_write_addtid_b32 v109 offset:2720
    ds_write_addtid_b32 v110 offset:3808
    ds_write_addtid_b32 v111 offset:1360
    v_fma_f32 v119, v162, v165, v209
    v_fma_f32 v118, v162, v164, -v208
    v_fma_f32 v135, v116, v165, v211
    v_fma_f32 v134, v116, v164, -v210
    v_fma_f32 v153, v152, v143, v213
    v_fma_f32 v152, v152, v142, -v212
    v_fma_f32 v151, v150, v197, v215
    v_fma_f32 v150, v150, v196, -v214
    v_cvt_pk_bf16_f32 v104, v118, -v119
    v_cvt_pk_bf16_f32 v105, v134, -v135
    v_cvt_pk_bf16_f32 v106, v152, -v153
    v_cvt_pk_bf16_f32 v107, v150, -v151
    v_mul_f32 v208, v119, v165
    v_mul_f32 v209, v119, v164
    v_mul_f32 v210, v135, v165
    v_mul_f32 v211, v135, v164
    v_mul_f32 v212, v153, v143
    v_mul_f32 v213, v153, v142
    v_mul_f32 v214, v151, v145
    v_mul_f32 v215, v151, v144
    v_fma_f32 v119, v118, v165, v209
    v_fma_f32 v118, v118, v164, -v208
    v_fma_f32 v135, v134, v165, v211
    v_fma_f32 v134, v134, v164, -v210
    v_fma_f32 v153, v152, v143, v213
    v_fma_f32 v152, v152, v142, -v212
    v_fma_f32 v155, v150, v145, v215
    v_fma_f32 v154, v150, v144, -v214
    v_cvt_pk_bf16_f32 v108, v118, -v119
    v_cvt_pk_bf16_f32 v109, v134, -v135
    v_cvt_pk_bf16_f32 v110, v152, -v153
    v_cvt_pk_bf16_f32 v111, v154, -v155
    v_mul_f32 v208, v161, v145
    v_mul_f32 v209, v161, v144
    v_mul_f32 v210, v163, v145
    v_mul_f32 v211, v163, v144
    v_mul_f32 v212, v199, v145
    v_mul_f32 v213, v199, v144
    v_mul_f32 v214, v151, v197
    v_mul_f32 v215, v151, v196
    ds_write_addtid_b32 v104 offset:5168
    ds_write_addtid_b32 v105 offset:2992
    ds_write_addtid_b32 v106 offset:4080
    ds_write_addtid_b32 v107 offset:544
    ds_write_addtid_b32 v108 offset:5440
    ds_write_addtid_b32 v109 offset:3264
    ds_write_addtid_b32 v110 offset:4352
    ds_write_addtid_b32 v111 offset:1632
    v_fma_f32 v155, v160, v145, v209
    v_fma_f32 v154, v160, v144, -v208
    v_fma_f32 v157, v162, v145, v211
    v_fma_f32 v156, v162, v144, -v210
    v_fma_f32 v153, v198, v145, v213
    v_fma_f32 v152, v198, v144, -v212
    v_fma_f32 v151, v150, v197, v215
    v_fma_f32 v150, v150, v196, -v214
    v_cvt_pk_bf16_f32 v104, v154, -v155
    v_cvt_pk_bf16_f32 v105, v156, -v157
    v_cvt_pk_bf16_f32 v106, v152, -v153
    v_cvt_pk_bf16_f32 v107, v150, -v151
    v_mul_f32 v208, v151, v145
    v_mul_f32 v209, v151, v144
    v_fma_f32 v151, v150, v145, v209
    v_fma_f32 v150, v150, v144, -v208
    v_cvt_pk_bf16_f32 v108, v150, -v151
    ds_write_addtid_b32 v104 offset:2448
    ds_write_addtid_b32 v105 offset:4896
    ds_write_addtid_b32 v106 offset:1088
    ds_write_addtid_b32 v107 offset:816
    ds_write_addtid_b32 v108 offset:1904
    ds_read_b128 v[68:71], v115 offset:0
    ds_read_b128 v[72:75], v115 offset:32
    ds_read_b128 v[76:79], v115 offset:64
    ds_read_b128 v[80:83], v115 offset:96
    ds_read_b128 v[84:87], v115 offset:128
    ds_read_b128 v[88:91], v115 offset:160
    ds_read_b128 v[92:95], v115 offset:192
    ds_read_b128 v[96:99], v115 offset:224
    v_mov_b32 v104, 0x00003f80
    v_cvt_pk_bf16_f32 v105, v200, v201
    v_cvt_pk_bf16_f32 v106, v202, v203
    v_mul_f32 v208, v203, v203
    v_mul_f32 v209, v203, v202
    v_mul_f32 v210, v201, v201
    v_mul_f32 v211, v201, v200
    v_mul_f32 v212, v203, v201
    v_mul_f32 v213, v203, v200
    v_mul_f32 v214, v205, v205
    v_mul_f32 v215, v205, v204
    v_fma_f32 v147, v202, v203, v209
    v_fma_f32 v146, v202, v202, -v208
    v_fma_f32 v151, v200, v201, v211
    v_fma_f32 v150, v200, v200, -v210
    v_fma_f32 v153, v202, v201, v213
    v_fma_f32 v152, v202, v200, -v212
    v_fma_f32 v143, v204, v205, v215
    v_fma_f32 v142, v204, v204, -v214
    v_cvt_pk_bf16_f32 v107, v150, v151
    v_cvt_pk_bf16_f32 v108, v152, v153
    v_cvt_pk_bf16_f32 v109, v146, v147
    v_mul_f32 v208, v147, v203
    v_mul_f32 v209, v147, v202
    v_mul_f32 v210, v151, v201
    v_mul_f32 v211, v151, v200
    v_mul_f32 v212, v153, v201
    v_mul_f32 v213, v153, v200
    v_mul_f32 v214, v147, v201
    v_mul_f32 v215, v147, v200
    s_waitcnt lgkmcnt(7)
    v_mfma_f32_32x32x16_bf16 v[168:183], v[68:71], v[36:39], v[168:183]
    s_waitcnt lgkmcnt(6)
    v_mfma_f32_32x32x16_bf16 v[168:183], v[72:75], v[40:43], v[168:183]
    ds_write_addtid_b32 v104 offset:0
    ds_write_addtid_b32 v105 offset:272
    ds_write_addtid_b32 v106 offset:2176
    ds_write_addtid_b32 v107 offset:544
    ds_write_addtid_b32 v108 offset:2448
    ds_write_addtid_b32 v109 offset:4352
    v_fma_f32 v157, v146, v203, v209
    v_fma_f32 v156, v146, v202, -v208
    v_fma_f32 v151, v150, v201, v211
    v_fma_f32 v150, v150, v200, -v210
    v_fma_f32 v153, v152, v201, v213
    v_fma_f32 v152, v152, v200, -v212
    v_fma_f32 v155, v146, v201, v215
    v_fma_f32 v154, v146, v200, -v214
    v_cvt_pk_bf16_f32 v104, v156, v157
    v_cvt_pk_bf16_f32 v105, v150, v151
    v_cvt_pk_bf16_f32 v106, v152, v153
    v_cvt_pk_bf16_f32 v107, v154, v155
    v_mul_f32 v208, v151, v201
    v_mul_f32 v209, v151, v200
    v_mul_f32 v210, v153, v201
    v_mul_f32 v211, v153, v200
    v_mul_f32 v212, v155, v201
    v_mul_f32 v213, v155, v200
    v_mul_f32 v214, v157, v201
    v_mul_f32 v215, v157, v200
    v_fma_f32 v151, v150, v201, v209
    v_fma_f32 v150, v150, v200, -v208
    v_fma_f32 v153, v152, v201, v211
    v_fma_f32 v152, v152, v200, -v210
    v_fma_f32 v155, v154, v201, v213
    v_fma_f32 v154, v154, v200, -v212
    v_fma_f32 v157, v156, v201, v215
    v_fma_f32 v156, v156, v200, -v214
    v_cvt_pk_bf16_f32 v108, v150, v151
    v_cvt_pk_bf16_f32 v109, v152, v153
    v_cvt_pk_bf16_f32 v110, v154, v155
    v_cvt_pk_bf16_f32 v111, v156, v157
    v_mul_f32 v208, v151, v201
    v_mul_f32 v209, v151, v200
    v_mul_f32 v210, v153, v201
    v_mul_f32 v211, v153, v200
    v_mul_f32 v212, v155, v201
    v_mul_f32 v213, v155, v200
    v_mul_f32 v214, v157, v201
    v_mul_f32 v215, v157, v200
    s_waitcnt lgkmcnt(11)
    v_mfma_f32_32x32x16_bf16 v[168:183], v[76:79], v[44:47], v[168:183]
    s_waitcnt lgkmcnt(10)
    v_mfma_f32_32x32x16_bf16 v[168:183], v[80:83], v[48:51], v[168:183]
    ds_write_addtid_b32 v104 offset:6528
    ds_write_addtid_b32 v105 offset:816
    ds_write_addtid_b32 v106 offset:2720
    ds_write_addtid_b32 v107 offset:4624
    ds_write_addtid_b32 v108 offset:1088
    ds_write_addtid_b32 v109 offset:2992
    ds_write_addtid_b32 v110 offset:4896
    ds_write_addtid_b32 v111 offset:6800
    v_fma_f32 v151, v150, v201, v209
    v_fma_f32 v150, v150, v200, -v208
    v_fma_f32 v153, v152, v201, v211
    v_fma_f32 v152, v152, v200, -v210
    v_fma_f32 v155, v154, v201, v213
    v_fma_f32 v154, v154, v200, -v212
    v_fma_f32 v157, v156, v201, v215
    v_fma_f32 v156, v156, v200, -v214
    v_cvt_pk_bf16_f32 v104, v150, v151
    v_cvt_pk_bf16_f32 v105, v152, v153
    v_cvt_pk_bf16_f32 v106, v154, v155
    v_cvt_pk_bf16_f32 v107, v156, v157
    v_mul_f32 v208, v151, v201
    v_mul_f32 v209, v151, v200
    v_mul_f32 v210, v153, v201
    v_mul_f32 v211, v153, v200
    v_mul_f32 v212, v155, v201
    v_mul_f32 v213, v155, v200
    v_mul_f32 v214, v157, v201
    v_mul_f32 v215, v157, v200
    v_fma_f32 v151, v150, v201, v209
    v_fma_f32 v150, v150, v200, -v208
    v_fma_f32 v153, v152, v201, v211
    v_fma_f32 v152, v152, v200, -v210
    v_fma_f32 v155, v154, v201, v213
    v_fma_f32 v154, v154, v200, -v212
    v_fma_f32 v157, v156, v201, v215
    v_fma_f32 v156, v156, v200, -v214
    v_cvt_pk_bf16_f32 v108, v150, v151
    v_cvt_pk_bf16_f32 v109, v152, v153
    v_cvt_pk_bf16_f32 v110, v154, v155
    v_cvt_pk_bf16_f32 v111, v156, v157
    v_mul_f32 v208, v151, v201
    v_mul_f32 v209, v151, v200
    v_mul_f32 v210, v153, v201
    v_mul_f32 v211, v153, v200
    v_mul_f32 v212, v155, v201
    v_mul_f32 v213, v155, v200
    v_mul_f32 v214, v157, v201
    v_mul_f32 v215, v157, v200
    s_waitcnt lgkmcnt(15)
    v_mfma_f32_32x32x16_bf16 v[168:183], v[84:87], v[52:55], v[168:183]
    v_mfma_f32_32x32x16_bf16 v[168:183], v[88:91], v[56:59], v[168:183]
    ds_write_addtid_b32 v104 offset:1360
    ds_write_addtid_b32 v105 offset:3264
    ds_write_addtid_b32 v106 offset:5168
    ds_write_addtid_b32 v107 offset:7072
    ds_write_addtid_b32 v108 offset:1632
    ds_write_addtid_b32 v109 offset:3536
    ds_write_addtid_b32 v110 offset:5440
    ds_write_addtid_b32 v111 offset:7344
    v_fma_f32 v151, v150, v201, v209
    v_fma_f32 v150, v150, v200, -v208
    v_fma_f32 v153, v152, v201, v211
    v_fma_f32 v152, v152, v200, -v210
    v_fma_f32 v155, v154, v201, v213
    v_fma_f32 v154, v154, v200, -v212
    v_fma_f32 v157, v156, v201, v215
    v_fma_f32 v156, v156, v200, -v214
    v_cvt_pk_bf16_f32 v104, v150, v151
    v_cvt_pk_bf16_f32 v105, v152, v153
    v_cvt_pk_bf16_f32 v106, v154, v155
    v_cvt_pk_bf16_f32 v107, v156, v157
    v_mul_f32 v208, v153, v201
    v_mul_f32 v209, v153, v200
    v_mul_f32 v210, v155, v201
    v_mul_f32 v211, v155, v200
    v_mul_f32 v212, v157, v201
    v_mul_f32 v213, v157, v200
    v_mul_f32 v214, v147, v147
    v_mul_f32 v215, v147, v146
    v_fma_f32 v153, v152, v201, v209
    v_fma_f32 v152, v152, v200, -v208
    v_fma_f32 v155, v154, v201, v211
    v_fma_f32 v154, v154, v200, -v210
    v_fma_f32 v157, v156, v201, v213
    v_fma_f32 v156, v156, v200, -v212
    v_fma_f32 v149, v146, v147, v215
    v_fma_f32 v148, v146, v146, -v214
    v_cvt_pk_bf16_f32 v108, v152, v153
    v_cvt_pk_bf16_f32 v109, v154, v155
    v_cvt_pk_bf16_f32 v110, v156, v157
    v_mul_f32 v208, v155, v201
    v_mul_f32 v209, v155, v200
    v_mul_f32 v210, v157, v201
    v_mul_f32 v211, v157, v200
    v_mul_f32 v212, v143, v143
    v_mul_f32 v213, v143, v142
    v_mul_f32 v214, v207, v149
    v_mul_f32 v215, v207, v148
    v_mfma_f32_32x32x16_bf16 v[168:183], v[92:95], v[60:63], v[168:183]
    ds_write_addtid_b32 v104 offset:1904
    ds_write_addtid_b32 v105 offset:3808
    ds_write_addtid_b32 v106 offset:5712
    ds_write_addtid_b32 v107 offset:7616
    ds_write_addtid_b32 v108 offset:4080
    ds_write_addtid_b32 v109 offset:5984
    ds_write_addtid_b32 v110 offset:7888
    v_fma_f32 v155, v154, v201, v209
    v_fma_f32 v154, v154, v200, -v208
    v_fma_f32 v157, v156, v201, v211
    v_fma_f32 v156, v156, v200, -v210
    v_fma_f32 v145, v142, v143, v213
    v_fma_f32 v144, v142, v142, -v212
    v_fma_f32 v159, v206, v149, v215
    v_fma_f32 v158, v206, v148, -v214
    v_cvt_pk_bf16_f32 v104, v154, v155
    v_cvt_pk_bf16_f32 v105, v156, v157
    v_mul_f32 v208, v157, v201
    v_mul_f32 v209, v157, v200
    v_mul_f32 v210, v159, v149
    v_mul_f32 v211, v159, v148
    v_mul_f32 v212, v207, v205
    v_mul_f32 v213, v207, v204
    v_mul_f32 v214, v149, v149
    v_mul_f32 v215, v149, v148
    v_fma_f32 v157, v156, v201, v209
    v_fma_f32 v156, v156, v200, -v208
    v_fma_f32 v161, v158, v149, v211
    v_fma_f32 v160, v158, v148, -v210
    v_fma_f32 v151, v206, v205, v213
    v_fma_f32 v150, v206, v204, -v212
    v_fma_f32 v165, v148, v149, v215
    v_fma_f32 v164, v148, v148, -v214
    v_cvt_pk_bf16_f32 v106, v156, v157
    v_mul_f32 v208, v159, v165
    v_mul_f32 v209, v159, v164
    v_mul_f32 v210, v161, v165
    v_mul_f32 v211, v161, v164
    v_mul_f32 v212, v159, v143
    v_mul_f32 v213, v159, v142
    v_mul_f32 v214, v151, v145
    v_mul_f32 v215, v151, v144
    s_waitcnt lgkmcnt(15)
    v_mfma_f32_32x32x16_bf16 v[168:183], v[96:99], v[64:67], v[168:183]
    ds_write_addtid_b32 v104 offset:6256
    ds_write_addtid_b32 v105 offset:8160
    ds_write_addtid_b32 v106 offset:8432
    ds_read_b128 v[36:39], v114 offset:0
    ds_read_b128 v[40:43], v114 offset:32
    ds_read_b128 v[44:47], v114 offset:64
    ds_read_b128 v[48:51], v114 offset:96
    ds_read_b128 v[52:55], v114 offset:128
    ds_read_b128 v[56:59], v114 offset:160
    ds_read_b128 v[60:63], v114 offset:192
    ds_read_b128 v[64:67], v114 offset:224
    v_fma_f32 v163, v158, v165, v209
    v_fma_f32 v162, v158, v164, -v208
    v_fma_f32 v117, v160, v165, v211
    v_fma_f32 v116, v160, v164, -v210
    v_fma_f32 v153, v158, v143, v213
    v_fma_f32 v152, v158, v142, -v212
    v_fma_f32 v155, v150, v145, v215
    v_fma_f32 v154, v150, v144, -v214
    v_cvt_pk_bf16_f32 v104, v206, -v207
    v_cvt_pk_bf16_f32 v105, v150, -v151
    v_cvt_pk_bf16_f32 v106, v158, -v159
    v_cvt_pk_bf16_f32 v107, v160, -v161
    v_cvt_pk_bf16_f32 v108, v162, -v163
    v_cvt_pk_bf16_f32 v109, v116, -v117
    v_cvt_pk_bf16_f32 v110, v152, -v153
    v_cvt_pk_bf16_f32 v111, v154, -v155
    v_mul_f32 v208, v163, v165
    v_mul_f32 v209, v163, v164
    v_mul_f32 v210, v117, v165
    v_mul_f32 v211, v117, v164
    v_mul_f32 v212, v153, v143
    v_mul_f32 v213, v153, v142
    v_mul_f32 v214, v151, v205
    v_mul_f32 v215, v151, v204
    ds_write_addtid_b32 v104 offset:0
    ds_write_addtid_b32 v105 offset:272
    ds_write_addtid_b32 v106 offset:3536
    ds_write_addtid_b32 v107 offset:2176
    ds_write_addtid_b32 v108 offset:4624
    ds_write_addtid_b32 v109 offset:2720
    ds_write_addtid_b32 v110 offset:3808
    ds_write_addtid_b32 v111 offset:1360
    v_fma_f32 v119, v162, v165, v209
    v_fma_f32 v118, v162, v164, -v208
    v_fma_f32 v135, v116, v165, v211
    v_fma_f32 v134, v116, v164, -v210
    v_fma_f32 v153, v152, v143, v213
    v_fma_f32 v152, v152, v142, -v212
    v_fma_f32 v151, v150, v205, v215
    v_fma_f32 v150, v150, v204, -v214
    v_cvt_pk_bf16_f32 v104, v118, -v119
    v_cvt_pk_bf16_f32 v105, v134, -v135
    v_cvt_pk_bf16_f32 v106, v152, -v153
    v_cvt_pk_bf16_f32 v107, v150, -v151
    v_mul_f32 v208, v119, v165
    v_mul_f32 v209, v119, v164
    v_mul_f32 v210, v135, v165
    v_mul_f32 v211, v135, v164
    v_mul_f32 v212, v153, v143
    v_mul_f32 v213, v153, v142
    v_mul_f32 v214, v151, v145
    v_mul_f32 v215, v151, v144
    v_fma_f32 v119, v118, v165, v209
    v_fma_f32 v118, v118, v164, -v208
    v_fma_f32 v135, v134, v165, v211
    v_fma_f32 v134, v134, v164, -v210
    v_fma_f32 v153, v152, v143, v213
    v_fma_f32 v152, v152, v142, -v212
    v_fma_f32 v155, v150, v145, v215
    v_fma_f32 v154, v150, v144, -v214
    v_cvt_pk_bf16_f32 v108, v118, -v119
    v_cvt_pk_bf16_f32 v109, v134, -v135
    v_cvt_pk_bf16_f32 v110, v152, -v153
    v_cvt_pk_bf16_f32 v111, v154, -v155
    v_mul_f32 v208, v161, v145
    v_mul_f32 v209, v161, v144
    v_mul_f32 v210, v163, v145
    v_mul_f32 v211, v163, v144
    v_mul_f32 v212, v207, v145
    v_mul_f32 v213, v207, v144
    v_mul_f32 v214, v151, v205
    v_mul_f32 v215, v151, v204
    ds_write_addtid_b32 v104 offset:5168
    ds_write_addtid_b32 v105 offset:2992
    ds_write_addtid_b32 v106 offset:4080
    ds_write_addtid_b32 v107 offset:544
    ds_write_addtid_b32 v108 offset:5440
    ds_write_addtid_b32 v109 offset:3264
    ds_write_addtid_b32 v110 offset:4352
    ds_write_addtid_b32 v111 offset:1632
    v_fma_f32 v155, v160, v145, v209
    v_fma_f32 v154, v160, v144, -v208
    v_fma_f32 v157, v162, v145, v211
    v_fma_f32 v156, v162, v144, -v210
    v_fma_f32 v153, v206, v145, v213
    v_fma_f32 v152, v206, v144, -v212
    v_fma_f32 v151, v150, v205, v215
    v_fma_f32 v150, v150, v204, -v214
    v_cvt_pk_bf16_f32 v104, v154, -v155
    v_cvt_pk_bf16_f32 v105, v156, -v157
    v_cvt_pk_bf16_f32 v106, v152, -v153
    v_cvt_pk_bf16_f32 v107, v150, -v151
    v_mul_f32 v208, v151, v145
    v_mul_f32 v209, v151, v144
    v_fma_f32 v151, v150, v145, v209
    v_fma_f32 v150, v150, v144, -v208
    v_cvt_pk_bf16_f32 v108, v150, -v151
    ds_write_addtid_b32 v104 offset:2448
    ds_write_addtid_b32 v105 offset:4896
    ds_write_addtid_b32 v106 offset:1088
    ds_write_addtid_b32 v107 offset:816
    ds_write_addtid_b32 v108 offset:1904
    ds_read_b128 v[68:71], v115 offset:0
    ds_read_b128 v[72:75], v115 offset:32
    ds_read_b128 v[76:79], v115 offset:64
    ds_read_b128 v[80:83], v115 offset:96
    ds_read_b128 v[84:87], v115 offset:128
    ds_read_b128 v[88:91], v115 offset:160
    ds_read_b128 v[92:95], v115 offset:192
    ds_read_b128 v[96:99], v115 offset:224
    s_waitcnt lgkmcnt(7)
    v_mfma_f32_32x32x16_bf16 v[168:183], v[68:71], v[36:39], v[168:183]
    s_waitcnt lgkmcnt(6)
    v_mfma_f32_32x32x16_bf16 v[168:183], v[72:75], v[40:43], v[168:183]
    s_waitcnt lgkmcnt(5)
    v_mfma_f32_32x32x16_bf16 v[168:183], v[76:79], v[44:47], v[168:183]
    s_waitcnt lgkmcnt(4)
    v_mfma_f32_32x32x16_bf16 v[168:183], v[80:83], v[48:51], v[168:183]
    s_waitcnt lgkmcnt(3)
    v_mfma_f32_32x32x16_bf16 v[168:183], v[84:87], v[52:55], v[168:183]
    s_waitcnt lgkmcnt(2)
    v_mfma_f32_32x32x16_bf16 v[168:183], v[88:91], v[56:59], v[168:183]
    s_waitcnt lgkmcnt(1)
    v_mfma_f32_32x32x16_bf16 v[168:183], v[92:95], v[60:63], v[168:183]
    s_waitcnt lgkmcnt(0)
    v_mfma_f32_32x32x16_bf16 v[168:183], v[96:99], v[64:67], v[168:183]
    s_setprio 0
    s_cmp_eq_u32 s67, 0
    s_cbranch_scc1 L_poll0
    s_mov_b64 exec, 1
    s_nop 7
    v_add_f32 v168, v168, v100
    s_mov_b64 exec, -1
    v_cmp_gt_u32 s[76:77], 32, v0
    v_readlane_b32 s63, v176, 0
    v_readlane_b32 s64, v178, 0
    v_readlane_b32 s65, v180, 0
    v_cvt_pk_bf16_f32 v236, v178, v179
    v_mov_b32 v224, s63
    v_mov_b32 v225, s64
    v_mov_b32 v226, s65
    v_cvt_pk_bf16_f32 v237, v225, v226
    v_cvt_pk_bf16_f32 v227, v225, v225
    v_mov_b32_dpp v224, v168 wave_shl:1 row_mask:0xf bank_mask:0xf
    v_mov_b32_dpp v225, v176 wave_shl:1 row_mask:0xf bank_mask:0xf
    v_cndmask_b32 v226, v224, v175, s[76:77]
    v_cvt_pk_bf16_f32 v184, v226, v174
    v_cvt_pk_bf16_f32 v188, v224, v226
    v_cvt_pk_bf16_f32 v185, v173, v172
    v_cvt_pk_bf16_f32 v189, v174, v173
    v_cvt_pk_bf16_f32 v186, v171, v170
    v_cvt_pk_bf16_f32 v190, v172, v171
    v_cvt_pk_bf16_f32 v187, v169, v168
    v_cvt_pk_bf16_f32 v191, v170, v169
    v_cvt_pk_bf16_f32 v200, v225, v225
    v_cvt_pk_bf16_f32 v204, v225, v225
    v_cvt_pk_bf16_f32 v201, v177, v177
    v_cvt_pk_bf16_f32 v205, v225, v177
    v_cvt_pk_bf16_f32 v202, v177, v176
    v_cvt_pk_bf16_f32 v206, v177, v177
    v_cvt_pk_bf16_f32 v203, v176, v176
    v_cvt_pk_bf16_f32 v207, v176, v176
    v_readlane_b32 s63, v203, 0
    v_readlane_b32 s64, v207, 0
    v_mov_b32 v208, v227
    v_mov_b32 v212, v227
    v_mov_b32 v192, s63
    v_mov_b32 v196, s64
    v_mov_b32 v193, v184
    v_mov_b32 v194, v185
    v_mov_b32 v195, v186
    v_mov_b32 v197, v188
    v_mov_b32 v198, v189
    v_mov_b32 v199, v190
    v_mov_b32 v209, v200
    v_mov_b32 v210, v201
    v_mov_b32 v211, v202
    v_mov_b32 v213, v204
    v_mov_b32 v214, v205
    v_mov_b32 v215, v206
    v_mov_b32_dpp v192, v187 wave_shl:1 row_mask:0xf bank_mask:0xf
    v_mov_b32_dpp v196, v191 wave_shl:1 row_mask:0xf bank_mask:0xf
    v_mov_b32_dpp v208, v203 wave_shl:1 row_mask:0xf bank_mask:0xf
    v_mov_b32_dpp v212, v207 wave_shl:1 row_mask:0xf bank_mask:0xf
    v_and_b32 v1, 15, v0
    v_lshrrev_b32 v2, 1, v0
    v_and_b32 v2, 24, v2
    v_sub_u32 v1, v1, v2
    v_add_u32 v1, 36, v1
    s_mov_b32 s73, 0x8001
    s_mov_b32 s74, 0x3f80
    v_mov_b32 v2, 511
    v_mov_b32 v3, 0
    v_lshlrev_b64 v[2:3], v1, v[2:3]
    v_bfe_u32 v240, v3, 0, 2
    v_bfe_u32 v241, v3, 2, 2
    v_bfe_u32 v242, v3, 4, 2
    v_bfe_u32 v243, v3, 6, 2
    v_mul_u32_u24 v240, s73, v240
    v_mul_u32_u24 v241, s73, v241
    v_mul_u32_u24 v242, s73, v242
    v_mul_u32_u24 v243, s73, v243
    v_and_b32 v240, 0x10001, v240
    v_and_b32 v241, 0x10001, v241
    v_and_b32 v242, 0x10001, v242
    v_and_b32 v243, 0x10001, v243
    v_mul_u32_u24 v240, s74, v240
    v_mul_u32_u24 v241, s74, v241
    v_mul_u32_u24 v242, s74, v242
    v_mul_u32_u24 v243, s74, v243
    v_mov_b32 v2, 254
    v_mov_b32 v3, 0
    v_lshlrev_b64 v[2:3], v1, v[2:3]
    v_bfe_u32 v244, v3, 0, 2
    v_bfe_u32 v245, v3, 2, 2
    v_bfe_u32 v246, v3, 4, 2
    v_bfe_u32 v247, v3, 6, 2
    v_mul_u32_u24 v244, s73, v244
    v_mul_u32_u24 v245, s73, v245
    v_mul_u32_u24 v246, s73, v246
    v_mul_u32_u24 v247, s73, v247
    v_and_b32 v244, 0x10001, v244
    v_and_b32 v245, 0x10001, v245
    v_and_b32 v246, 0x10001, v246
    v_and_b32 v247, 0x10001, v247
    v_mul_u32_u24 v244, s74, v244
    v_mul_u32_u24 v245, s74, v245
    v_mul_u32_u24 v246, s74, v246
    v_mul_u32_u24 v247, s74, v247
    s_branch L_kvissued
L_frontB_nossm:
    s_mov_b32 s14, 25600
    s_mov_b32 s15, 0x20000
    s_mov_b32 s10, 819200
    s_mov_b32 s11, 0x20000
    s_mov_b32 s30, 16777216
    s_mov_b32 s31, 0x20000
    s_mul_i32 s63, s68, 6400
    v_add_u32 v1, s63, v14
    s_mov_b32 m0, s63
    s_add_u32 s64, s63, 4096
    v_add_u32 v3, 4096, v1
    s_cmp_eq_u32 s58, 7
    s_waitcnt lgkmcnt(0)
    s_cbranch_scc1 L_now
    buffer_load_dwordx4 v1, s[12:15], 0 offen offset:0 lds
    buffer_load_dwordx4 v1, s[12:15], 0 offen offset:1024 lds
    buffer_load_dwordx4 v1, s[12:15], 0 offen offset:2048 lds
    buffer_load_dwordx4 v1, s[12:15], 0 offen offset:3072 lds
    s_mov_b32 m0, s64
    s_nop 0
    buffer_load_dwordx4 v3, s[12:15], 0 offen offset:0 lds
    buffer_load_dwordx4 v3, s[12:15], 0 offen offset:1024 lds
    s_mov_b64 exec, 0xffff
    buffer_load_dwordx4 v3, s[12:15], 0 offen offset:2048 lds
    s_mov_b64 exec, -1
L_now:
    buffer_load_dword v101, v2, s[28:31], 0 offen sc1
    s_barrier
    s_mov_b32 s72, 52429
    s_mov_b32 s73, 1120
    v_mov_b32 v1, v0
    s_mov_b32 s74, 1280
    v_mul_u32_u24 v2, s72, v1
    v_lshlrev_b32 v3, 4, v1
    v_lshrrev_b32 v224, 21, v2
    v_lshrrev_b32 v225, 22, v2
    v_lshrrev_b32 v2, 19, v2
    v_xor_b32 v224, v224, v225
    v_mad_u32_u24 v3, v2, s73, v3
    v_and_b32 v224, 1, v224
    v_bfe_u32 v225, v2, 2, 1
    v_lshlrev_b32 v225, 1, v225
    v_add_u32 v225, -1, v225
    v_mul_i32_i24 v224, v224, v225
    v_mul_i32_i24 v224, 5120, v224
    v_add_u32 v1, 64, v1
    v_add_u32 v15, v3, v224
    v_mul_u32_u24 v2, s72, v1
    v_lshlrev_b32 v3, 4, v1
    v_lshrrev_b32 v224, 21, v2
    v_lshrrev_b32 v225, 22, v2
    v_lshrrev_b32 v2, 19, v2
    v_xor_b32 v224, v224, v225
    v_mad_u32_u24 v3, v2, s73, v3
    v_and_b32 v224, 1, v224
    v_bfe_u32 v225, v2, 2, 1
    v_lshlrev_b32 v225, 1, v225
    v_add_u32 v225, -1, v225
    v_mul_i32_i24 v224, v224, v225
    v_mul_i32_i24 v224, 5120, v224
    v_add_u32 v1, 64, v1
    v_add_u32 v16, v3, v224
    v_mul_u32_u24 v2, s72, v1
    v_lshlrev_b32 v3, 4, v1
    v_lshrrev_b32 v224, 21, v2
    v_lshrrev_b32 v225, 22, v2
    v_lshrrev_b32 v2, 19, v2
    v_xor_b32 v224, v224, v225
    v_mad_u32_u24 v3, v2, s73, v3
    v_and_b32 v224, 1, v224
    v_bfe_u32 v225, v2, 2, 1
    v_lshlrev_b32 v225, 1, v225
    v_add_u32 v225, -1, v225
    v_mul_i32_i24 v224, v224, v225
    v_mul_i32_i24 v224, 5120, v224
    v_add_u32 v1, 64, v1
    v_add_u32 v17, v3, v224
    v_mul_u32_u24 v2, s72, v1
    v_lshlrev_b32 v3, 4, v1
    v_lshrrev_b32 v224, 21, v2
    v_lshrrev_b32 v225, 22, v2
    v_lshrrev_b32 v2, 19, v2
    v_xor_b32 v224, v224, v225
    v_mad_u32_u24 v3, v2, s73, v3
    v_and_b32 v224, 1, v224
    v_bfe_u32 v225, v2, 2, 1
    v_lshlrev_b32 v225, 1, v225
    v_add_u32 v225, -1, v225
    v_mul_i32_i24 v224, v224, v225
    v_mul_i32_i24 v224, 5120, v224
    v_add_u32 v1, 64, v1
    v_add_u32 v18, v3, v224
    v_mul_u32_u24 v2, s72, v1
    v_lshlrev_b32 v3, 4, v1
    v_lshrrev_b32 v224, 21, v2
    v_lshrrev_b32 v225, 22, v2
    v_lshrrev_b32 v2, 19, v2
    v_xor_b32 v224, v224, v225
    v_mad_u32_u24 v3, v2, s73, v3
    v_and_b32 v224, 1, v224
    v_bfe_u32 v225, v2, 2, 1
    v_lshlrev_b32 v225, 1, v225
    v_add_u32 v225, -1, v225
    v_mul_i32_i24 v224, v224, v225
    v_mul_i32_i24 v224, 5120, v224
    v_add_u32 v1, 64, v1
    v_add_u32 v19, v3, v224
    s_waitcnt vmcnt(0)
    v_readfirstlane_b32 s61, v101
    v_mov_b32 v1, 60416
    v_mov_b32 v2, 1
    s_mov_b64 exec, 1
    ds_add_u32 v1, v2 offset:20
    s_mov_b64 exec, -1
    s_mul_i32 s63, s68, 40960
    s_mul_i32 s66, s58, 160
    s_add_u32 s63, s63, s66
    s_mul_i32 s64, s68, 5120
    s_add_u32 s64, s64, 61440
    s_add_u32 m0, s64, 0
    s_nop 0
    buffer_load_dwordx4 v15, s[8:11], s63 offen lds
    s_add_u32 m0, s64, 1024
    s_nop 0
    buffer_load_dwordx4 v16, s[8:11], s63 offen lds
    s_add_u32 m0, s64, 2048
    s_nop 0
    buffer_load_dwordx4 v17, s[8:11], s63 offen lds
    s_add_u32 m0, s64, 3072
    s_nop 0
    buffer_load_dwordx4 v18, s[8:11], s63 offen lds
    s_add_u32 m0, s64, 4096
    s_nop 0
    buffer_load_dwordx4 v19, s[8:11], s63 offen lds
    s_add_u32 s63, s68, 1
    s_mul_i32 s63, s63, 163840
    s_add_u32 s66, s66, s63
    s_mov_b32 s18, 819200
    s_mov_b32 s19, 0x20000
    s_mul_i32 s22, s59, 2621440
    s_mov_b32 s23, 0x20000
    s_mov_b32 s26, 5242880
    s_mov_b32 s27, 0x20000
    s_add_u32 s61, s61, 0x9e3779b9
    s_mul_i32 s68, s68, 20480
    s_add_u32 s68, s68, 81920
    v_mov_b32 v1, 60416
    s_mov_b32 s69, 200000
L_lw_1:
    ds_read_b32 v2, v1 offset:24
    s_sub_u32 s69, s69, 1
    s_waitcnt lgkmcnt(0)
    v_readfirstlane_b32 s65, v2
    s_cmp_ge_u32 s65, 4
    s_cbranch_scc1 L_lg_2
    s_sleep 1
    s_cmp_lg_u32 s69, 0
    s_cbranch_scc1 L_lw_1
L_lg_2:
    s_add_u32 m0, s68, 0
    s_nop 0
    buffer_load_dwordx4 v15, s[8:11], s66 offen lds
    s_add_u32 m0, s68, 1024
    s_nop 0
    buffer_load_dwordx4 v16, s[8:11], s66 offen lds
    s_add_u32 m0, s68, 2048
    s_nop 0
    buffer_load_dwordx4 v17, s[8:11], s66 offen lds
    s_add_u32 m0, s68, 3072
    s_nop 0
    buffer_load_dwordx4 v18, s[8:11], s66 offen lds
    s_add_u32 m0, s68, 4096
    s_nop 0
    buffer_load_dwordx4 v19, s[8:11], s66 offen lds
    s_add_u32 s66, s66, 40960
    s_add_u32 m0, s68, 5120
    s_nop 0
    buffer_load_dwordx4 v15, s[8:11], s66 offen lds
    s_add_u32 m0, s68, 6144
    s_nop 0
    buffer_load_dwordx4 v16, s[8:11], s66 offen lds
    s_add_u32 m0, s68, 7168
    s_nop 0
    buffer_load_dwordx4 v17, s[8:11], s66 offen lds
    s_add_u32 m0, s68, 8192
    s_nop 0
    buffer_load_dwordx4 v18, s[8:11], s66 offen lds
    s_add_u32 m0, s68, 9216
    s_nop 0
    buffer_load_dwordx4 v19, s[8:11], s66 offen lds
    s_waitcnt vmcnt(10)
    v_mov_b32 v1, 60416
    v_mov_b32 v2, 1
    s_mov_b64 exec, 1
    ds_add_u32 v1, v2 offset:12
    s_mov_b64 exec, -1
    s_add_u32 s66, s66, 40960
    s_add_u32 m0, s68, 10240
    s_nop 0
    buffer_load_dwordx4 v15, s[8:11], s66 offen lds
    s_add_u32 m0, s68, 11264
    s_nop 0
    buffer_load_dwordx4 v16, s[8:11], s66 offen lds
    s_add_u32 m0, s68, 12288
    s_nop 0
    buffer_load_dwordx4 v17, s[8:11], s66 offen lds
    s_add_u32 m0, s68, 13312
    s_nop 0
    buffer_load_dwordx4 v18, s[8:11], s66 offen lds
    s_add_u32 m0, s68, 14336
    s_nop 0
    buffer_load_dwordx4 v19, s[8:11], s66 offen lds
    s_add_u32 s66, s66, 40960
    s_add_u32 m0, s68, 15360
    s_nop 0
    buffer_load_dwordx4 v15, s[8:11], s66 offen lds
    s_add_u32 m0, s68, 16384
    s_nop 0
    buffer_load_dwordx4 v16, s[8:11], s66 offen lds
    s_add_u32 m0, s68, 17408
    s_nop 0
    buffer_load_dwordx4 v17, s[8:11], s66 offen lds
    s_add_u32 m0, s68, 18432
    s_nop 0
    buffer_load_dwordx4 v18, s[8:11], s66 offen lds
    s_add_u32 m0, s68, 19456
    s_nop 0
    buffer_load_dwordx4 v19, s[8:11], s66 offen lds
    v_and_b32 v1, 31, v0
    v_lshrrev_b32 v2, 5, v0
    v_mov_b32 v26, 0xdddddddd
    v_add_u32 v27, 6144, v14
    v_lshlrev_b32 v102, 3, v1
    v_add_u32 v102, 7168, v102
    v_min_u32 v1, 21, v1
    v_mul_u32_u24 v2, 352, v2
    v_lshl_add_u32 v1, v1, 4, v2
    v_add_u32 v103, 7680, v1
    s_lshl_b32 s63, s56, 6
    s_mov_b32 s72, 52429
    s_mov_b32 s73, 1120
    v_add_u32 v232, s63, v0
    v_mul_u32_u24 v233, s72, v232
    v_lshlrev_b32 v234, 4, v232
    v_lshrrev_b32 v233, 19, v233
    v_add_u32 v232, 512, v232
    v_mad_u32_u24 v15, v233, s73, v234
    v_mul_u32_u24 v233, s72, v232
    v_lshlrev_b32 v234, 4, v232
    v_lshrrev_b32 v233, 19, v233
    v_add_u32 v232, 512, v232
    v_mad_u32_u24 v16, v233, s73, v234
    v_mul_u32_u24 v233, s72, v232
    v_lshlrev_b32 v234, 4, v232
    v_lshrrev_b32 v233, 19, v233
    v_add_u32 v232, 512, v232
    v_mad_u32_u24 v17, v233, s73, v234
    v_mul_u32_u24 v233, s72, v232
    v_lshlrev_b32 v234, 4, v232
    v_lshrrev_b32 v233, 19, v233
    v_add_u32 v232, 512, v232
    v_mad_u32_u24 v18, v233, s73, v234
    v_mul_u32_u24 v233, s72, v232
    v_lshlrev_b32 v234, 4, v232
    v_lshrrev_b32 v233, 19, v233
    v_add_u32 v232, 512, v232
    v_mad_u32_u24 v19, v233, s73, v234
    s_waitcnt vmcnt(0)
    v_mov_b32 v1, 60416
    v_mov_b32 v2, 1
    s_mov_b64 exec, 1
    ds_add_u32 v1, v2 offset:16
    s_mov_b64 exec, -1
    s_cmp_eq_u32 s58, 7
    s_cbranch_scc1 L_frontB_join
    v_mov_b32 v1, 60416
    s_mov_b32 s69, 200000
L_lw_3:
    ds_read_b32 v2, v1 offset:28
    s_sub_u32 s69, s69, 1
    s_waitcnt lgkmcnt(0)
    v_readfirstlane_b32 s65, v2
    s_cmp_ge_u32 s65, 4
    s_cbranch_scc1 L_lg_4
    s_sleep 1
    s_cmp_lg_u32 s69, 0
    s_cbranch_scc1 L_lw_3
L_lg_4:
L_frontB_join:
    s_sub_u32 s68, s56, 4
    v_lshrrev_b32 v232, 2, v0
    v_and_b32 v233, 3, v0
    v_lshl_add_u32 v232, v232, 3, v233
    v_mul_u32_u24 v232, 128, v232
    s_and_b32 s66, s68, 1
    s_lshr_b32 s68, s68, 1
    s_lshl_b32 s68, s68, 5
    s_add_u32 s66, s66, s68
    s_mul_i32 s66, s66, 512
    s_add_u32 s66, s66, 4096
    v_mov_b32 v1, 60416
    s_mov_b32 s69, 200000
L_lw_5:
    ds_read_b32 v2, v1 offset:16
    s_sub_u32 s69, s69, 1
    s_waitcnt lgkmcnt(0)
    v_readfirstlane_b32 s65, v2
    s_cmp_ge_u32 s65, 4
    s_cbranch_scc1 L_lg_6
    s_sleep 1
    s_cmp_lg_u32 s69, 0
    s_cbranch_scc1 L_lw_5
L_lg_6:
L_poll0:
    s_mov_b32 s69, 200000
L_kvpoll:
    buffer_load_dwordx2 v[234:235], v232, s[28:31], s66 offen sc1
    s_sub_u32 s69, s69, 1
    s_waitcnt vmcnt(0)
    v_cmp_ne_u32 vcc, s61, v234
    s_cbranch_vccz L_kvready
    s_mov_b64 exec, vcc
    s_cmp_eq_u32 s69, 0
    s_cbranch_scc1 L_kvready
    s_sleep 4
    s_branch L_kvpoll
L_kvready:
    s_mov_b64 exec, -1
    s_and_b32 s64, s56, 3
    s_and_b32 s63, s56, 1
    s_bitcmp1_b32 s56, 1
    s_cselect_b32 s65, 32, 0
    s_add_u32 s63, s63, s65
    s_mul_i32 s63, s63, 3072
    s_add_u32 s63, s63, 65536
    s_mul_i32 s64, s64, 3072
    s_add_u32 s64, s64, 0
    s_add_u32 m0, s64, 0
    s_nop 0
    buffer_load_dwordx4 v14, s[28:31], s63 offen offset:0 sc1 lds
    buffer_load_dwordx4 v14, s[28:31], s63 offen offset:1024 sc1 lds
    buffer_load_dwordx4 v14, s[28:31], s63 offen offset:2048 sc1 lds
    s_add_u32 s63, s63, 6144
    s_add_u32 m0, s64, 12288
    s_nop 0
    buffer_load_dwordx4 v14, s[28:31], s63 offen offset:0 sc1 lds
    buffer_load_dwordx4 v14, s[28:31], s63 offen offset:1024 sc1 lds
    buffer_load_dwordx4 v14, s[28:31], s63 offen offset:2048 sc1 lds
    s_add_u32 s63, s63, 6144
    s_cmp_eq_u32 s59, 0
    s_cbranch_scc1 L_kvissued
    s_mov_b64 exec, 1
    v_add_f32 v168, v168, v100
    s_mov_b64 exec, -1
    v_cmp_gt_u32 s[76:77], 32, v0
    v_readlane_b32 s63, v176, 0
    v_readlane_b32 s64, v178, 0
    v_readlane_b32 s65, v180, 0
    v_cvt_pk_bf16_f32 v236, v178, v179
    v_mov_b32 v224, s63
    v_mov_b32 v225, s64
    v_mov_b32 v226, s65
    v_cvt_pk_bf16_f32 v237, v225, v226
    v_cvt_pk_bf16_f32 v227, v225, v225
    v_mov_b32_dpp v224, v168 wave_shl:1 row_mask:0xf bank_mask:0xf
    v_mov_b32_dpp v225, v176 wave_shl:1 row_mask:0xf bank_mask:0xf
    v_cndmask_b32 v226, v224, v175, s[76:77]
    v_cvt_pk_bf16_f32 v184, v226, v174
    v_cvt_pk_bf16_f32 v188, v224, v226
    v_cvt_pk_bf16_f32 v185, v173, v172
    v_cvt_pk_bf16_f32 v189, v174, v173
    v_cvt_pk_bf16_f32 v186, v171, v170
    v_cvt_pk_bf16_f32 v190, v172, v171
    v_cvt_pk_bf16_f32 v187, v169, v168
    v_cvt_pk_bf16_f32 v191, v170, v169
    v_cvt_pk_bf16_f32 v200, v225, v225
    v_cvt_pk_bf16_f32 v204, v225, v225
    v_cvt_pk_bf16_f32 v201, v177, v177
    v_cvt_pk_bf16_f32 v205, v225, v177
    v_cvt_pk_bf16_f32 v202, v177, v176
    v_cvt_pk_bf16_f32 v206, v177, v177
    v_cvt_pk_bf16_f32 v203, v176, v176
    v_cvt_pk_bf16_f32 v207, v176, v176
    v_readlane_b32 s63, v203, 0
    v_readlane_b32 s64, v207, 0
    v_mov_b32 v208, v227
    v_mov_b32 v212, v227
    v_mov_b32 v192, s63
    v_mov_b32 v196, s64
    v_mov_b32 v193, v184
    v_mov_b32 v194, v185
    v_mov_b32 v195, v186
    v_mov_b32 v197, v188
    v_mov_b32 v198, v189
    v_mov_b32 v199, v190
    v_mov_b32 v209, v200
    v_mov_b32 v210, v201
    v_mov_b32 v211, v202
    v_mov_b32 v213, v204
    v_mov_b32 v214, v205
    v_mov_b32 v215, v206
    v_mov_b32_dpp v192, v187 wave_shl:1 row_mask:0xf bank_mask:0xf
    v_mov_b32_dpp v196, v191 wave_shl:1 row_mask:0xf bank_mask:0xf
    v_mov_b32_dpp v208, v203 wave_shl:1 row_mask:0xf bank_mask:0xf
    v_mov_b32_dpp v212, v207 wave_shl:1 row_mask:0xf bank_mask:0xf
    v_and_b32 v1, 15, v0
    v_lshrrev_b32 v2, 1, v0
    v_and_b32 v2, 24, v2
    v_sub_u32 v1, v1, v2
    v_add_u32 v1, 36, v1
    s_mov_b32 s73, 0x8001
    s_mov_b32 s74, 0x3f80
    v_mov_b32 v2, 511
    v_mov_b32 v3, 0
    v_lshlrev_b64 v[2:3], v1, v[2:3]
    v_bfe_u32 v240, v3, 0, 2
    v_bfe_u32 v241, v3, 2, 2
    v_bfe_u32 v242, v3, 4, 2
    v_bfe_u32 v243, v3, 6, 2
    v_mul_u32_u24 v240, s73, v240
    v_mul_u32_u24 v241, s73, v241
    v_mul_u32_u24 v242, s73, v242
    v_mul_u32_u24 v243, s73, v243
    v_and_b32 v240, 0x10001, v240
    v_and_b32 v241, 0x10001, v241
    v_and_b32 v242, 0x10001, v242
    v_and_b32 v243, 0x10001, v243
    v_mul_u32_u24 v240, s74, v240
    v_mul_u32_u24 v241, s74, v241
    v_mul_u32_u24 v242, s74, v242
    v_mul_u32_u24 v243, s74, v243
    v_mov_b32 v2, 254
    v_mov_b32 v3, 0
    v_lshlrev_b64 v[2:3], v1, v[2:3]
    v_bfe_u32 v244, v3, 0, 2
    v_bfe_u32 v245, v3, 2, 2
    v_bfe_u32 v246, v3, 4, 2
    v_bfe_u32 v247, v3, 6, 2
    v_mul_u32_u24 v244, s73, v244
    v_mul_u32_u24 v245, s73, v245
    v_mul_u32_u24 v246, s73, v246
    v_mul_u32_u24 v247, s73, v247
    v_and_b32 v244, 0x10001, v244
    v_and_b32 v245, 0x10001, v245
    v_and_b32 v246, 0x10001, v246
    v_and_b32 v247, 0x10001, v247
    v_mul_u32_u24 v244, s74, v244
    v_mul_u32_u24 v245, s74, v245
    v_mul_u32_u24 v246, s74, v246
    v_mul_u32_u24 v247, s74, v247
L_kvissued:
    v_max_u32_dpp v235, v235, v235 row_shr:1 row_mask:0xf bank_mask:0xf
    s_nop 1
    v_max_u32_dpp v235, v235, v235 row_shr:2 row_mask:0xf bank_mask:0xf
    s_nop 1
    v_max_u32_dpp v235, v235, v235 row_shr:4 row_mask:0xf bank_mask:0xf
    s_nop 1
    v_max_u32_dpp v235, v235, v235 row_shr:8 row_mask:0xf bank_mask:0xf
    v_mov_b32 v1, 60416
    s_mov_b32 exec_lo, 0x80008000
    s_mov_b32 exec_hi, 0x80008000
    ds_max_u32 v1, v235 offset:8
    s_mov_b64 exec, -1
    s_and_b32 s63, s56, 3
    s_mul_i32 s63, s63, 40
    s_add_u32 s63, s63, 61440
    v_and_b32 v1, 31, v0
    v_lshrrev_b32 v2, 5, v0
    v_mul_u32_u24 v3, 168, v1
    v_mul_u32_u24 v1, 168, v0
    v_lshl_add_u32 v3, v2, 3, v3
    v_add_u32 v228, s63, v3
    v_add_u32 v229, s63, v1
    v_mov_b32 v230, 60416
    v_mov_b32 v20, 0
    v_mov_b32 v21, 0
    s_nop 1
    v_mfma_f32_32x32x4bf16_1k v[120:151], v[20:21], v[20:21], 0
    s_and_b32 s64, s56, 3
    s_and_b32 s63, s56, 1
    s_bitcmp1_b32 s56, 1
    s_cselect_b32 s65, 32, 0
    s_add_u32 s63, s63, s65
    s_mul_i32 s63, s63, 3072
    s_add_u32 s63, s63, 77824
    s_mul_i32 s64, s64, 3072
    s_add_u32 s64, s64, 0
    s_add_u32 m0, s64, 24576
    s_waitcnt vmcnt(3) lgkmcnt(0)
    s_barrier
    buffer_load_dwordx4 v14, s[28:31], s63 offen offset:0 sc1 lds
    buffer_load_dwordx4 v14, s[28:31], s63 offen offset:1024 sc1 lds
    buffer_load_dwordx4 v14, s[28:31], s63 offen offset:2048 sc1 lds
    s_branch L_pathB
L_frontA1:
    s_cmp_eq_u32 s59, 0
    s_cbranch_scc1 L_frontA_non
    s_mov_b32 s10, 819200
    s_mov_b32 s11, 0x20000
    s_mov_b32 s18, 819200
    s_mov_b32 s19, 0x20000
    s_mov_b32 s26, 5242880
    s_mov_b32 s27, 0x20000
    s_mov_b32 s72, 52429
    s_mov_b32 s73, 1120
    v_mov_b32 v1, v0
    s_mov_b32 s74, 1280
    v_mul_u32_u24 v2, s72, v1
    v_lshlrev_b32 v3, 4, v1
    v_lshrrev_b32 v224, 21, v2
    v_lshrrev_b32 v225, 22, v2
    v_lshrrev_b32 v2, 19, v2
    v_xor_b32 v224, v224, v225
    v_mad_u32_u24 v3, v2, s73, v3
    v_and_b32 v224, 1, v224
    v_bfe_u32 v225, v2, 2, 1
    v_lshlrev_b32 v225, 1, v225
    v_add_u32 v225, -1, v225
    v_mul_i32_i24 v224, v224, v225
    v_mul_i32_i24 v224, 5120, v224
    v_add_u32 v1, 64, v1
    v_add_u32 v15, v3, v224
    v_mul_u32_u24 v2, s72, v1
    v_lshlrev_b32 v3, 4, v1
    v_lshrrev_b32 v224, 21, v2
    v_lshrrev_b32 v225, 22, v2
    v_lshrrev_b32 v2, 19, v2
    v_xor_b32 v224, v224, v225
    v_mad_u32_u24 v3, v2, s73, v3
    v_and_b32 v224, 1, v224
    v_bfe_u32 v225, v2, 2, 1
    v_lshlrev_b32 v225, 1, v225
    v_add_u32 v225, -1, v225
    v_mul_i32_i24 v224, v224, v225
    v_mul_i32_i24 v224, 5120, v224
    v_add_u32 v1, 64, v1
    v_add_u32 v16, v3, v224
    v_mul_u32_u24 v2, s72, v1
    v_lshlrev_b32 v3, 4, v1
    v_lshrrev_b32 v224, 21, v2
    v_lshrrev_b32 v225, 22, v2
    v_lshrrev_b32 v2, 19, v2
    v_xor_b32 v224, v224, v225
    v_mad_u32_u24 v3, v2, s73, v3
    v_and_b32 v224, 1, v224
    v_bfe_u32 v225, v2, 2, 1
    v_lshlrev_b32 v225, 1, v225
    v_add_u32 v225, -1, v225
    v_mul_i32_i24 v224, v224, v225
    v_mul_i32_i24 v224, 5120, v224
    v_add_u32 v1, 64, v1
    v_add_u32 v17, v3, v224
    v_mul_u32_u24 v2, s72, v1
    v_lshlrev_b32 v3, 4, v1
    v_lshrrev_b32 v224, 21, v2
    v_lshrrev_b32 v225, 22, v2
    v_lshrrev_b32 v2, 19, v2
    v_xor_b32 v224, v224, v225
    v_mad_u32_u24 v3, v2, s73, v3
    v_and_b32 v224, 1, v224
    v_bfe_u32 v225, v2, 2, 1
    v_lshlrev_b32 v225, 1, v225
    v_add_u32 v225, -1, v225
    v_mul_i32_i24 v224, v224, v225
    v_mul_i32_i24 v224, 5120, v224
    v_add_u32 v1, 64, v1
    v_add_u32 v18, v3, v224
    v_mul_u32_u24 v2, s72, v1
    v_lshlrev_b32 v3, 4, v1
    v_lshrrev_b32 v224, 21, v2
    v_lshrrev_b32 v225, 22, v2
    v_lshrrev_b32 v2, 19, v2
    v_xor_b32 v224, v224, v225
    v_mad_u32_u24 v3, v2, s73, v3
    v_and_b32 v224, 1, v224
    v_bfe_u32 v225, v2, 2, 1
    v_lshlrev_b32 v225, 1, v225
    v_add_u32 v225, -1, v225
    v_mul_i32_i24 v224, v224, v225
    v_mul_i32_i24 v224, 5120, v224
    v_add_u32 v1, 64, v1
    v_add_u32 v19, v3, v224
    s_mul_i32 s63, s56, 40960
    s_mul_i32 s66, s58, 160
    s_add_u32 s63, s63, s66
    s_mul_i32 s64, s56, 5120
    s_add_u32 s64, s64, 61440
    s_add_u32 m0, s64, 0
    s_nop 0
    buffer_load_dwordx4 v15, s[8:11], s63 offen lds
    s_add_u32 m0, s64, 1024
    s_nop 0
    buffer_load_dwordx4 v16, s[8:11], s63 offen lds
    s_add_u32 m0, s64, 2048
    s_nop 0
    buffer_load_dwordx4 v17, s[8:11], s63 offen lds
    s_add_u32 m0, s64, 3072
    s_nop 0
    buffer_load_dwordx4 v18, s[8:11], s63 offen lds
    s_add_u32 m0, s64, 4096
    s_nop 0
    buffer_load_dwordx4 v19, s[8:11], s63 offen lds
    s_add_u32 s63, s56, 1
    s_mul_i32 s63, s63, 163840
    s_add_u32 s66, s66, s63
    v_lshrrev_b32 v2, 4, v0
    v_and_b32 v228, 7, v0
    v_xor_b32 v229, v228, v2
    v_lshlrev_b32 v229, 4, v229
    v_lshl_add_u32 v229, v228, 7, v229
    v_bfe_u32 v228, v0, 3, 1
    v_lshl_add_u32 v229, v228, 10, v229
    v_add_u32 v228, s68, v229
    v_xor_b32 v229, 64, v228
    v_bfe_u32 v3, v0, 2, 2
    v_and_b32 v1, 3, v0
    v_lshlrev_b32 v1, 3, v1
    v_lshl_add_u32 v224, v2, 3, v3
    v_mul_u32_u24 v224, 40, v224
    v_add_u32 v225, v224, v1
    v_mov_b32 v230, v224
    v_lshrrev_b32 v224, 1, v2
    v_and_b32 v2, 1, v2
    v_lshlrev_b32 v224, 4, v224
    v_lshl_add_u32 v224, v2, 2, v224
    v_add_u32 v224, v224, v3
    v_mul_u32_u24 v224, 160, v224
    v_add_u32 v224, v224, v1
    v_add_u32 v226, 61440, v224
    v_add_u32 v227, 122880, v224
    s_waitcnt vmcnt(5)
    v_readfirstlane_b32 s61, v101
    ds_read_b128 v[120:123], v228 offset:0
    ds_read_b128 v[124:127], v229 offset:0
    ds_read_b128 v[128:131], v228 offset:2048
    ds_read_b128 v[132:135], v229 offset:2048
    ds_read_b128 v[136:139], v228 offset:4096
    ds_read_b128 v[140:143], v229 offset:4096
    ds_read_b128 v[144:147], v228 offset:6144
    ds_read_b128 v[148:151], v229 offset:6144
    ds_read_b128 v[152:155], v228 offset:8192
    ds_read_b128 v[156:159], v229 offset:8192
    ds_read_b128 v[160:163], v228 offset:10240
    ds_read_b128 v[164:167], v229 offset:10240
    ds_read_b128 v[168:171], v228 offset:12288
    ds_read_b128 v[172:175], v229 offset:12288
    ds_read_b128 v[176:179], v228 offset:14336
    ds_read_b128 v[180:183], v229 offset:14336
    ds_read_b128 v[184:187], v228 offset:16384
    ds_read_b128 v[188:191], v229 offset:16384
    ds_read_b128 v[192:195], v228 offset:18432
    ds_read_b128 v[196:199], v229 offset:18432
    s_add_u32 s61, s61, 0x9e3779b9
    s_waitcnt lgkmcnt(0)
    s_add_u32 m0, s68, 0
    s_nop 0
    buffer_load_dwordx4 v15, s[8:11], s66 offen lds
    s_add_u32 m0, s68, 1024
    s_nop 0
    buffer_load_dwordx4 v16, s[8:11], s66 offen lds
    s_add_u32 m0, s68, 2048
    s_nop 0
    buffer_load_dwordx4 v17, s[8:11], s66 offen lds
    s_add_u32 m0, s68, 3072
    s_nop 0
    buffer_load_dwordx4 v18, s[8:11], s66 offen lds
    s_add_u32 m0, s68, 4096
    s_nop 0
    buffer_load_dwordx4 v19, s[8:11], s66 offen lds
    s_add_u32 s66, s66, 40960
    s_add_u32 m0, s68, 5120
    s_nop 0
    buffer_load_dwordx4 v15, s[8:11], s66 offen lds
    s_add_u32 m0, s68, 6144
    s_nop 0
    buffer_load_dwordx4 v16, s[8:11], s66 offen lds
    s_add_u32 m0, s68, 7168
    s_nop 0
    buffer_load_dwordx4 v17, s[8:11], s66 offen lds
    s_add_u32 m0, s68, 8192
    s_nop 0
    buffer_load_dwordx4 v18, s[8:11], s66 offen lds
    s_add_u32 m0, s68, 9216
    s_nop 0
    buffer_load_dwordx4 v19, s[8:11], s66 offen lds
    s_waitcnt vmcnt(10)
    v_mov_b32 v1, 60416
    v_mov_b32 v2, 1
    s_mov_b64 exec, 1
    ds_add_u32 v1, v2 offset:12
    s_mov_b64 exec, -1
    s_add_u32 s66, s66, 40960
    s_add_u32 m0, s68, 10240
    s_nop 0
    buffer_load_dwordx4 v15, s[8:11], s66 offen lds
    s_add_u32 m0, s68, 11264
    s_nop 0
    buffer_load_dwordx4 v16, s[8:11], s66 offen lds
    s_add_u32 m0, s68, 12288
    s_nop 0
    buffer_load_dwordx4 v17, s[8:11], s66 offen lds
    s_add_u32 m0, s68, 13312
    s_nop 0
    buffer_load_dwordx4 v18, s[8:11], s66 offen lds
    s_add_u32 m0, s68, 14336
    s_nop 0
    buffer_load_dwordx4 v19, s[8:11], s66 offen lds
    s_add_u32 s66, s66, 40960
    s_add_u32 m0, s68, 15360
    s_nop 0
    buffer_load_dwordx4 v15, s[8:11], s66 offen lds
    s_add_u32 m0, s68, 16384
    s_nop 0
    buffer_load_dwordx4 v16, s[8:11], s66 offen lds
    s_add_u32 m0, s68, 17408
    s_nop 0
    buffer_load_dwordx4 v17, s[8:11], s66 offen lds
    s_add_u32 m0, s68, 18432
    s_nop 0
    buffer_load_dwordx4 v18, s[8:11], s66 offen lds
    s_add_u32 m0, s68, 19456
    s_nop 0
    buffer_load_dwordx4 v19, s[8:11], s66 offen lds
    v_mov_b32 v1, 60416
    s_mov_b32 s69, 200000
L_lw_7:
    ds_read_b32 v2, v1 offset:12
    s_sub_u32 s69, s69, 1
    s_waitcnt lgkmcnt(0)
    v_readfirstlane_b32 s65, v2
    s_cmp_ge_u32 s65, 4
    s_cbranch_scc1 L_lg_8
    s_sleep 1
    s_cmp_lg_u32 s69, 0
    s_cbranch_scc1 L_lw_7
L_lg_8:
    ds_read_b64_tr_b16 v[200:201], v226 offset:0
    ds_read_b64_tr_b16 v[202:203], v226 offset:1280
    ds_read_b64_tr_b16 v[204:205], v226 offset:32
    ds_read_b64_tr_b16 v[206:207], v226 offset:1312
    ds_read_b64_tr_b16 v[208:209], v226 offset:64
    ds_read_b64_tr_b16 v[210:211], v226 offset:1344
    ds_read_b64_tr_b16 v[212:213], v226 offset:96
    ds_read_b64_tr_b16 v[214:215], v226 offset:1376
    ds_read_b64_tr_b16 v[216:217], v226 offset:128
    ds_read_b64_tr_b16 v[218:219], v226 offset:1408
    s_waitcnt lgkmcnt(8)
    v_mfma_f32_16x16x32_bf16 v[36:39], v[200:203], v[120:123], 0
    ds_read_b64_tr_b16 v[200:201], v226 offset:5120
    ds_read_b64_tr_b16 v[202:203], v226 offset:6400
    s_waitcnt lgkmcnt(8)
    v_mfma_f32_16x16x32_bf16 v[40:43], v[204:207], v[120:123], 0
    ds_read_b64_tr_b16 v[204:205], v226 offset:5152
    ds_read_b64_tr_b16 v[206:207], v226 offset:6432
    s_waitcnt lgkmcnt(8)
    v_mfma_f32_16x16x32_bf16 v[44:47], v[208:211], v[120:123], 0
    ds_read_b64_tr_b16 v[208:209], v226 offset:5184
    ds_read_b64_tr_b16 v[210:211], v226 offset:6464
    s_waitcnt lgkmcnt(8)
    v_mfma_f32_16x16x32_bf16 v[48:51], v[212:215], v[120:123], 0
    ds_read_b64_tr_b16 v[212:213], v226 offset:5216
    ds_read_b64_tr_b16 v[214:215], v226 offset:6496
    s_waitcnt lgkmcnt(8)
    v_mfma_f32_16x16x32_bf16 v[52:55], v[216:219], v[120:123], 0
    ds_read_b64_tr_b16 v[216:217], v226 offset:5248
    ds_read_b64_tr_b16 v[218:219], v226 offset:6528
    s_waitcnt lgkmcnt(8)
    v_mfma_f32_16x16x32_bf16 v[36:39], v[200:203], v[124:127], v[36:39]
    ds_read_b64_tr_b16 v[200:201], v226 offset:10240
    ds_read_b64_tr_b16 v[202:203], v226 offset:11520
    s_waitcnt lgkmcnt(8)
    v_mfma_f32_16x16x32_bf16 v[40:43], v[204:207], v[124:127], v[40:43]
    ds_read_b64_tr_b16 v[204:205], v226 offset:10272
    ds_read_b64_tr_b16 v[206:207], v226 offset:11552
    s_waitcnt lgkmcnt(8)
    v_mfma_f32_16x16x32_bf16 v[44:47], v[208:211], v[124:127], v[44:47]
    ds_read_b64_tr_b16 v[208:209], v226 offset:10304
    ds_read_b64_tr_b16 v[210:211], v226 offset:11584
    s_waitcnt lgkmcnt(8)
    v_mfma_f32_16x16x32_bf16 v[48:51], v[212:215], v[124:127], v[48:51]
    ds_read_b64_tr_b16 v[212:213], v226 offset:10336
    ds_read_b64_tr_b16 v[214:215], v226 offset:11616
    s_waitcnt lgkmcnt(8)
    v_mfma_f32_16x16x32_bf16 v[52:55], v[216:219], v[124:127], v[52:55]
    ds_read_b64_tr_b16 v[216:217], v226 offset:10368
    ds_read_b64_tr_b16 v[218:219], v226 offset:11648
    s_waitcnt lgkmcnt(8)
    v_mfma_f32_16x16x32_bf16 v[36:39], v[200:203], v[128:131], v[36:39]
    ds_read_b64_tr_b16 v[200:201], v226 offset:15360
    ds_read_b64_tr_b16 v[202:203], v226 offset:16640
    s_waitcnt lgkmcnt(8)
    v_mfma_f32_16x16x32_bf16 v[40:43], v[204:207], v[128:131], v[40:43]
    ds_read_b64_tr_b16 v[204:205], v226 offset:15392
    ds_read_b64_tr_b16 v[206:207], v226 offset:16672
    s_waitcnt lgkmcnt(8)
    v_mfma_f32_16x16x32_bf16 v[44:47], v[208:211], v[128:131], v[44:47]
    ds_read_b64_tr_b16 v[208:209], v226 offset:15424
    ds_read_b64_tr_b16 v[210:211], v226 offset:16704
    s_waitcnt lgkmcnt(8)
    v_mfma_f32_16x16x32_bf16 v[48:51], v[212:215], v[128:131], v[48:51]
    ds_read_b64_tr_b16 v[212:213], v226 offset:15456
    ds_read_b64_tr_b16 v[214:215], v226 offset:16736
    s_waitcnt lgkmcnt(8)
    v_mfma_f32_16x16x32_bf16 v[52:55], v[216:219], v[128:131], v[52:55]
    ds_read_b64_tr_b16 v[216:217], v226 offset:15488
    ds_read_b64_tr_b16 v[218:219], v226 offset:16768
    s_waitcnt lgkmcnt(8)
    v_mfma_f32_16x16x32_bf16 v[36:39], v[200:203], v[132:135], v[36:39]
    s_waitcnt lgkmcnt(6)
    v_mfma_f32_16x16x32_bf16 v[40:43], v[204:207], v[132:135], v[40:43]
    s_waitcnt lgkmcnt(4)
    v_mfma_f32_16x16x32_bf16 v[44:47], v[208:211], v[132:135], v[44:47]
    s_waitcnt lgkmcnt(2)
    v_mfma_f32_16x16x32_bf16 v[48:51], v[212:215], v[132:135], v[48:51]
    s_waitcnt lgkmcnt(0)
    v_mfma_f32_16x16x32_bf16 v[52:55], v[216:219], v[132:135], v[52:55]
    v_and_b32 v1, 31, v0
    v_lshrrev_b32 v2, 5, v0
    v_mov_b32 v26, 0xdddddddd
    v_add_u32 v27, 0, v14
    v_lshlrev_b32 v102, 3, v1
    v_add_u32 v102, 1024, v102
    v_min_u32 v1, 21, v1
    v_mul_u32_u24 v2, 352, v2
    v_lshl_add_u32 v1, v1, 4, v2
    v_add_u32 v103, 1536, v1
    s_lshl_b32 s63, s56, 6
    s_mov_b32 s72, 52429
    s_mov_b32 s73, 1120
    v_add_u32 v232, s63, v0
    v_mul_u32_u24 v233, s72, v232
    v_lshlrev_b32 v234, 4, v232
    v_lshrrev_b32 v233, 19, v233
    v_add_u32 v232, 512, v232
    v_mad_u32_u24 v240, v233, s73, v234
    v_mul_u32_u24 v233, s72, v232
    v_lshlrev_b32 v234, 4, v232
    v_lshrrev_b32 v233, 19, v233
    v_add_u32 v232, 512, v232
    v_mad_u32_u24 v241, v233, s73, v234
    v_mul_u32_u24 v233, s72, v232
    v_lshlrev_b32 v234, 4, v232
    v_lshrrev_b32 v233, 19, v233
    v_add_u32 v232, 512, v232
    v_mad_u32_u24 v242, v233, s73, v234
    v_mul_u32_u24 v233, s72, v232
    v_lshlrev_b32 v234, 4, v232
    v_lshrrev_b32 v233, 19, v233
    v_add_u32 v232, 512, v232
    v_mad_u32_u24 v243, v233, s73, v234
    v_mul_u32_u24 v233, s72, v232
    v_lshlrev_b32 v234, 4, v232
    v_lshrrev_b32 v233, 19, v233
    v_add_u32 v232, 512, v232
    v_mad_u32_u24 v244, v233, s73, v234
    s_and_b32 s63, s56, 3
    s_mul_i32 s63, s63, 40
    s_add_u32 s63, s63, 61440
    v_and_b32 v1, 31, v0
    v_lshrrev_b32 v2, 5, v0
    v_mul_u32_u24 v3, 168, v1
    v_mul_u32_u24 v1, 168, v0
    v_lshl_add_u32 v3, v2, 3, v3
    v_add_u32 v245, s63, v3
    v_add_u32 v246, s63, v1
    v_mov_b32 v247, 60416
    s_waitcnt vmcnt(0)
    v_mov_b32 v1, 60416
    v_mov_b32 v2, 1
    s_mov_b64 exec, 1
    ds_add_u32 v1, v2 offset:16
    s_mov_b64 exec, -1
    v_mov_b32 v1, 60416
    s_mov_b32 s69, 200000
L_lw_9:
    ds_read_b32 v2, v1 offset:16
    s_sub_u32 s69, s69, 1
    s_waitcnt lgkmcnt(0)
    v_readfirstlane_b32 s65, v2
    s_cmp_ge_u32 s65, 4
    s_cbranch_scc1 L_lg_10
    s_sleep 1
    s_cmp_lg_u32 s69, 0
    s_cbranch_scc1 L_lw_9
L_lg_10:
    s_branch L_frontA_join
L_frontA_non:
    s_mov_b32 s18, 819200
    s_mov_b32 s19, 0x20000
    s_mov_b32 s26, 5242880
    s_mov_b32 s27, 0x20000
    v_lshrrev_b32 v2, 4, v0
    v_and_b32 v228, 7, v0
    v_xor_b32 v229, v228, v2
    v_lshlrev_b32 v229, 4, v229
    v_lshl_add_u32 v229, v228, 7, v229
    v_bfe_u32 v228, v0, 3, 1
    v_lshl_add_u32 v229, v228, 10, v229
    v_add_u32 v228, s68, v229
    v_xor_b32 v229, 64, v228
    v_bfe_u32 v3, v0, 2, 2
    v_and_b32 v1, 3, v0
    v_lshlrev_b32 v1, 3, v1
    v_lshl_add_u32 v224, v2, 3, v3
    v_mul_u32_u24 v224, 40, v224
    v_add_u32 v225, v224, v1
    v_mov_b32 v230, v224
    v_lshrrev_b32 v224, 1, v2
    v_and_b32 v2, 1, v2
    v_lshlrev_b32 v224, 4, v224
    v_lshl_add_u32 v224, v2, 2, v224
    v_add_u32 v224, v224, v3
    v_mul_u32_u24 v224, 160, v224
    v_add_u32 v224, v224, v1
    v_add_u32 v226, 61440, v224
    v_add_u32 v227, 122880, v224
    s_cmp_eq_u32 s58, 7
    s_cbranch_scc1 L_frontA_plain
    s_setprio 2
    s_waitcnt vmcnt(0)
    v_readfirstlane_b32 s61, v101
    ds_read_b128 v[120:123], v228 offset:0
    ds_read_b128 v[124:127], v229 offset:0
    ds_read_b128 v[128:131], v228 offset:2048
    ds_read_b128 v[132:135], v229 offset:2048
    ds_read_b128 v[136:139], v228 offset:4096
    ds_read_b128 v[140:143], v229 offset:4096
    ds_read_b128 v[144:147], v228 offset:6144
    ds_read_b128 v[148:151], v229 offset:6144
    ds_read_b128 v[152:155], v228 offset:8192
    ds_read_b128 v[156:159], v229 offset:8192
    ds_read_b128 v[160:163], v228 offset:10240
    ds_read_b128 v[164:167], v229 offset:10240
    ds_read_b128 v[168:171], v228 offset:12288
    ds_read_b128 v[172:175], v229 offset:12288
    ds_read_b128 v[176:179], v228 offset:14336
    ds_read_b128 v[180:183], v229 offset:14336
    ds_read_b128 v[184:187], v228 offset:16384
    ds_read_b128 v[188:191], v229 offset:16384
    ds_read_b128 v[192:195], v228 offset:18432
    ds_read_b128 v[196:199], v229 offset:18432
    v_mov_b32 v1, 60416
    v_mov_b32 v2, 1
    s_mov_b64 exec, 1
    ds_add_u32 v1, v2 offset:24
    s_mov_b64 exec, -1
    v_mov_b32 v1, 60416
    s_mov_b32 s69, 200000
L_lw_11:
    ds_read_b32 v2, v1 offset:20
    s_sub_u32 s69, s69, 1
    s_waitcnt lgkmcnt(0)
    v_readfirstlane_b32 s65, v2
    s_cmp_ge_u32 s65, 4
    s_cbranch_scc1 L_lg_12
    s_sleep 1
    s_cmp_lg_u32 s69, 0
    s_cbranch_scc1 L_lw_11
L_lg_12:
    s_add_u32 s61, s61, 0x9e3779b9
    s_cmp_eq_u32 s58, 6
    s_cbranch_scc1 L_vproj
    ds_read_b64_tr_b16 v[20:21], v225 offset:0
    ds_read_b64_tr_b16 v[22:23], v225 offset:160
    ds_read_b64_tr_b16 v[24:25], v230 offset:32
    ds_read_b64_tr_b16 v[26:27], v230 offset:192
    ds_read_b64_tr_b16 v[28:29], v225 offset:1280
    ds_read_b64_tr_b16 v[30:31], v225 offset:1440
    ds_read_b64_tr_b16 v[32:33], v230 offset:1312
    ds_read_b64_tr_b16 v[34:35], v230 offset:1472
    ds_read_b64_tr_b16 v[36:37], v225 offset:2560
    ds_read_b64_tr_b16 v[38:39], v225 offset:2720
    ds_read_b64_tr_b16 v[40:41], v230 offset:2592
    ds_read_b64_tr_b16 v[42:43], v230 offset:2752
    s_waitcnt lgkmcnt(10)
    v_mfma_f32_16x16x32_bf16 v[4:7], v[20:23], v[120:123], 0
    s_waitcnt lgkmcnt(8)
    v_mfma_f32_16x16x32_bf16 v[8:11], v[24:27], v[120:123], 0
    ds_read_b64_tr_b16 v[44:45], v225 offset:3840
    ds_read_b64_tr_b16 v[46:47], v225 offset:4000
    ds_read_b64_tr_b16 v[48:49], v230 offset:3872
    ds_read_b64_tr_b16 v[50:51], v230 offset:4032
    s_waitcnt lgkmcnt(10)
    v_mfma_f32_16x16x32_bf16 v[4:7], v[28:31], v[124:127], v[4:7]
    s_waitcnt lgkmcnt(8)
    v_mfma_f32_16x16x32_bf16 v[8:11], v[32:35], v[124:127], v[8:11]
    ds_read_b64_tr_b16 v[52:53], v225 offset:5120
    ds_read_b64_tr_b16 v[54:55], v225 offset:5280
    ds_read_b64_tr_b16 v[56:57], v230 offset:5152
    ds_read_b64_tr_b16 v[58:59], v230 offset:5312
    s_waitcnt lgkmcnt(10)
    v_mfma_f32_16x16x32_bf16 v[4:7], v[36:39], v[128:131], v[4:7]
    s_waitcnt lgkmcnt(8)
    v_mfma_f32_16x16x32_bf16 v[8:11], v[40:43], v[128:131], v[8:11]
    ds_read_b64_tr_b16 v[60:61], v225 offset:6400
    ds_read_b64_tr_b16 v[62:63], v225 offset:6560
    ds_read_b64_tr_b16 v[64:65], v230 offset:6432
    ds_read_b64_tr_b16 v[66:67], v230 offset:6592
    s_waitcnt lgkmcnt(10)
    v_mfma_f32_16x16x32_bf16 v[4:7], v[44:47], v[132:135], v[4:7]
    s_waitcnt lgkmcnt(8)
    v_mfma_f32_16x16x32_bf16 v[8:11], v[48:51], v[132:135], v[8:11]
    ds_read_b64_tr_b16 v[68:69], v225 offset:7680
    ds_read_b64_tr_b16 v[70:71], v225 offset:7840
    ds_read_b64_tr_b16 v[72:73], v230 offset:7712
    ds_read_b64_tr_b16 v[74:75], v230 offset:7872
    s_waitcnt lgkmcnt(10)
    v_mfma_f32_16x16x32_bf16 v[4:7], v[52:55], v[136:139], v[4:7]
    s_waitcnt lgkmcnt(8)
    v_mfma_f32_16x16x32_bf16 v[8:11], v[56:59], v[136:139], v[8:11]
    ds_read_b64_tr_b16 v[76:77], v225 offset:8960
    ds_read_b64_tr_b16 v[78:79], v225 offset:9120
    ds_read_b64_tr_b16 v[80:81], v230 offset:8992
    ds_read_b64_tr_b16 v[82:83], v230 offset:9152
    s_waitcnt lgkmcnt(10)
    v_mfma_f32_16x16x32_bf16 v[4:7], v[60:63], v[140:143], v[4:7]
    s_waitcnt lgkmcnt(8)
    v_mfma_f32_16x16x32_bf16 v[8:11], v[64:67], v[140:143], v[8:11]
    ds_read_b64_tr_b16 v[84:85], v225 offset:10240
    ds_read_b64_tr_b16 v[86:87], v225 offset:10400
    ds_read_b64_tr_b16 v[88:89], v230 offset:10272
    ds_read_b64_tr_b16 v[90:91], v230 offset:10432
    s_waitcnt lgkmcnt(10)
    v_mfma_f32_16x16x32_bf16 v[4:7], v[68:71], v[144:147], v[4:7]
    s_waitcnt lgkmcnt(8)
    v_mfma_f32_16x16x32_bf16 v[8:11], v[72:75], v[144:147], v[8:11]
    ds_read_b64_tr_b16 v[92:93], v225 offset:11520
    ds_read_b64_tr_b16 v[94:95], v225 offset:11680
    ds_read_b64_tr_b16 v[96:97], v230 offset:11552
    ds_read_b64_tr_b16 v[98:99], v230 offset:11712
    s_waitcnt lgkmcnt(10)
    v_mfma_f32_16x16x32_bf16 v[4:7], v[76:79], v[148:151], v[4:7]
    s_waitcnt lgkmcnt(8)
    v_mfma_f32_16x16x32_bf16 v[8:11], v[80:83], v[148:151], v[8:11]
    ds_read_b64_tr_b16 v[200:201], v225 offset:12800
    ds_read_b64_tr_b16 v[202:203], v225 offset:12960
    ds_read_b64_tr_b16 v[204:205], v230 offset:12832
    ds_read_b64_tr_b16 v[206:207], v230 offset:12992
    s_waitcnt lgkmcnt(10)
    v_mfma_f32_16x16x32_bf16 v[4:7], v[84:87], v[152:155], v[4:7]
    s_waitcnt lgkmcnt(8)
    v_mfma_f32_16x16x32_bf16 v[8:11], v[88:91], v[152:155], v[8:11]
    ds_read_b64_tr_b16 v[208:209], v225 offset:14080
    ds_read_b64_tr_b16 v[210:211], v225 offset:14240
    ds_read_b64_tr_b16 v[212:213], v230 offset:14112
    ds_read_b64_tr_b16 v[214:215], v230 offset:14272
    s_waitcnt lgkmcnt(10)
    v_mfma_f32_16x16x32_bf16 v[4:7], v[92:95], v[156:159], v[4:7]
    s_waitcnt lgkmcnt(8)
    v_mfma_f32_16x16x32_bf16 v[8:11], v[96:99], v[156:159], v[8:11]
    ds_read_b64_tr_b16 v[216:217], v225 offset:15360
    ds_read_b64_tr_b16 v[218:219], v225 offset:15520
    ds_read_b64_tr_b16 v[220:221], v230 offset:15392
    ds_read_b64_tr_b16 v[222:223], v230 offset:15552
    s_waitcnt lgkmcnt(10)
    v_mfma_f32_16x16x32_bf16 v[4:7], v[200:203], v[160:163], v[4:7]
    s_waitcnt lgkmcnt(8)
    v_mfma_f32_16x16x32_bf16 v[8:11], v[204:207], v[160:163], v[8:11]
    ds_read_b64_tr_b16 v[232:233], v225 offset:16640
    ds_read_b64_tr_b16 v[234:235], v225 offset:16800
    ds_read_b64_tr_b16 v[236:237], v230 offset:16672
    ds_read_b64_tr_b16 v[238:239], v230 offset:16832
    s_waitcnt lgkmcnt(10)
    v_mfma_f32_16x16x32_bf16 v[4:7], v[208:211], v[164:167], v[4:7]
    s_waitcnt lgkmcnt(8)
    v_mfma_f32_16x16x32_bf16 v[8:11], v[212:215], v[164:167], v[8:11]
    ds_read_b64_tr_b16 v[240:241], v225 offset:17920
    ds_read_b64_tr_b16 v[242:243], v225 offset:18080
    ds_read_b64_tr_b16 v[244:245], v230 offset:17952
    ds_read_b64_tr_b16 v[246:247], v230 offset:18112
    s_waitcnt lgkmcnt(10)
    v_mfma_f32_16x16x32_bf16 v[4:7], v[216:219], v[168:171], v[4:7]
    s_waitcnt lgkmcnt(8)
    v_mfma_f32_16x16x32_bf16 v[8:11], v[220:223], v[168:171], v[8:11]
    ds_read_b64_tr_b16 v[20:21], v225 offset:19200
    ds_read_b64_tr_b16 v[22:23], v225 offset:19360
    ds_read_b64_tr_b16 v[24:25], v230 offset:19232
    ds_read_b64_tr_b16 v[26:27], v230 offset:19392
    s_waitcnt lgkmcnt(10)
    v_mfma_f32_16x16x32_bf16 v[4:7], v[232:235], v[172:175], v[4:7]
    s_waitcnt lgkmcnt(8)
    v_mfma_f32_16x16x32_bf16 v[8:11], v[236:239], v[172:175], v[8:11]
    ds_read_b64_tr_b16 v[28:29], v225 offset:20480
    ds_read_b64_tr_b16 v[30:31], v225 offset:20640
    ds_read_b64_tr_b16 v[32:33], v230 offset:20512
    ds_read_b64_tr_b16 v[34:35], v230 offset:20672
    s_waitcnt lgkmcnt(10)
    v_mfma_f32_16x16x32_bf16 v[4:7], v[240:243], v[176:179], v[4:7]
    s_waitcnt lgkmcnt(8)
    v_mfma_f32_16x16x32_bf16 v[8:11], v[244:247], v[176:179], v[8:11]
    ds_read_b64_tr_b16 v[36:37], v225 offset:21760
    ds_read_b64_tr_b16 v[38:39], v225 offset:21920
    ds_read_b64_tr_b16 v[40:41], v230 offset:21792
    ds_read_b64_tr_b16 v[42:43], v230 offset:21952
    s_waitcnt lgkmcnt(10)
    v_mfma_f32_16x16x32_bf16 v[4:7], v[20:23], v[180:183], v[4:7]
    s_waitcnt lgkmcnt(8)
    v_mfma_f32_16x16x32_bf16 v[8:11], v[24:27], v[180:183], v[8:11]
    ds_read_b64_tr_b16 v[44:45], v225 offset:23040
    ds_read_b64_tr_b16 v[46:47], v225 offset:23200
    ds_read_b64_tr_b16 v[48:49], v230 offset:23072
    ds_read_b64_tr_b16 v[50:51], v230 offset:23232
    s_waitcnt lgkmcnt(10)
    v_mfma_f32_16x16x32_bf16 v[4:7], v[28:31], v[184:187], v[4:7]
    s_waitcnt lgkmcnt(8)
    v_mfma_f32_16x16x32_bf16 v[8:11], v[32:35], v[184:187], v[8:11]
    ds_read_b64_tr_b16 v[52:53], v225 offset:24320
    ds_read_b64_tr_b16 v[54:55], v225 offset:24480
    ds_read_b64_tr_b16 v[56:57], v230 offset:24352
    ds_read_b64_tr_b16 v[58:59], v230 offset:24512
    s_waitcnt lgkmcnt(10)
    v_mfma_f32_16x16x32_bf16 v[4:7], v[36:39], v[188:191], v[4:7]
    s_waitcnt lgkmcnt(8)
    v_mfma_f32_16x16x32_bf16 v[8:11], v[40:43], v[188:191], v[8:11]
    s_waitcnt lgkmcnt(6)
    v_mfma_f32_16x16x32_bf16 v[4:7], v[44:47], v[192:195], v[4:7]
    s_waitcnt lgkmcnt(4)
    v_mfma_f32_16x16x32_bf16 v[8:11], v[48:51], v[192:195], v[8:11]
    s_waitcnt lgkmcnt(2)
    v_mfma_f32_16x16x32_bf16 v[4:7], v[52:55], v[196:199], v[4:7]
    s_waitcnt lgkmcnt(0)
    v_mfma_f32_16x16x32_bf16 v[8:11], v[56:59], v[196:199], v[8:11]
    s_lshl_b32 s63, s57, 2
    s_add_u32 s63, s63, s56
    s_and_b32 s64, s63, 1
    s_lshr_b32 s63, s63, 1
    s_mul_i32 s63, s63, 3072
    s_add_u32 s63, s63, 65536
    v_and_b32 v1, 15, v0
    v_lshrrev_b32 v2, 4, v0
    s_lshl_b32 s64, s64, 4
    v_lshl_add_u32 v3, v2, 5, v1
    v_add_u32 v3, s64, v3
    v_lshlrev_b32 v240, 4, v3
    v_lshlrev_b32 v241, 3, v3
    s_mov_b32 s65, 0x3ea52b5c
    v_cmp_eq_u32 vcc, 0, v2
    v_mul_f32 v4, s65, v4
    v_mul_f32 v5, s65, v5
    v_mul_f32 v6, s65, v6
    v_mul_f32 v7, s65, v7
    v_mul_f32 v8, s65, v8
    v_mul_f32 v9, s65, v9
    v_mul_f32 v10, s65, v10
    v_mul_f32 v11, s65, v11
    v_mul_f32 v242, v8, v8
    v_fmac_f32 v242, v9, v9
    v_fmac_f32 v242, v10, v10
    v_fmac_f32 v242, v11, v11
    v_cndmask_b32 v242, 0, v242, vcc
    v_cvt_pk_bf16_f32 v232, v4, v5
    v_cvt_pk_bf16_f32 v233, v6, v7
    v_cvt_pk_bf16_f32 v236, v8, v9
    v_cvt_pk_bf16_f32 v237, v10, v11
    v_mov_b32 v234, v232
    v_mov_b32 v235, v233
    s_nop 0
    v_permlane32_swap_b32 v232, v234
    v_permlane32_swap_b32 v233, v235
    s_mov_b32 exec_hi, 0
    buffer_store_dwordx4 v[232:235], v240, s[28:31], s63 offen sc1
    s_mov_b32 exec_lo, 0xffff
    buffer_store_dwordx2 v[236:237], v241, s[28:31], s63 offen offset:1024 sc1
    s_mov_b64 exec, -1
    v_fmac_f32 v242, v4, v4
    v_fmac_f32 v242, v5, v5
    v_fmac_f32 v242, v6, v6
    v_fmac_f32 v242, v7, v7
    v_mov_b32 v243, v242
    s_nop 1
    v_permlane32_swap_b32 v242, v243
    v_add_f32 v242, v242, v243
    v_mov_b32 v243, v242
    s_nop 1
    v_permlane16_swap_b32 v242, v243
    v_add_f32 v242, v242, v243
    s_nop 1
    v_max_u32_dpp v242, v242, v242 row_shr:1 row_mask:0xf bank_mask:0xf
    s_nop 1
    v_max_u32_dpp v242, v242, v242 row_shr:2 row_mask:0xf bank_mask:0xf
    s_nop 1
    v_max_u32_dpp v242, v242, v242 row_shr:4 row_mask:0xf bank_mask:0xf
    s_nop 1
    v_max_u32_dpp v242, v242, v242 row_shr:8 row_mask:0xf bank_mask:0xf
    s_nop 0
    v_readlane_b32 s62, v242, 15
    s_branch L_kvdone
L_vproj:
    ds_read_b64_tr_b16 v[20:21], v225 offset:0
    ds_read_b64_tr_b16 v[22:23], v225 offset:160
    ds_read_b64_tr_b16 v[24:25], v230 offset:32
    ds_read_b64_tr_b16 v[26:27], v230 offset:192
    ds_read_b64_tr_b16 v[28:29], v225 offset:1280
    ds_read_b64_tr_b16 v[30:31], v225 offset:1440
    ds_read_b64_tr_b16 v[32:33], v230 offset:1312
    ds_read_b64_tr_b16 v[34:35], v230 offset:1472
    ds_read_b64_tr_b16 v[36:37], v225 offset:2560
    ds_read_b64_tr_b16 v[38:39], v225 offset:2720
    ds_read_b64_tr_b16 v[40:41], v230 offset:2592
    ds_read_b64_tr_b16 v[42:43], v230 offset:2752
    s_waitcnt lgkmcnt(10)
    v_mfma_f32_16x16x32_bf16 v[4:7], v[120:123], v[20:23], 0
    s_waitcnt lgkmcnt(8)
    v_mfma_f32_16x16x32_bf16 v[8:11], v[120:123], v[24:27], 0
    ds_read_b64_tr_b16 v[44:45], v225 offset:3840
    ds_read_b64_tr_b16 v[46:47], v225 offset:4000
    ds_read_b64_tr_b16 v[48:49], v230 offset:3872
    ds_read_b64_tr_b16 v[50:51], v230 offset:4032
    s_waitcnt lgkmcnt(10)
    v_mfma_f32_16x16x32_bf16 v[4:7], v[124:127], v[28:31], v[4:7]
    s_waitcnt lgkmcnt(8)
    v_mfma_f32_16x16x32_bf16 v[8:11], v[124:127], v[32:35], v[8:11]
    ds_read_b64_tr_b16 v[52:53], v225 offset:5120
    ds_read_b64_tr_b16 v[54:55], v225 offset:5280
    ds_read_b64_tr_b16 v[56:57], v230 offset:5152
    ds_read_b64_tr_b16 v[58:59], v230 offset:5312
    s_waitcnt lgkmcnt(10)
    v_mfma_f32_16x16x32_bf16 v[4:7], v[128:131], v[36:39], v[4:7]
    s_waitcnt lgkmcnt(8)
    v_mfma_f32_16x16x32_bf16 v[8:11], v[128:131], v[40:43], v[8:11]
    ds_read_b64_tr_b16 v[60:61], v225 offset:6400
    ds_read_b64_tr_b16 v[62:63], v225 offset:6560
    ds_read_b64_tr_b16 v[64:65], v230 offset:6432
    ds_read_b64_tr_b16 v[66:67], v230 offset:6592
    s_waitcnt lgkmcnt(10)
    v_mfma_f32_16x16x32_bf16 v[4:7], v[132:135], v[44:47], v[4:7]
    s_waitcnt lgkmcnt(8)
    v_mfma_f32_16x16x32_bf16 v[8:11], v[132:135], v[48:51], v[8:11]
    ds_read_b64_tr_b16 v[68:69], v225 offset:7680
    ds_read_b64_tr_b16 v[70:71], v225 offset:7840
    ds_read_b64_tr_b16 v[72:73], v230 offset:7712
    ds_read_b64_tr_b16 v[74:75], v230 offset:7872
    s_waitcnt lgkmcnt(10)
    v_mfma_f32_16x16x32_bf16 v[4:7], v[136:139], v[52:55], v[4:7]
    s_waitcnt lgkmcnt(8)
    v_mfma_f32_16x16x32_bf16 v[8:11], v[136:139], v[56:59], v[8:11]
    ds_read_b64_tr_b16 v[76:77], v225 offset:8960
    ds_read_b64_tr_b16 v[78:79], v225 offset:9120
    ds_read_b64_tr_b16 v[80:81], v230 offset:8992
    ds_read_b64_tr_b16 v[82:83], v230 offset:9152
    s_waitcnt lgkmcnt(10)
    v_mfma_f32_16x16x32_bf16 v[4:7], v[140:143], v[60:63], v[4:7]
    s_waitcnt lgkmcnt(8)
    v_mfma_f32_16x16x32_bf16 v[8:11], v[140:143], v[64:67], v[8:11]
    ds_read_b64_tr_b16 v[84:85], v225 offset:10240
    ds_read_b64_tr_b16 v[86:87], v225 offset:10400
    ds_read_b64_tr_b16 v[88:89], v230 offset:10272
    ds_read_b64_tr_b16 v[90:91], v230 offset:10432
    s_waitcnt lgkmcnt(10)
    v_mfma_f32_16x16x32_bf16 v[4:7], v[144:147], v[68:71], v[4:7]
    s_waitcnt lgkmcnt(8)
    v_mfma_f32_16x16x32_bf16 v[8:11], v[144:147], v[72:75], v[8:11]
    ds_read_b64_tr_b16 v[92:93], v225 offset:11520
    ds_read_b64_tr_b16 v[94:95], v225 offset:11680
    ds_read_b64_tr_b16 v[96:97], v230 offset:11552
    ds_read_b64_tr_b16 v[98:99], v230 offset:11712
    s_waitcnt lgkmcnt(10)
    v_mfma_f32_16x16x32_bf16 v[4:7], v[148:151], v[76:79], v[4:7]
    s_waitcnt lgkmcnt(8)
    v_mfma_f32_16x16x32_bf16 v[8:11], v[148:151], v[80:83], v[8:11]
    ds_read_b64_tr_b16 v[200:201], v225 offset:12800
    ds_read_b64_tr_b16 v[202:203], v225 offset:12960
    ds_read_b64_tr_b16 v[204:205], v230 offset:12832
    ds_read_b64_tr_b16 v[206:207], v230 offset:12992
    s_waitcnt lgkmcnt(10)
    v_mfma_f32_16x16x32_bf16 v[4:7], v[152:155], v[84:87], v[4:7]
    s_waitcnt lgkmcnt(8)
    v_mfma_f32_16x16x32_bf16 v[8:11], v[152:155], v[88:91], v[8:11]
    ds_read_b64_tr_b16 v[208:209], v225 offset:14080
    ds_read_b64_tr_b16 v[210:211], v225 offset:14240
    ds_read_b64_tr_b16 v[212:213], v230 offset:14112
    ds_read_b64_tr_b16 v[214:215], v230 offset:14272
    s_waitcnt lgkmcnt(10)
    v_mfma_f32_16x16x32_bf16 v[4:7], v[156:159], v[92:95], v[4:7]
    s_waitcnt lgkmcnt(8)
    v_mfma_f32_16x16x32_bf16 v[8:11], v[156:159], v[96:99], v[8:11]
    ds_read_b64_tr_b16 v[216:217], v225 offset:15360
    ds_read_b64_tr_b16 v[218:219], v225 offset:15520
    ds_read_b64_tr_b16 v[220:221], v230 offset:15392
    ds_read_b64_tr_b16 v[222:223], v230 offset:15552
    s_waitcnt lgkmcnt(10)
    v_mfma_f32_16x16x32_bf16 v[4:7], v[160:163], v[200:203], v[4:7]
    s_waitcnt lgkmcnt(8)
    v_mfma_f32_16x16x32_bf16 v[8:11], v[160:163], v[204:207], v[8:11]
    ds_read_b64_tr_b16 v[232:233], v225 offset:16640
    ds_read_b64_tr_b16 v[234:235], v225 offset:16800
    ds_read_b64_tr_b16 v[236:237], v230 offset:16672
    ds_read_b64_tr_b16 v[238:239], v230 offset:16832
    s_waitcnt lgkmcnt(10)
    v_mfma_f32_16x16x32_bf16 v[4:7], v[164:167], v[208:211], v[4:7]
    s_waitcnt lgkmcnt(8)
    v_mfma_f32_16x16x32_bf16 v[8:11], v[164:167], v[212:215], v[8:11]
    ds_read_b64_tr_b16 v[240:241], v225 offset:17920
    ds_read_b64_tr_b16 v[242:243], v225 offset:18080
    ds_read_b64_tr_b16 v[244:245], v230 offset:17952
    ds_read_b64_tr_b16 v[246:247], v230 offset:18112
    s_waitcnt lgkmcnt(10)
    v_mfma_f32_16x16x32_bf16 v[4:7], v[168:171], v[216:219], v[4:7]
    s_waitcnt lgkmcnt(8)
    v_mfma_f32_16x16x32_bf16 v[8:11], v[168:171], v[220:223], v[8:11]
    ds_read_b64_tr_b16 v[20:21], v225 offset:19200
    ds_read_b64_tr_b16 v[22:23], v225 offset:19360
    ds_read_b64_tr_b16 v[24:25], v230 offset:19232
    ds_read_b64_tr_b16 v[26:27], v230 offset:19392
    s_waitcnt lgkmcnt(10)
    v_mfma_f32_16x16x32_bf16 v[4:7], v[172:175], v[232:235], v[4:7]
    s_waitcnt lgkmcnt(8)
    v_mfma_f32_16x16x32_bf16 v[8:11], v[172:175], v[236:239], v[8:11]
    ds_read_b64_tr_b16 v[28:29], v225 offset:20480
    ds_read_b64_tr_b16 v[30:31], v225 offset:20640
    ds_read_b64_tr_b16 v[32:33], v230 offset:20512
    ds_read_b64_tr_b16 v[34:35], v230 offset:20672
    s_waitcnt lgkmcnt(10)
    v_mfma_f32_16x16x32_bf16 v[4:7], v[176:179], v[240:243], v[4:7]
    s_waitcnt lgkmcnt(8)
    v_mfma_f32_16x16x32_bf16 v[8:11], v[176:179], v[244:247], v[8:11]
    ds_read_b64_tr_b16 v[36:37], v225 offset:21760
    ds_read_b64_tr_b16 v[38:39], v225 offset:21920
    ds_read_b64_tr_b16 v[40:41], v230 offset:21792
    ds_read_b64_tr_b16 v[42:43], v230 offset:21952
    s_waitcnt lgkmcnt(10)
    v_mfma_f32_16x16x32_bf16 v[4:7], v[180:183], v[20:23], v[4:7]
    s_waitcnt lgkmcnt(8)
    v_mfma_f32_16x16x32_bf16 v[8:11], v[180:183], v[24:27], v[8:11]
    ds_read_b64_tr_b16 v[44:45], v225 offset:23040
    ds_read_b64_tr_b16 v[46:47], v225 offset:23200
    ds_read_b64_tr_b16 v[48:49], v230 offset:23072
    ds_read_b64_tr_b16 v[50:51], v230 offset:23232
    s_waitcnt lgkmcnt(10)
    v_mfma_f32_16x16x32_bf16 v[4:7], v[184:187], v[28:31], v[4:7]
    s_waitcnt lgkmcnt(8)
    v_mfma_f32_16x16x32_bf16 v[8:11], v[184:187], v[32:35], v[8:11]
    ds_read_b64_tr_b16 v[52:53], v225 offset:24320
    ds_read_b64_tr_b16 v[54:55], v225 offset:24480
    ds_read_b64_tr_b16 v[56:57], v230 offset:24352
    ds_read_b64_tr_b16 v[58:59], v230 offset:24512
    s_waitcnt lgkmcnt(10)
    v_mfma_f32_16x16x32_bf16 v[4:7], v[188:191], v[36:39], v[4:7]
    s_waitcnt lgkmcnt(8)
    v_mfma_f32_16x16x32_bf16 v[8:11], v[188:191], v[40:43], v[8:11]
    s_waitcnt lgkmcnt(6)
    v_mfma_f32_16x16x32_bf16 v[4:7], v[192:195], v[44:47], v[4:7]
    s_waitcnt lgkmcnt(4)
    v_mfma_f32_16x16x32_bf16 v[8:11], v[192:195], v[48:51], v[8:11]
    s_waitcnt lgkmcnt(2)
    v_mfma_f32_16x16x32_bf16 v[4:7], v[196:199], v[52:55], v[4:7]
    s_waitcnt lgkmcnt(0)
    v_mfma_f32_16x16x32_bf16 v[8:11], v[196:199], v[56:59], v[8:11]
    s_lshl_b32 s63, s57, 2
    s_add_u32 s63, s63, s56
    s_and_b32 s64, s63, 1
    s_lshr_b32 s63, s63, 1
    s_mul_i32 s63, s63, 3072
    s_add_u32 s63, s63, 65536
    v_and_b32 v1, 15, v0
    v_lshrrev_b32 v2, 4, v0
    s_mul_i32 s64, s64, 704
    s_add_u32 s63, s63, s64
    v_cmp_gt_u32 s[76:77], 4, v1
    v_cmp_eq_u32 vcc, 4, v1
    v_and_b32 v3, 1, v2
    v_lshl_add_u32 v3, v3, 4, v1
    v_lshlrev_b32 v3, 4, v3
    v_lshrrev_b32 v2, 1, v2
    v_mul_u32_u24 v2, 352, v2
    v_add_u32 v240, v3, v2
    v_cvt_pk_bf16_f32 v232, v4, v5
    v_cvt_pk_bf16_f32 v233, v6, v7
    v_cvt_pk_bf16_f32 v234, v8, v9
    v_cvt_pk_bf16_f32 v235, v10, v11
    v_mov_b32 v238, 0x3f803f80
    v_cndmask_b32 v238, 0, v238, vcc
    v_cndmask_b32 v234, v238, v234, s[76:77]
    v_cndmask_b32 v235, v238, v235, s[76:77]
    s_mov_b32 s62, 0
    v_permlane16_swap_b32 v232, v234
    v_permlane16_swap_b32 v233, v235
    s_mov_b32 exec_lo, 0x003fffff
    s_mov_b32 exec_hi, 0x003fffff
    buffer_store_dwordx4 v[232:235], v240, s[28:31], s63 offen offset:1536 sc1
    s_mov_b64 exec, -1
L_kvdone:
    v_mov_b32 v1, 60416
    v_mov_b32 v2, 1
    s_mov_b64 exec, 1
    ds_add_u32 v1, v2 offset:28
    s_mov_b64 exec, -1
    v_and_b32 v1, 31, v0
    v_lshrrev_b32 v2, 5, v0
    v_mov_b32 v26, 0xdddddddd
    v_add_u32 v27, 0, v14
    v_lshlrev_b32 v102, 3, v1
    v_add_u32 v102, 1024, v102
    v_min_u32 v1, 21, v1
    v_mul_u32_u24 v2, 352, v2
    v_lshl_add_u32 v1, v1, 4, v2
    v_add_u32 v103, 1536, v1
    s_lshl_b32 s63, s56, 6
    s_mov_b32 s72, 52429
    s_mov_b32 s73, 1120
    v_add_u32 v232, s63, v0
    v_mul_u32_u24 v233, s72, v232
    v_lshlrev_b32 v234, 4, v232
    v_lshrrev_b32 v233, 19, v233
    v_add_u32 v232, 512, v232
    v_mad_u32_u24 v240, v233, s73, v234
    v_mul_u32_u24 v233, s72, v232
    v_lshlrev_b32 v234, 4, v232
    v_lshrrev_b32 v233, 19, v233
    v_add_u32 v232, 512, v232
    v_mad_u32_u24 v241, v233, s73, v234
    v_mul_u32_u24 v233, s72, v232
    v_lshlrev_b32 v234, 4, v232
    v_lshrrev_b32 v233, 19, v233
    v_add_u32 v232, 512, v232
    v_mad_u32_u24 v242, v233, s73, v234
    v_mul_u32_u24 v233, s72, v232
    v_lshlrev_b32 v234, 4, v232
    v_lshrrev_b32 v233, 19, v233
    v_add_u32 v232, 512, v232
    v_mad_u32_u24 v243, v233, s73, v234
    v_mul_u32_u24 v233, s72, v232
    v_lshlrev_b32 v234, 4, v232
    v_lshrrev_b32 v233, 19, v233
    v_add_u32 v232, 512, v232
    v_mad_u32_u24 v244, v233, s73, v234
    s_and_b32 s63, s56, 3
    s_mul_i32 s63, s63, 40
    s_add_u32 s63, s63, 61440
    v_and_b32 v1, 31, v0
    v_lshrrev_b32 v2, 5, v0
    v_mul_u32_u24 v3, 168, v1
    v_mul_u32_u24 v1, 168, v0
    v_lshl_add_u32 v3, v2, 3, v3
    v_add_u32 v245, s63, v3
    v_add_u32 v246, s63, v1
    v_mov_b32 v247, 60416
    s_lshl_b32 s63, s57, 2
    s_add_u32 s63, s63, s56
    s_lshl_b32 s63, s63, 1
    s_add_u32 s63, s63, s58
    s_sub_u32 s63, s63, 5
    s_mul_i32 s63, s63, 128
    s_add_u32 s63, s63, 4096
    v_mov_b32 v2, s61
    v_mov_b32 v3, s62
    v_mov_b32 v1, 0
    s_waitcnt vmcnt(0)
    s_mov_b64 exec, 1
    buffer_store_dwordx2 v[2:3], v1, s[28:31], s63 offen sc1
    s_mov_b64 exec, -1
    s_setprio 0
    s_branch L_frontA_q0
L_frontA_plain:
    s_waitcnt vmcnt(0)
    v_readfirstlane_b32 s61, v101
    ds_read_b128 v[120:123], v228 offset:0
    ds_read_b128 v[124:127], v229 offset:0
    ds_read_b128 v[128:131], v228 offset:2048
    ds_read_b128 v[132:135], v229 offset:2048
    ds_read_b128 v[136:139], v228 offset:4096
    ds_read_b128 v[140:143], v229 offset:4096
    ds_read_b128 v[144:147], v228 offset:6144
    ds_read_b128 v[148:151], v229 offset:6144
    ds_read_b128 v[152:155], v228 offset:8192
    ds_read_b128 v[156:159], v229 offset:8192
    ds_read_b128 v[160:163], v228 offset:10240
    ds_read_b128 v[164:167], v229 offset:10240
    ds_read_b128 v[168:171], v228 offset:12288
    ds_read_b128 v[172:175], v229 offset:12288
    ds_read_b128 v[176:179], v228 offset:14336
    ds_read_b128 v[180:183], v229 offset:14336
    ds_read_b128 v[184:187], v228 offset:16384
    ds_read_b128 v[188:191], v229 offset:16384
    ds_read_b128 v[192:195], v228 offset:18432
    ds_read_b128 v[196:199], v229 offset:18432
    v_mov_b32 v1, 60416
    v_mov_b32 v2, 1
    s_mov_b64 exec, 1
    ds_add_u32 v1, v2 offset:24
    s_mov_b64 exec, -1
    s_add_u32 s61, s61, 0x9e3779b9
    v_and_b32 v1, 31, v0
    v_lshrrev_b32 v2, 5, v0
    v_mov_b32 v26, 0xdddddddd
    v_add_u32 v27, 0, v14
    v_lshlrev_b32 v102, 3, v1
    v_add_u32 v102, 1024, v102
    v_min_u32 v1, 21, v1
    v_mul_u32_u24 v2, 352, v2
    v_lshl_add_u32 v1, v1, 4, v2
    v_add_u32 v103, 1536, v1
    s_lshl_b32 s63, s56, 6
    s_mov_b32 s72, 52429
    s_mov_b32 s73, 1120
    v_add_u32 v232, s63, v0
    v_mul_u32_u24 v233, s72, v232
    v_lshlrev_b32 v234, 4, v232
    v_lshrrev_b32 v233, 19, v233
    v_add_u32 v232, 512, v232
    v_mad_u32_u24 v240, v233, s73, v234
    v_mul_u32_u24 v233, s72, v232
    v_lshlrev_b32 v234, 4, v232
    v_lshrrev_b32 v233, 19, v233
    v_add_u32 v232, 512, v232
    v_mad_u32_u24 v241, v233, s73, v234
    v_mul_u32_u24 v233, s72, v232
    v_lshlrev_b32 v234, 4, v232
    v_lshrrev_b32 v233, 19, v233
    v_add_u32 v232, 512, v232
    v_mad_u32_u24 v242, v233, s73, v234
    v_mul_u32_u24 v233, s72, v232
    v_lshlrev_b32 v234, 4, v232
    v_lshrrev_b32 v233, 19, v233
    v_add_u32 v232, 512, v232
    v_mad_u32_u24 v243, v233, s73, v234
    v_mul_u32_u24 v233, s72, v232
    v_lshlrev_b32 v234, 4, v232
    v_lshrrev_b32 v233, 19, v233
    v_add_u32 v232, 512, v232
    v_mad_u32_u24 v244, v233, s73, v234
    s_and_b32 s63, s56, 3
    s_mul_i32 s63, s63, 40
    s_add_u32 s63, s63, 61440
    v_and_b32 v1, 31, v0
    v_lshrrev_b32 v2, 5, v0
    v_mul_u32_u24 v3, 168, v1
    v_mul_u32_u24 v1, 168, v0
    v_lshl_add_u32 v3, v2, 3, v3
    v_add_u32 v245, s63, v3
    v_add_u32 v246, s63, v1
    v_mov_b32 v247, 60416
L_frontA_q0:
    v_mov_b32 v1, 60416
    s_mov_b32 s69, 200000
L_lw_13:
    ds_read_b32 v2, v1 offset:12
    s_sub_u32 s69, s69, 1
    s_waitcnt lgkmcnt(0)
    v_readfirstlane_b32 s65, v2
    s_cmp_ge_u32 s65, 4
    s_cbranch_scc1 L_lg_14
    s_sleep 1
    s_cmp_lg_u32 s69, 0
    s_cbranch_scc1 L_lw_13
L_lg_14:
    ds_read_b64_tr_b16 v[200:201], v226 offset:0
    ds_read_b64_tr_b16 v[202:203], v226 offset:1280
    ds_read_b64_tr_b16 v[204:205], v226 offset:32
    ds_read_b64_tr_b16 v[206:207], v226 offset:1312
    ds_read_b64_tr_b16 v[208:209], v226 offset:64
    ds_read_b64_tr_b16 v[210:211], v226 offset:1344
    ds_read_b64_tr_b16 v[212:213], v226 offset:96
    ds_read_b64_tr_b16 v[214:215], v226 offset:1376
    ds_read_b64_tr_b16 v[216:217], v226 offset:128
    ds_read_b64_tr_b16 v[218:219], v226 offset:1408
    s_waitcnt lgkmcnt(8)
    v_mfma_f32_16x16x32_bf16 v[36:39], v[200:203], v[120:123], 0
    ds_read_b64_tr_b16 v[200:201], v226 offset:5120
    ds_read_b64_tr_b16 v[202:203], v226 offset:6400
    s_waitcnt lgkmcnt(8)
    v_mfma_f32_16x16x32_bf16 v[40:43], v[204:207], v[120:123], 0
    ds_read_b64_tr_b16 v[204:205], v226 offset:5152
    ds_read_b64_tr_b16 v[206:207], v226 offset:6432
    s_waitcnt lgkmcnt(8)
    v_mfma_f32_16x16x32_bf16 v[44:47], v[208:211], v[120:123], 0
    ds_read_b64_tr_b16 v[208:209], v226 offset:5184
    ds_read_b64_tr_b16 v[210:211], v226 offset:6464
    s_waitcnt lgkmcnt(8)
    v_mfma_f32_16x16x32_bf16 v[48:51], v[212:215], v[120:123], 0
    ds_read_b64_tr_b16 v[212:213], v226 offset:5216
    ds_read_b64_tr_b16 v[214:215], v226 offset:6496
    s_waitcnt lgkmcnt(8)
    v_mfma_f32_16x16x32_bf16 v[52:55], v[216:219], v[120:123], 0
    ds_read_b64_tr_b16 v[216:217], v226 offset:5248
    ds_read_b64_tr_b16 v[218:219], v226 offset:6528
    s_waitcnt lgkmcnt(8)
    v_mfma_f32_16x16x32_bf16 v[36:39], v[200:203], v[124:127], v[36:39]
    ds_read_b64_tr_b16 v[200:201], v226 offset:10240
    ds_read_b64_tr_b16 v[202:203], v226 offset:11520
    s_waitcnt lgkmcnt(8)
    v_mfma_f32_16x16x32_bf16 v[40:43], v[204:207], v[124:127], v[40:43]
    ds_read_b64_tr_b16 v[204:205], v226 offset:10272
    ds_read_b64_tr_b16 v[206:207], v226 offset:11552
    s_waitcnt lgkmcnt(8)
    v_mfma_f32_16x16x32_bf16 v[44:47], v[208:211], v[124:127], v[44:47]
    ds_read_b64_tr_b16 v[208:209], v226 offset:10304
    ds_read_b64_tr_b16 v[210:211], v226 offset:11584
    s_waitcnt lgkmcnt(8)
    v_mfma_f32_16x16x32_bf16 v[48:51], v[212:215], v[124:127], v[48:51]
    ds_read_b64_tr_b16 v[212:213], v226 offset:10336
    ds_read_b64_tr_b16 v[214:215], v226 offset:11616
    s_waitcnt lgkmcnt(8)
    v_mfma_f32_16x16x32_bf16 v[52:55], v[216:219], v[124:127], v[52:55]
    ds_read_b64_tr_b16 v[216:217], v226 offset:10368
    ds_read_b64_tr_b16 v[218:219], v226 offset:11648
    s_waitcnt lgkmcnt(8)
    v_mfma_f32_16x16x32_bf16 v[36:39], v[200:203], v[128:131], v[36:39]
    ds_read_b64_tr_b16 v[200:201], v226 offset:15360
    ds_read_b64_tr_b16 v[202:203], v226 offset:16640
    s_waitcnt lgkmcnt(8)
    v_mfma_f32_16x16x32_bf16 v[40:43], v[204:207], v[128:131], v[40:43]
    ds_read_b64_tr_b16 v[204:205], v226 offset:15392
    ds_read_b64_tr_b16 v[206:207], v226 offset:16672
    s_waitcnt lgkmcnt(8)
    v_mfma_f32_16x16x32_bf16 v[44:47], v[208:211], v[128:131], v[44:47]
    ds_read_b64_tr_b16 v[208:209], v226 offset:15424
    ds_read_b64_tr_b16 v[210:211], v226 offset:16704
    s_waitcnt lgkmcnt(8)
    v_mfma_f32_16x16x32_bf16 v[48:51], v[212:215], v[128:131], v[48:51]
    ds_read_b64_tr_b16 v[212:213], v226 offset:15456
    ds_read_b64_tr_b16 v[214:215], v226 offset:16736
    s_waitcnt lgkmcnt(8)
    v_mfma_f32_16x16x32_bf16 v[52:55], v[216:219], v[128:131], v[52:55]
    ds_read_b64_tr_b16 v[216:217], v226 offset:15488
    ds_read_b64_tr_b16 v[218:219], v226 offset:16768
    s_waitcnt lgkmcnt(8)
    v_mfma_f32_16x16x32_bf16 v[36:39], v[200:203], v[132:135], v[36:39]
    s_waitcnt lgkmcnt(6)
    v_mfma_f32_16x16x32_bf16 v[40:43], v[204:207], v[132:135], v[40:43]
    s_waitcnt lgkmcnt(4)
    v_mfma_f32_16x16x32_bf16 v[44:47], v[208:211], v[132:135], v[44:47]
    s_waitcnt lgkmcnt(2)
    v_mfma_f32_16x16x32_bf16 v[48:51], v[212:215], v[132:135], v[48:51]
    s_waitcnt lgkmcnt(0)
    v_mfma_f32_16x16x32_bf16 v[52:55], v[216:219], v[132:135], v[52:55]
    v_mov_b32 v1, 60416
    v_mov_b32 v2, 1
    s_mov_b64 exec, 1
    ds_add_u32 v1, v2 offset:16
    s_mov_b64 exec, -1
    v_mov_b32 v1, 60416
    s_mov_b32 s69, 200000
L_lw_15:
    ds_read_b32 v2, v1 offset:16
    s_sub_u32 s69, s69, 1
    s_waitcnt lgkmcnt(0)
    v_readfirstlane_b32 s65, v2
    s_cmp_ge_u32 s65, 8
    s_cbranch_scc1 L_lg_16
    s_sleep 1
    s_cmp_lg_u32 s69, 0
    s_cbranch_scc1 L_lw_15
L_lg_16:
L_frontA_join:
    ds_read_b64_tr_b16 v[200:201], v226 offset:20480
    ds_read_b64_tr_b16 v[202:203], v226 offset:21760
    ds_read_b64_tr_b16 v[204:205], v226 offset:20512
    ds_read_b64_tr_b16 v[206:207], v226 offset:21792
    ds_read_b64_tr_b16 v[208:209], v226 offset:20544
    ds_read_b64_tr_b16 v[210:211], v226 offset:21824
    ds_read_b64_tr_b16 v[212:213], v226 offset:20576
    ds_read_b64_tr_b16 v[214:215], v226 offset:21856
    ds_read_b64_tr_b16 v[216:217], v226 offset:20608
    ds_read_b64_tr_b16 v[218:219], v226 offset:21888
    s_waitcnt lgkmcnt(8)
    v_mfma_f32_16x16x32_bf16 v[36:39], v[200:203], v[136:139], v[36:39]
    ds_read_b64_tr_b16 v[200:201], v226 offset:25600
    ds_read_b64_tr_b16 v[202:203], v226 offset:26880
    s_waitcnt lgkmcnt(8)
    v_mfma_f32_16x16x32_bf16 v[40:43], v[204:207], v[136:139], v[40:43]
    ds_read_b64_tr_b16 v[204:205], v226 offset:25632
    ds_read_b64_tr_b16 v[206:207], v226 offset:26912
    s_waitcnt lgkmcnt(8)
    v_mfma_f32_16x16x32_bf16 v[44:47], v[208:211], v[136:139], v[44:47]
    ds_read_b64_tr_b16 v[208:209], v226 offset:25664
    ds_read_b64_tr_b16 v[210:211], v226 offset:26944
    s_waitcnt lgkmcnt(8)
    v_mfma_f32_16x16x32_bf16 v[48:51], v[212:215], v[136:139], v[48:51]
    ds_read_b64_tr_b16 v[212:213], v226 offset:25696
    ds_read_b64_tr_b16 v[214:215], v226 offset:26976
    s_waitcnt lgkmcnt(8)
    v_mfma_f32_16x16x32_bf16 v[52:55], v[216:219], v[136:139], v[52:55]
    ds_read_b64_tr_b16 v[216:217], v226 offset:25728
    ds_read_b64_tr_b16 v[218:219], v226 offset:27008
    s_waitcnt lgkmcnt(8)
    v_mfma_f32_16x16x32_bf16 v[36:39], v[200:203], v[140:143], v[36:39]
    ds_read_b64_tr_b16 v[200:201], v226 offset:30720
    ds_read_b64_tr_b16 v[202:203], v226 offset:32000
    s_waitcnt lgkmcnt(8)
    v_mfma_f32_16x16x32_bf16 v[40:43], v[204:207], v[140:143], v[40:43]
    ds_read_b64_tr_b16 v[204:205], v226 offset:30752
    ds_read_b64_tr_b16 v[206:207], v226 offset:32032
    s_waitcnt lgkmcnt(8)
    v_mfma_f32_16x16x32_bf16 v[44:47], v[208:211], v[140:143], v[44:47]
    ds_read_b64_tr_b16 v[208:209], v226 offset:30784
    ds_read_b64_tr_b16 v[210:211], v226 offset:32064
    s_waitcnt lgkmcnt(8)
    v_mfma_f32_16x16x32_bf16 v[48:51], v[212:215], v[140:143], v[48:51]
    ds_read_b64_tr_b16 v[212:213], v226 offset:30816
    ds_read_b64_tr_b16 v[214:215], v226 offset:32096
    s_waitcnt lgkmcnt(8)
    v_mfma_f32_16x16x32_bf16 v[52:55], v[216:219], v[140:143], v[52:55]
    ds_read_b64_tr_b16 v[216:217], v226 offset:30848
    ds_read_b64_tr_b16 v[218:219], v226 offset:32128
    s_waitcnt lgkmcnt(8)
    v_mfma_f32_16x16x32_bf16 v[36:39], v[200:203], v[144:147], v[36:39]
    ds_read_b64_tr_b16 v[200:201], v226 offset:35840
    ds_read_b64_tr_b16 v[202:203], v226 offset:37120
    s_waitcnt lgkmcnt(8)
    v_mfma_f32_16x16x32_bf16 v[40:43], v[204:207], v[144:147], v[40:43]
    ds_read_b64_tr_b16 v[204:205], v226 offset:35872
    ds_read_b64_tr_b16 v[206:207], v226 offset:37152
    s_waitcnt lgkmcnt(8)
    v_mfma_f32_16x16x32_bf16 v[44:47], v[208:211], v[144:147], v[44:47]
    ds_read_b64_tr_b16 v[208:209], v226 offset:35904
    ds_read_b64_tr_b16 v[210:211], v226 offset:37184
    s_waitcnt lgkmcnt(8)
    v_mfma_f32_16x16x32_bf16 v[48:51], v[212:215], v[144:147], v[48:51]
    ds_read_b64_tr_b16 v[212:213], v226 offset:35936
    ds_read_b64_tr_b16 v[214:215], v226 offset:37216
    s_waitcnt lgkmcnt(8)
    v_mfma_f32_16x16x32_bf16 v[52:55], v[216:219], v[144:147], v[52:55]
    ds_read_b64_tr_b16 v[216:217], v226 offset:35968
    ds_read_b64_tr_b16 v[218:219], v226 offset:37248
    s_waitcnt lgkmcnt(8)
    v_mfma_f32_16x16x32_bf16 v[36:39], v[200:203], v[148:151], v[36:39]
    ds_read_b64_tr_b16 v[200:201], v226 offset:40960
    ds_read_b64_tr_b16 v[202:203], v226 offset:42240
    s_waitcnt lgkmcnt(8)
    v_mfma_f32_16x16x32_bf16 v[40:43], v[204:207], v[148:151], v[40:43]
    ds_read_b64_tr_b16 v[204:205], v226 offset:40992
    ds_read_b64_tr_b16 v[206:207], v226 offset:42272
    s_waitcnt lgkmcnt(8)
    v_mfma_f32_16x16x32_bf16 v[44:47], v[208:211], v[148:151], v[44:47]
    ds_read_b64_tr_b16 v[208:209], v226 offset:41024
    ds_read_b64_tr_b16 v[210:211], v226 offset:42304
    s_waitcnt lgkmcnt(8)
    v_mfma_f32_16x16x32_bf16 v[48:51], v[212:215], v[148:151], v[48:51]
    ds_read_b64_tr_b16 v[212:213], v226 offset:41056
    ds_read_b64_tr_b16 v[214:215], v226 offset:42336
    s_waitcnt lgkmcnt(8)
    v_mfma_f32_16x16x32_bf16 v[52:55], v[216:219], v[148:151], v[52:55]
    ds_read_b64_tr_b16 v[216:217], v226 offset:41088
    ds_read_b64_tr_b16 v[218:219], v226 offset:42368
    s_waitcnt lgkmcnt(8)
    v_mfma_f32_16x16x32_bf16 v[36:39], v[200:203], v[152:155], v[36:39]
    ds_read_b64_tr_b16 v[200:201], v226 offset:46080
    ds_read_b64_tr_b16 v[202:203], v226 offset:47360
    s_waitcnt lgkmcnt(8)
    v_mfma_f32_16x16x32_bf16 v[40:43], v[204:207], v[152:155], v[40:43]
    ds_read_b64_tr_b16 v[204:205], v226 offset:46112
    ds_read_b64_tr_b16 v[206:207], v226 offset:47392
    s_waitcnt lgkmcnt(8)
    v_mfma_f32_16x16x32_bf16 v[44:47], v[208:211], v[152:155], v[44:47]
    ds_read_b64_tr_b16 v[208:209], v226 offset:46144
    ds_read_b64_tr_b16 v[210:211], v226 offset:47424
    s_waitcnt lgkmcnt(8)
    v_mfma_f32_16x16x32_bf16 v[48:51], v[212:215], v[152:155], v[48:51]
    ds_read_b64_tr_b16 v[212:213], v226 offset:46176
    ds_read_b64_tr_b16 v[214:215], v226 offset:47456
    s_waitcnt lgkmcnt(8)
    v_mfma_f32_16x16x32_bf16 v[52:55], v[216:219], v[152:155], v[52:55]
    ds_read_b64_tr_b16 v[216:217], v226 offset:46208
    ds_read_b64_tr_b16 v[218:219], v226 offset:47488
    s_waitcnt lgkmcnt(8)
    v_mfma_f32_16x16x32_bf16 v[36:39], v[200:203], v[156:159], v[36:39]
    ds_read_b64_tr_b16 v[200:201], v226 offset:51200
    ds_read_b64_tr_b16 v[202:203], v226 offset:52480
    s_waitcnt lgkmcnt(8)
    v_mfma_f32_16x16x32_bf16 v[40:43], v[204:207], v[156:159], v[40:43]
    ds_read_b64_tr_b16 v[204:205], v226 offset:51232
    ds_read_b64_tr_b16 v[206:207], v226 offset:52512
    s_waitcnt lgkmcnt(8)
    v_mfma_f32_16x16x32_bf16 v[44:47], v[208:211], v[156:159], v[44:47]
    ds_read_b64_tr_b16 v[208:209], v226 offset:51264
    ds_read_b64_tr_b16 v[210:211], v226 offset:52544
    s_waitcnt lgkmcnt(8)
    v_mfma_f32_16x16x32_bf16 v[48:51], v[212:215], v[156:159], v[48:51]
    ds_read_b64_tr_b16 v[212:213], v226 offset:51296
    ds_read_b64_tr_b16 v[214:215], v226 offset:52576
    s_waitcnt lgkmcnt(8)
    v_mfma_f32_16x16x32_bf16 v[52:55], v[216:219], v[156:159], v[52:55]
    ds_read_b64_tr_b16 v[216:217], v226 offset:51328
    ds_read_b64_tr_b16 v[218:219], v226 offset:52608
    s_waitcnt lgkmcnt(8)
    v_mfma_f32_16x16x32_bf16 v[36:39], v[200:203], v[160:163], v[36:39]
    ds_read_b64_tr_b16 v[200:201], v226 offset:56320
    ds_read_b64_tr_b16 v[202:203], v226 offset:57600
    s_waitcnt lgkmcnt(8)
    v_mfma_f32_16x16x32_bf16 v[40:43], v[204:207], v[160:163], v[40:43]
    ds_read_b64_tr_b16 v[204:205], v226 offset:56352
    ds_read_b64_tr_b16 v[206:207], v226 offset:57632
    s_waitcnt lgkmcnt(8)
    v_mfma_f32_16x16x32_bf16 v[44:47], v[208:211], v[160:163], v[44:47]
    ds_read_b64_tr_b16 v[208:209], v226 offset:56384
    ds_read_b64_tr_b16 v[210:211], v226 offset:57664
    s_waitcnt lgkmcnt(8)
    v_mfma_f32_16x16x32_bf16 v[48:51], v[212:215], v[160:163], v[48:51]
    ds_read_b64_tr_b16 v[212:213], v226 offset:56416
    ds_read_b64_tr_b16 v[214:215], v226 offset:57696
    s_waitcnt lgkmcnt(8)
    v_mfma_f32_16x16x32_bf16 v[52:55], v[216:219], v[160:163], v[52:55]
    ds_read_b64_tr_b16 v[216:217], v226 offset:56448
    ds_read_b64_tr_b16 v[218:219], v226 offset:57728
    s_waitcnt lgkmcnt(8)
    v_mfma_f32_16x16x32_bf16 v[36:39], v[200:203], v[164:167], v[36:39]
    ds_read_b64_tr_b16 v[200:201], v227 offset:0
    ds_read_b64_tr_b16 v[202:203], v227 offset:1280
    s_waitcnt lgkmcnt(8)
    v_mfma_f32_16x16x32_bf16 v[40:43], v[204:207], v[164:167], v[40:43]
    ds_read_b64_tr_b16 v[204:205], v227 offset:32
    ds_read_b64_tr_b16 v[206:207], v227 offset:1312
    s_waitcnt lgkmcnt(8)
    v_mfma_f32_16x16x32_bf16 v[44:47], v[208:211], v[164:167], v[44:47]
    ds_read_b64_tr_b16 v[208:209], v227 offset:64
    ds_read_b64_tr_b16 v[210:211], v227 offset:1344
    s_waitcnt lgkmcnt(8)
    v_mfma_f32_16x16x32_bf16 v[48:51], v[212:215], v[164:167], v[48:51]
    ds_read_b64_tr_b16 v[212:213], v227 offset:96
    ds_read_b64_tr_b16 v[214:215], v227 offset:1376
    s_waitcnt lgkmcnt(8)
    v_mfma_f32_16x16x32_bf16 v[52:55], v[216:219], v[164:167], v[52:55]
    ds_read_b64_tr_b16 v[216:217], v227 offset:128
    ds_read_b64_tr_b16 v[218:219], v227 offset:1408
    s_waitcnt lgkmcnt(8)
    v_mfma_f32_16x16x32_bf16 v[36:39], v[200:203], v[168:171], v[36:39]
    ds_read_b64_tr_b16 v[200:201], v227 offset:5120
    ds_read_b64_tr_b16 v[202:203], v227 offset:6400
    s_waitcnt lgkmcnt(8)
    v_mfma_f32_16x16x32_bf16 v[40:43], v[204:207], v[168:171], v[40:43]
    ds_read_b64_tr_b16 v[204:205], v227 offset:5152
    ds_read_b64_tr_b16 v[206:207], v227 offset:6432
    s_waitcnt lgkmcnt(8)
    v_mfma_f32_16x16x32_bf16 v[44:47], v[208:211], v[168:171], v[44:47]
    ds_read_b64_tr_b16 v[208:209], v227 offset:5184
    ds_read_b64_tr_b16 v[210:211], v227 offset:6464
    s_waitcnt lgkmcnt(8)
    v_mfma_f32_16x16x32_bf16 v[48:51], v[212:215], v[168:171], v[48:51]
    ds_read_b64_tr_b16 v[212:213], v227 offset:5216
    ds_read_b64_tr_b16 v[214:215], v227 offset:6496
    s_waitcnt lgkmcnt(8)
    v_mfma_f32_16x16x32_bf16 v[52:55], v[216:219], v[168:171], v[52:55]
    ds_read_b64_tr_b16 v[216:217], v227 offset:5248
    ds_read_b64_tr_b16 v[218:219], v227 offset:6528
    s_waitcnt lgkmcnt(8)
    v_mfma_f32_16x16x32_bf16 v[36:39], v[200:203], v[172:175], v[36:39]
    ds_read_b64_tr_b16 v[200:201], v227 offset:10240
    ds_read_b64_tr_b16 v[202:203], v227 offset:11520
    s_waitcnt lgkmcnt(8)
    v_mfma_f32_16x16x32_bf16 v[40:43], v[204:207], v[172:175], v[40:43]
    ds_read_b64_tr_b16 v[204:205], v227 offset:10272
    ds_read_b64_tr_b16 v[206:207], v227 offset:11552
    s_waitcnt lgkmcnt(8)
    v_mfma_f32_16x16x32_bf16 v[44:47], v[208:211], v[172:175], v[44:47]
    ds_read_b64_tr_b16 v[208:209], v227 offset:10304
    ds_read_b64_tr_b16 v[210:211], v227 offset:11584
    s_waitcnt lgkmcnt(8)
    v_mfma_f32_16x16x32_bf16 v[48:51], v[212:215], v[172:175], v[48:51]
    ds_read_b64_tr_b16 v[212:213], v227 offset:10336
    ds_read_b64_tr_b16 v[214:215], v227 offset:11616
    s_waitcnt lgkmcnt(8)
    v_mfma_f32_16x16x32_bf16 v[52:55], v[216:219], v[172:175], v[52:55]
    ds_read_b64_tr_b16 v[216:217], v227 offset:10368
    ds_read_b64_tr_b16 v[218:219], v227 offset:11648
    s_waitcnt lgkmcnt(8)
    v_mfma_f32_16x16x32_bf16 v[36:39], v[200:203], v[176:179], v[36:39]
    ds_read_b64_tr_b16 v[200:201], v227 offset:15360
    ds_read_b64_tr_b16 v[202:203], v227 offset:16640
    s_waitcnt lgkmcnt(8)
    v_mfma_f32_16x16x32_bf16 v[40:43], v[204:207], v[176:179], v[40:43]
    ds_read_b64_tr_b16 v[204:205], v227 offset:15392
    ds_read_b64_tr_b16 v[206:207], v227 offset:16672
    s_waitcnt lgkmcnt(8)
    v_mfma_f32_16x16x32_bf16 v[44:47], v[208:211], v[176:179], v[44:47]
    ds_read_b64_tr_b16 v[208:209], v227 offset:15424
    ds_read_b64_tr_b16 v[210:211], v227 offset:16704
    s_waitcnt lgkmcnt(8)
    v_mfma_f32_16x16x32_bf16 v[48:51], v[212:215], v[176:179], v[48:51]
    ds_read_b64_tr_b16 v[212:213], v227 offset:15456
    ds_read_b64_tr_b16 v[214:215], v227 offset:16736
    s_waitcnt lgkmcnt(8)
    v_mfma_f32_16x16x32_bf16 v[52:55], v[216:219], v[176:179], v[52:55]
    ds_read_b64_tr_b16 v[216:217], v227 offset:15488
    ds_read_b64_tr_b16 v[218:219], v227 offset:16768
    s_waitcnt lgkmcnt(8)
    v_mfma_f32_16x16x32_bf16 v[36:39], v[200:203], v[180:183], v[36:39]
    ds_read_b64_tr_b16 v[200:201], v227 offset:20480
    ds_read_b64_tr_b16 v[202:203], v227 offset:21760
    s_waitcnt lgkmcnt(8)
    v_mfma_f32_16x16x32_bf16 v[40:43], v[204:207], v[180:183], v[40:43]
    ds_read_b64_tr_b16 v[204:205], v227 offset:20512
    ds_read_b64_tr_b16 v[206:207], v227 offset:21792
    s_waitcnt lgkmcnt(8)
    v_mfma_f32_16x16x32_bf16 v[44:47], v[208:211], v[180:183], v[44:47]
    ds_read_b64_tr_b16 v[208:209], v227 offset:20544
    ds_read_b64_tr_b16 v[210:211], v227 offset:21824
    s_waitcnt lgkmcnt(8)
    v_mfma_f32_16x16x32_bf16 v[48:51], v[212:215], v[180:183], v[48:51]
    ds_read_b64_tr_b16 v[212:213], v227 offset:20576
    ds_read_b64_tr_b16 v[214:215], v227 offset:21856
    s_waitcnt lgkmcnt(8)
    v_mfma_f32_16x16x32_bf16 v[52:55], v[216:219], v[180:183], v[52:55]
    ds_read_b64_tr_b16 v[216:217], v227 offset:20608
    ds_read_b64_tr_b16 v[218:219], v227 offset:21888
    s_waitcnt lgkmcnt(8)
    v_mfma_f32_16x16x32_bf16 v[36:39], v[200:203], v[184:187], v[36:39]
    ds_read_b64_tr_b16 v[200:201], v227 offset:25600
    ds_read_b64_tr_b16 v[202:203], v227 offset:26880
    s_waitcnt lgkmcnt(8)
    v_mfma_f32_16x16x32_bf16 v[40:43], v[204:207], v[184:187], v[40:43]
    ds_read_b64_tr_b16 v[204:205], v227 offset:25632
    ds_read_b64_tr_b16 v[206:207], v227 offset:26912
    s_waitcnt lgkmcnt(8)
    v_mfma_f32_16x16x32_bf16 v[44:47], v[208:211], v[184:187], v[44:47]
    ds_read_b64_tr_b16 v[208:209], v227 offset:25664
    ds_read_b64_tr_b16 v[210:211], v227 offset:26944
    s_waitcnt lgkmcnt(8)
    v_mfma_f32_16x16x32_bf16 v[48:51], v[212:215], v[184:187], v[48:51]
    ds_read_b64_tr_b16 v[212:213], v227 offset:25696
    ds_read_b64_tr_b16 v[214:215], v227 offset:26976
    s_waitcnt lgkmcnt(8)
    v_mfma_f32_16x16x32_bf16 v[52:55], v[216:219], v[184:187], v[52:55]
    ds_read_b64_tr_b16 v[216:217], v227 offset:25728
    ds_read_b64_tr_b16 v[218:219], v227 offset:27008
    s_waitcnt lgkmcnt(8)
    v_mfma_f32_16x16x32_bf16 v[36:39], v[200:203], v[188:191], v[36:39]
    ds_read_b64_tr_b16 v[200:201], v227 offset:30720
    ds_read_b64_tr_b16 v[202:203], v227 offset:32000
    s_waitcnt lgkmcnt(8)
    v_mfma_f32_16x16x32_bf16 v[40:43], v[204:207], v[188:191], v[40:43]
    ds_read_b64_tr_b16 v[204:205], v227 offset:30752
    ds_read_b64_tr_b16 v[206:207], v227 offset:32032
    s_waitcnt lgkmcnt(8)
    v_mfma_f32_16x16x32_bf16 v[44:47], v[208:211], v[188:191], v[44:47]
    ds_read_b64_tr_b16 v[208:209], v227 offset:30784
    ds_read_b64_tr_b16 v[210:211], v227 offset:32064
    s_waitcnt lgkmcnt(8)
    v_mfma_f32_16x16x32_bf16 v[48:51], v[212:215], v[188:191], v[48:51]
    ds_read_b64_tr_b16 v[212:213], v227 offset:30816
    ds_read_b64_tr_b16 v[214:215], v227 offset:32096
    s_waitcnt lgkmcnt(8)
    v_mfma_f32_16x16x32_bf16 v[52:55], v[216:219], v[188:191], v[52:55]
    ds_read_b64_tr_b16 v[216:217], v227 offset:30848
    ds_read_b64_tr_b16 v[218:219], v227 offset:32128
    s_waitcnt lgkmcnt(8)
    v_mfma_f32_16x16x32_bf16 v[36:39], v[200:203], v[192:195], v[36:39]
    ds_read_b64_tr_b16 v[200:201], v227 offset:35840
    ds_read_b64_tr_b16 v[202:203], v227 offset:37120
    s_waitcnt lgkmcnt(8)
    v_mfma_f32_16x16x32_bf16 v[40:43], v[204:207], v[192:195], v[40:43]
    ds_read_b64_tr_b16 v[204:205], v227 offset:35872
    ds_read_b64_tr_b16 v[206:207], v227 offset:37152
    s_waitcnt lgkmcnt(8)
    v_mfma_f32_16x16x32_bf16 v[44:47], v[208:211], v[192:195], v[44:47]
    ds_read_b64_tr_b16 v[208:209], v227 offset:35904
    ds_read_b64_tr_b16 v[210:211], v227 offset:37184
    s_waitcnt lgkmcnt(8)
    v_mfma_f32_16x16x32_bf16 v[48:51], v[212:215], v[192:195], v[48:51]
    ds_read_b64_tr_b16 v[212:213], v227 offset:35936
    ds_read_b64_tr_b16 v[214:215], v227 offset:37216
    s_waitcnt lgkmcnt(8)
    v_mfma_f32_16x16x32_bf16 v[52:55], v[216:219], v[192:195], v[52:55]
    ds_read_b64_tr_b16 v[216:217], v227 offset:35968
    ds_read_b64_tr_b16 v[218:219], v227 offset:37248
    s_waitcnt lgkmcnt(8)
    v_mfma_f32_16x16x32_bf16 v[36:39], v[200:203], v[196:199], v[36:39]
    s_waitcnt lgkmcnt(6)
    v_mfma_f32_16x16x32_bf16 v[40:43], v[204:207], v[196:199], v[40:43]
    s_waitcnt lgkmcnt(4)
    v_mfma_f32_16x16x32_bf16 v[44:47], v[208:211], v[196:199], v[44:47]
    s_waitcnt lgkmcnt(2)
    v_mfma_f32_16x16x32_bf16 v[48:51], v[212:215], v[196:199], v[48:51]
    s_waitcnt lgkmcnt(0)
    v_mfma_f32_16x16x32_bf16 v[52:55], v[216:219], v[196:199], v[52:55]
    v_and_b32 v1, 15, v0
    s_lshl_b32 s63, s56, 4
    v_add_u32 v1, s63, v1
    v_mul_u32_u24 v1, 168, v1
    v_lshrrev_b32 v2, 4, v0
    v_lshl_add_u32 v1, v2, 3, v1
    v_add_u32 v1, 61440, v1
    v_cvt_pk_bf16_f32 v200, v36, v37
    v_cvt_pk_bf16_f32 v201, v38, v39
    ds_write_b64 v1, v[200:201] offset:0
    v_cvt_pk_bf16_f32 v202, v40, v41
    v_cvt_pk_bf16_f32 v203, v42, v43
    ds_write_b64 v1, v[202:203] offset:32
    v_cvt_pk_bf16_f32 v204, v44, v45
    v_cvt_pk_bf16_f32 v205, v46, v47
    ds_write_b64 v1, v[204:205] offset:64
    v_cvt_pk_bf16_f32 v206, v48, v49
    v_cvt_pk_bf16_f32 v207, v50, v51
    ds_write_b64 v1, v[206:207] offset:96
    v_cvt_pk_bf16_f32 v208, v52, v53
    v_cvt_pk_bf16_f32 v209, v54, v55
    ds_write_b64 v1, v[208:209] offset:128
    v_and_b32 v3, 15, v0
    v_add_u32 v3, s63, v3
    v_mul_u32_u24 v3, 168, v3
    v_mad_u32_u24 v3, v2, 40, v3
    ds_read_b64 v[210:211], v3 offset:61440
    ds_read_b64 v[212:213], v3 offset:61448
    ds_read_b64 v[214:215], v3 offset:61456
    ds_read_b64 v[216:217], v3 offset:61464
    ds_read_b64 v[218:219], v3 offset:61472
    v_mov_b32 v20, 0
    v_mov_b32 v21, 0
    s_nop 1
    v_mfma_f32_32x32x4bf16_1k v[120:151], v[20:21], v[20:21], 0
    s_waitcnt lgkmcnt(0)
    v_dot2_f32_bf16 v232, v210, v210, 0
    v_dot2_f32_bf16 v233, v212, v212, 0
    v_dot2_f32_bf16 v234, v214, v214, 0
    v_dot2_f32_bf16 v235, v216, v216, 0
    v_dot2_f32_bf16 v236, v218, v218, 0
    v_dot2_f32_bf16 v232, v211, v211, v232
    v_dot2_f32_bf16 v233, v213, v213, v233
    v_dot2_f32_bf16 v234, v215, v215, v234
    v_dot2_f32_bf16 v235, v217, v217, v235
    v_dot2_f32_bf16 v236, v219, v219, v236
    v_mov_b32 v1, 60416
    v_add_f32 v232, v232, v233
    v_add_f32 v234, v234, v235
    v_add_f32 v232, v232, v236
    v_add_f32 v232, v232, v234
    s_nop 1
    v_max_u32_dpp v232, v232, v232 row_shr:1 row_mask:0xf bank_mask:0xf
    s_nop 1
    v_max_u32_dpp v232, v232, v232 row_shr:2 row_mask:0xf bank_mask:0xf
    s_nop 1
    v_max_u32_dpp v232, v232, v232 row_shr:4 row_mask:0xf bank_mask:0xf
    s_nop 1
    v_max_u32_dpp v232, v232, v232 row_shr:8 row_mask:0xf bank_mask:0xf
    s_mov_b32 exec_lo, 0x80008000
    s_mov_b32 exec_hi, 0x80008000
    ds_max_u32 v1, v232 offset:52
    s_mov_b64 exec, -1
    s_waitcnt lgkmcnt(0)
    s_barrier
    ds_read_b32 v224, v247 offset:8
    ds_read_b32 v225, v247 offset:52
    ds_read_b64 v[4:5], v245
    ds_read_b64 v[6:7], v245 offset:16
    ds_read_b64 v[8:9], v245 offset:5376
    ds_read_b64 v[10:11], v245 offset:5392
    ds_read_b64 v[12:13], v246 offset:32
    ds_read_b128 v[20:23], v27
    ds_read_b64 v[24:25], v102
    s_mov_b32 s64, 0xbf828f5c
    s_mov_b32 s65, 0xc2000000
    s_waitcnt lgkmcnt(7)
    v_mul_f32 v224, v224, v225
    v_sqrt_f32 v224, v224
    s_nop 0
    v_mul_f32 v152, s64, v224
    v_cmp_nle_f32 vcc, s65, v152
    v_mov_b32 v153, v152
    v_mov_b32 v154, v152
    v_mov_b32 v155, v152
    v_mov_b32 v156, v152
    v_mov_b32 v157, v152
    v_mov_b32 v158, v152
    v_mov_b32 v159, v152
    v_mov_b32 v160, v152
    v_mov_b32 v161, v152
    v_mov_b32 v162, v152
    v_mov_b32 v163, v152
    v_mov_b32 v164, v152
    v_mov_b32 v165, v152
    v_mov_b32 v166, v152
    v_mov_b32 v167, v152
    v_mov_b32 v224, v152
    s_cbranch_vccz L_goA
    s_waitcnt lgkmcnt(0)
    s_waitcnt vmcnt(0)
    s_barrier
    v_mov_b32 v226, 0xff800000
    v_mov_b32 v227, 0xff800000
    s_mov_b32 s69, 0
    s_and_b32 s63, s56, 3
    s_mul_i32 s63, s63, 3072
    s_add_u32 s64, s63, 36864
    s_add_u32 s63, s63, 65536
L_maxloopA:
    s_mov_b32 m0, s64
    s_nop 0
    buffer_load_dwordx4 v14, s[28:31], s63 offen offset:0 sc1 lds
    buffer_load_dwordx4 v14, s[28:31], s63 offen offset:1024 sc1 lds
    buffer_load_dwordx4 v14, s[28:31], s63 offen offset:2048 sc1 lds
    s_waitcnt vmcnt(0)
    s_barrier
    ds_read_b128 v[20:23], v27 offset:36864
    ds_read_b64 v[24:25], v102 offset:36864
    s_waitcnt lgkmcnt(0)
    v_mfma_f32_32x32x16_bf16 v[36:51], v[20:23], v[4:7], 0
    v_mfma_f32_32x32x16_bf16 v[52:67], v[20:23], v[8:11], 0
    s_nop 9
    v_mfma_f32_32x32x4bf16_1k v[36:67], v[24:25], v[12:13], v[36:67]
    s_nop 15
    s_nop 3
    v_max3_f32 v226, v226, v36, v37
    v_max3_f32 v227, v227, v52, v53
    v_max3_f32 v226, v226, v38, v39
    v_max3_f32 v227, v227, v54, v55
    v_max3_f32 v226, v226, v40, v41
    v_max3_f32 v227, v227, v56, v57
    v_max3_f32 v226, v226, v42, v43
    v_max3_f32 v227, v227, v58, v59
    v_max3_f32 v226, v226, v44, v45
    v_max3_f32 v227, v227, v60, v61
    v_max3_f32 v226, v226, v46, v47
    v_max3_f32 v227, v227, v62, v63
    v_max3_f32 v226, v226, v48, v49
    v_max3_f32 v227, v227, v64, v65
    v_max3_f32 v226, v226, v50, v51
    v_max3_f32 v227, v227, v66, v67
    ds_read_b128 v[20:23], v27 offset:39936
    ds_read_b64 v[24:25], v102 offset:39936
    s_waitcnt lgkmcnt(0)
    v_mfma_f32_32x32x16_bf16 v[36:51], v[20:23], v[4:7], 0
    v_mfma_f32_32x32x16_bf16 v[52:67], v[20:23], v[8:11], 0
    s_nop 9
    v_mfma_f32_32x32x4bf16_1k v[36:67], v[24:25], v[12:13], v[36:67]
    s_nop 15
    s_nop 3
    v_max3_f32 v226, v226, v36, v37
    v_max3_f32 v227, v227, v52, v53
    v_max3_f32 v226, v226, v38, v39
    v_max3_f32 v227, v227, v54, v55
    v_max3_f32 v226, v226, v40, v41
    v_max3_f32 v227, v227, v56, v57
    v_max3_f32 v226, v226, v42, v43
    v_max3_f32 v227, v227, v58, v59
    v_max3_f32 v226, v226, v44, v45
    v_max3_f32 v227, v227, v60, v61
    v_max3_f32 v226, v226, v46, v47
    v_max3_f32 v227, v227, v62, v63
    v_max3_f32 v226, v226, v48, v49
    v_max3_f32 v227, v227, v64, v65
    v_max3_f32 v226, v226, v50, v51
    v_max3_f32 v227, v227, v66, v67
    ds_read_b128 v[20:23], v27 offset:43008
    ds_read_b64 v[24:25], v102 offset:43008
    s_waitcnt lgkmcnt(0)
    v_mfma_f32_32x32x16_bf16 v[36:51], v[20:23], v[4:7], 0
    v_mfma_f32_32x32x16_bf16 v[52:67], v[20:23], v[8:11], 0
    s_nop 9
    v_mfma_f32_32x32x4bf16_1k v[36:67], v[24:25], v[12:13], v[36:67]
    s_nop 15
    s_nop 3
    v_max3_f32 v226, v226, v36, v37
    v_max3_f32 v227, v227, v52, v53
    v_max3_f32 v226, v226, v38, v39
    v_max3_f32 v227, v227, v54, v55
    v_max3_f32 v226, v226, v40, v41
    v_max3_f32 v227, v227, v56, v57
    v_max3_f32 v226, v226, v42, v43
    v_max3_f32 v227, v227, v58, v59
    v_max3_f32 v226, v226, v44, v45
    v_max3_f32 v227, v227, v60, v61
    v_max3_f32 v226, v226, v46, v47
    v_max3_f32 v227, v227, v62, v63
    v_max3_f32 v226, v226, v48, v49
    v_max3_f32 v227, v227, v64, v65
    v_max3_f32 v226, v226, v50, v51
    v_max3_f32 v227, v227, v66, v67
    ds_read_b128 v[20:23], v27 offset:46080
    ds_read_b64 v[24:25], v102 offset:46080
    s_waitcnt lgkmcnt(0)
    v_mfma_f32_32x32x16_bf16 v[36:51], v[20:23], v[4:7], 0
    v_mfma_f32_32x32x16_bf16 v[52:67], v[20:23], v[8:11], 0
    s_nop 9
    v_mfma_f32_32x32x4bf16_1k v[36:67], v[24:25], v[12:13], v[36:67]
    s_nop 15
    s_nop 3
    v_max3_f32 v226, v226, v36, v37
    v_max3_f32 v227, v227, v52, v53
    v_max3_f32 v226, v226, v38, v39
    v_max3_f32 v227, v227, v54, v55
    v_max3_f32 v226, v226, v40, v41
    v_max3_f32 v227, v227, v56, v57
    v_max3_f32 v226, v226, v42, v43
    v_max3_f32 v227, v227, v58, v59
    v_max3_f32 v226, v226, v44, v45
    v_max3_f32 v227, v227, v60, v61
    v_max3_f32 v226, v226, v46, v47
    v_max3_f32 v227, v227, v62, v63
    v_max3_f32 v226, v226, v48, v49
    v_max3_f32 v227, v227, v64, v65
    v_max3_f32 v226, v226, v50, v51
    v_max3_f32 v227, v227, v66, v67
    s_barrier
    s_add_u32 s63, s63, 12288
    s_add_u32 s69, s69, 1
    s_cmp_lt_u32 s69, 16
    s_cbranch_scc1 L_maxloopA
    v_mov_b32 v230, v226
    v_mov_b32 v231, v227
    s_nop 0
    v_permlane32_swap_b32 v226, v230
    v_permlane32_swap_b32 v227, v231
    v_max_f32 v226, v226, v230
    v_max_f32 v227, v227, v231
    v_sub_f32 v152, 0, v226
    v_sub_f32 v153, 0, v226
    v_sub_f32 v154, 0, v226
    v_sub_f32 v155, 0, v226
    v_sub_f32 v156, 0, v226
    v_sub_f32 v157, 0, v226
    v_sub_f32 v158, 0, v226
    v_sub_f32 v159, 0, v226
    v_sub_f32 v160, 0, v226
    v_sub_f32 v161, 0, v226
    v_sub_f32 v162, 0, v226
    v_sub_f32 v163, 0, v226
    v_sub_f32 v164, 0, v226
    v_sub_f32 v165, 0, v226
    v_sub_f32 v166, 0, v226
    v_sub_f32 v167, 0, v226
    v_sub_f32 v224, 0, v227
    ds_read_b128 v[20:23], v27
    ds_read_b64 v[24:25], v102
L_goA:
    s_setprio 0
    s_waitcnt lgkmcnt(0)
    v_mfma_f32_32x32x16_bf16 v[36:51], v[20:23], v[4:7], v[152:167]
    v_mov_b32 v168, v224
    v_mov_b32 v169, v224
    v_mov_b32 v170, v224
    v_mov_b32 v171, v224
    v_mov_b32 v172, v224
    v_mov_b32 v173, v224
    v_mov_b32 v174, v224
    v_mov_b32 v175, v224
    v_mov_b32 v176, v224
    v_mov_b32 v177, v224
    v_mov_b32 v178, v224
    v_mov_b32 v179, v224
    v_mov_b32 v180, v224
    v_mov_b32 v181, v224
    v_mov_b32 v182, v224
    v_mov_b32 v183, v224
    s_nop 1
    v_mfma_f32_32x32x16_bf16 v[52:67], v[20:23], v[8:11], v[168:183]
    ds_read_b128 v[20:23], v27 offset:3072
    ds_read_b128 v[28:31], v103 offset:0
    s_and_b32 s64, s56, 3
    s_and_b32 s63, s56, 1
    s_bitcmp1_b32 s56, 1
    s_cselect_b32 s65, 32, 0
    s_add_u32 s63, s63, s65
    s_mul_i32 s63, s63, 3072
    s_add_u32 s63, s63, 77824
    s_mul_i32 s64, s64, 3072
    s_add_u32 s64, s64, 0
    s_mul_i32 s65, s58, 160
    s_lshl_b32 s66, s56, 10
    s_add_u32 s66, s66, 61440
    v_mfma_f32_32x32x4bf16_1k v[36:67], v[24:25], v[12:13], v[36:67]
    ds_read_b64 v[24:25], v102 offset:3072
    s_nop 15
    s_nop 2
    v_exp_f32 v36, v36
    v_exp_f32 v37, v37
    s_waitcnt lgkmcnt(0)
    ds_read_b128 v[32:35], v103 offset:704
    v_exp_f32 v38, v38
    v_exp_f32 v39, v39
    v_exp_f32 v40, v40
    v_mfma_f32_32x32x16_bf16 v[68:83], v[20:23], v[4:7], v[152:167]
    v_exp_f32 v41, v41
    v_exp_f32 v42, v42
    v_exp_f32 v43, v43
    v_mfma_f32_32x32x16_bf16 v[84:99], v[20:23], v[8:11], v[168:183]
    s_barrier
    ds_read_b128 v[20:23], v27 offset:12288
    v_exp_f32 v44, v44
    v_exp_f32 v45, v45
    v_exp_f32 v46, v46
    v_exp_f32 v47, v47
    v_smfmac_f32_32x32x32_bf16 v[120:135], v[28:31], v[36:43], v26
    v_exp_f32 v48, v48
    v_exp_f32 v49, v49
    v_exp_f32 v50, v50
    v_exp_f32 v51, v51
    v_mfma_f32_32x32x4bf16_1k v[68:99], v[24:25], v[12:13], v[68:99]
    ds_read_b64 v[24:25], v102 offset:12288
    v_exp_f32 v52, v52
    v_exp_f32 v53, v53
    v_exp_f32 v54, v54
    v_exp_f32 v55, v55
    v_exp_f32 v56, v56
    v_exp_f32 v57, v57
    v_exp_f32 v58, v58
    s_waitcnt lgkmcnt(2)
    v_smfmac_f32_32x32x32_bf16 v[120:135], v[32:35], v[44:51], v26
    v_exp_f32 v59, v59
    v_exp_f32 v60, v60
    v_exp_f32 v61, v61
    v_exp_f32 v62, v62
    v_smfmac_f32_32x32x32_bf16 v[136:151], v[28:31], v[52:59], v26
    ds_read_b128 v[28:31], v103 offset:3072
    v_exp_f32 v63, v63
    v_exp_f32 v64, v64
    v_exp_f32 v65, v65
    v_exp_f32 v66, v66
    v_exp_f32 v67, v67
    v_exp_f32 v68, v68
    v_exp_f32 v69, v69
    s_waitcnt lgkmcnt(0)
    v_smfmac_f32_32x32x32_bf16 v[136:151], v[32:35], v[60:67], v26
    ds_read_b128 v[32:35], v103 offset:3776
    v_exp_f32 v70, v70
    v_exp_f32 v71, v71
    v_exp_f32 v72, v72
    v_mfma_f32_32x32x16_bf16 v[36:51], v[20:23], v[4:7], v[152:167]
    v_exp_f32 v73, v73
    v_exp_f32 v74, v74
    v_exp_f32 v75, v75
    v_mfma_f32_32x32x16_bf16 v[52:67], v[20:23], v[8:11], v[168:183]
    ds_read_b128 v[20:23], v27 offset:15360
    v_exp_f32 v76, v76
    v_exp_f32 v77, v77
    v_exp_f32 v78, v78
    v_exp_f32 v79, v79
    v_smfmac_f32_32x32x32_bf16 v[120:135], v[28:31], v[68:75], v26
    v_exp_f32 v80, v80
    v_exp_f32 v81, v81
    v_exp_f32 v82, v82
    v_exp_f32 v83, v83
    v_mfma_f32_32x32x4bf16_1k v[36:67], v[24:25], v[12:13], v[36:67]
    ds_read_b64 v[24:25], v102 offset:15360
    v_exp_f32 v84, v84
    v_exp_f32 v85, v85
    v_exp_f32 v86, v86
    v_exp_f32 v87, v87
    v_exp_f32 v88, v88
    v_exp_f32 v89, v89
    v_exp_f32 v90, v90
    s_waitcnt lgkmcnt(2)
    v_smfmac_f32_32x32x32_bf16 v[120:135], v[32:35], v[76:83], v26
    v_exp_f32 v91, v91
    v_exp_f32 v92, v92
    v_exp_f32 v93, v93
    v_exp_f32 v94, v94
    v_smfmac_f32_32x32x32_bf16 v[136:151], v[28:31], v[84:91], v26
    ds_read_b128 v[28:31], v103 offset:12288
    v_exp_f32 v95, v95
    v_exp_f32 v96, v96
    v_exp_f32 v97, v97
    v_exp_f32 v98, v98
    v_exp_f32 v99, v99
    v_exp_f32 v36, v36
    v_exp_f32 v37, v37
    s_waitcnt lgkmcnt(0)
    v_smfmac_f32_32x32x32_bf16 v[136:151], v[32:35], v[92:99], v26
    ds_read_b128 v[32:35], v103 offset:12992
    v_exp_f32 v38, v38
    v_exp_f32 v39, v39
    v_exp_f32 v40, v40
    v_mfma_f32_32x32x16_bf16 v[68:83], v[20:23], v[4:7], v[152:167]
    v_exp_f32 v41, v41
    v_exp_f32 v42, v42
    v_exp_f32 v43, v43
    v_mfma_f32_32x32x16_bf16 v[84:99], v[20:23], v[8:11], v[168:183]
    s_barrier
    s_add_u32 m0, s64, 0
    s_add_u32 s63, s63, 12288
    buffer_load_dwordx4 v14, s[28:31], s63 offen offset:0 sc1 lds
    buffer_load_dwordx4 v14, s[28:31], s63 offen offset:1024 sc1 lds
    buffer_load_dwordx4 v14, s[28:31], s63 offen offset:2048 sc1 lds
    s_add_u32 m0, s66, 0
    s_nop 0
    buffer_load_dwordx4 v240, s[16:19], s65 offen lds
    s_add_u32 m0, s66, 8192
    s_nop 0
    buffer_load_dwordx4 v241, s[16:19], s65 offen lds
    ds_read_b128 v[20:23], v27 offset:24576
    v_exp_f32 v44, v44
    v_exp_f32 v45, v45
    v_exp_f32 v46, v46
    v_exp_f32 v47, v47
    v_smfmac_f32_32x32x32_bf16 v[120:135], v[28:31], v[36:43], v26
    v_exp_f32 v48, v48
    v_exp_f32 v49, v49
    v_exp_f32 v50, v50
    v_exp_f32 v51, v51
    v_mfma_f32_32x32x4bf16_1k v[68:99], v[24:25], v[12:13], v[68:99]
    ds_read_b64 v[24:25], v102 offset:24576
    v_exp_f32 v52, v52
    v_exp_f32 v53, v53
    v_exp_f32 v54, v54
    v_exp_f32 v55, v55
    v_exp_f32 v56, v56
    v_exp_f32 v57, v57
    v_exp_f32 v58, v58
    s_waitcnt lgkmcnt(2)
    v_smfmac_f32_32x32x32_bf16 v[120:135], v[32:35], v[44:51], v26
    v_exp_f32 v59, v59
    v_exp_f32 v60, v60
    v_exp_f32 v61, v61
    v_exp_f32 v62, v62
    v_smfmac_f32_32x32x32_bf16 v[136:151], v[28:31], v[52:59], v26
    ds_read_b128 v[28:31], v103 offset:15360
    v_exp_f32 v63, v63
    v_exp_f32 v64, v64
    v_exp_f32 v65, v65
    v_exp_f32 v66, v66
    v_exp_f32 v67, v67
    v_exp_f32 v68, v68
    v_exp_f32 v69, v69
    s_waitcnt lgkmcnt(0)
    v_smfmac_f32_32x32x32_bf16 v[136:151], v[32:35], v[60:67], v26
    ds_read_b128 v[32:35], v103 offset:16064
    v_exp_f32 v70, v70
    v_exp_f32 v71, v71
    v_exp_f32 v72, v72
    v_mfma_f32_32x32x16_bf16 v[36:51], v[20:23], v[4:7], v[152:167]
    v_exp_f32 v73, v73
    v_exp_f32 v74, v74
    v_exp_f32 v75, v75
    v_mfma_f32_32x32x16_bf16 v[52:67], v[20:23], v[8:11], v[168:183]
    ds_read_b128 v[20:23], v27 offset:27648
    v_exp_f32 v76, v76
    v_exp_f32 v77, v77
    v_exp_f32 v78, v78
    v_exp_f32 v79, v79
    v_smfmac_f32_32x32x32_bf16 v[120:135], v[28:31], v[68:75], v26
    v_exp_f32 v80, v80
    v_exp_f32 v81, v81
    v_exp_f32 v82, v82
    v_exp_f32 v83, v83
    v_mfma_f32_32x32x4bf16_1k v[36:67], v[24:25], v[12:13], v[36:67]
    ds_read_b64 v[24:25], v102 offset:27648
    v_exp_f32 v84, v84
    v_exp_f32 v85, v85
    v_exp_f32 v86, v86
    v_exp_f32 v87, v87
    v_exp_f32 v88, v88
    v_exp_f32 v89, v89
    v_exp_f32 v90, v90
    s_waitcnt lgkmcnt(2)
    v_smfmac_f32_32x32x32_bf16 v[120:135], v[32:35], v[76:83], v26
    v_exp_f32 v91, v91
    v_exp_f32 v92, v92
    v_exp_f32 v93, v93
    v_exp_f32 v94, v94
    v_smfmac_f32_32x32x32_bf16 v[136:151], v[28:31], v[84:91], v26
    ds_read_b128 v[28:31], v103 offset:24576
    v_exp_f32 v95, v95
    v_exp_f32 v96, v96
    v_exp_f32 v97, v97
    v_exp_f32 v98, v98
    v_exp_f32 v99, v99
    v_exp_f32 v36, v36
    v_exp_f32 v37, v37
    s_waitcnt lgkmcnt(0)
    v_smfmac_f32_32x32x32_bf16 v[136:151], v[32:35], v[92:99], v26
    ds_read_b128 v[32:35], v103 offset:25280
    v_exp_f32 v38, v38
    v_exp_f32 v39, v39
    v_exp_f32 v40, v40
    v_mfma_f32_32x32x16_bf16 v[68:83], v[20:23], v[4:7], v[152:167]
    v_exp_f32 v41, v41
    v_exp_f32 v42, v42
    v_exp_f32 v43, v43
    v_mfma_f32_32x32x16_bf16 v[84:99], v[20:23], v[8:11], v[168:183]
    s_barrier
    ds_read_b128 v[20:23], v27 offset:36864
    v_exp_f32 v44, v44
    v_exp_f32 v45, v45
    v_exp_f32 v46, v46
    v_exp_f32 v47, v47
    v_smfmac_f32_32x32x32_bf16 v[120:135], v[28:31], v[36:43], v26
    v_exp_f32 v48, v48
    v_exp_f32 v49, v49
    v_exp_f32 v50, v50
    v_exp_f32 v51, v51
    v_mfma_f32_32x32x4bf16_1k v[68:99], v[24:25], v[12:13], v[68:99]
    ds_read_b64 v[24:25], v102 offset:36864
    v_exp_f32 v52, v52
    v_exp_f32 v53, v53
    v_exp_f32 v54, v54
    v_exp_f32 v55, v55
    v_exp_f32 v56, v56
    v_exp_f32 v57, v57
    v_exp_f32 v58, v58
    s_waitcnt lgkmcnt(2)
    v_smfmac_f32_32x32x32_bf16 v[120:135], v[32:35], v[44:51], v26
    v_exp_f32 v59, v59
    v_exp_f32 v60, v60
    v_exp_f32 v61, v61
    v_exp_f32 v62, v62
    v_smfmac_f32_32x32x32_bf16 v[136:151], v[28:31], v[52:59], v26
    ds_read_b128 v[28:31], v103 offset:27648
    v_exp_f32 v63, v63
    v_exp_f32 v64, v64
    v_exp_f32 v65, v65
    v_exp_f32 v66, v66
    v_exp_f32 v67, v67
    v_exp_f32 v68, v68
    v_exp_f32 v69, v69
    s_waitcnt lgkmcnt(0)
    v_smfmac_f32_32x32x32_bf16 v[136:151], v[32:35], v[60:67], v26
    ds_read_b128 v[32:35], v103 offset:28352
    v_exp_f32 v70, v70
    v_exp_f32 v71, v71
    v_exp_f32 v72, v72
    v_mfma_f32_32x32x16_bf16 v[36:51], v[20:23], v[4:7], v[152:167]
    v_exp_f32 v73, v73
    v_exp_f32 v74, v74
    v_exp_f32 v75, v75
    v_mfma_f32_32x32x16_bf16 v[52:67], v[20:23], v[8:11], v[168:183]
    ds_read_b128 v[20:23], v27 offset:39936
    v_exp_f32 v76, v76
    v_exp_f32 v77, v77
    v_exp_f32 v78, v78
    v_exp_f32 v79, v79
    v_smfmac_f32_32x32x32_bf16 v[120:135], v[28:31], v[68:75], v26
    v_exp_f32 v80, v80
    v_exp_f32 v81, v81
    v_exp_f32 v82, v82
    v_exp_f32 v83, v83
    v_mfma_f32_32x32x4bf16_1k v[36:67], v[24:25], v[12:13], v[36:67]
    ds_read_b64 v[24:25], v102 offset:39936
    v_exp_f32 v84, v84
    v_exp_f32 v85, v85
    v_exp_f32 v86, v86
    v_exp_f32 v87, v87
    v_exp_f32 v88, v88
    v_exp_f32 v89, v89
    v_exp_f32 v90, v90
    s_waitcnt lgkmcnt(2)
    v_smfmac_f32_32x32x32_bf16 v[120:135], v[32:35], v[76:83], v26
    v_exp_f32 v91, v91
    v_exp_f32 v92, v92
    v_exp_f32 v93, v93
    v_exp_f32 v94, v94
    v_smfmac_f32_32x32x32_bf16 v[136:151], v[28:31], v[84:91], v26
    ds_read_b128 v[28:31], v103 offset:36864
    v_exp_f32 v95, v95
    v_exp_f32 v96, v96
    v_exp_f32 v97, v97
    v_exp_f32 v98, v98
    v_exp_f32 v99, v99
    v_exp_f32 v36, v36
    v_exp_f32 v37, v37
    s_waitcnt lgkmcnt(0)
    v_smfmac_f32_32x32x32_bf16 v[136:151], v[32:35], v[92:99], v26
    ds_read_b128 v[32:35], v103 offset:37568
    v_exp_f32 v38, v38
    v_exp_f32 v39, v39
    v_exp_f32 v40, v40
    v_mfma_f32_32x32x16_bf16 v[68:83], v[20:23], v[4:7], v[152:167]
    v_exp_f32 v41, v41
    v_exp_f32 v42, v42
    v_exp_f32 v43, v43
    v_mfma_f32_32x32x16_bf16 v[84:99], v[20:23], v[8:11], v[168:183]
    s_waitcnt vmcnt(2)
    s_barrier
    s_add_u32 m0, s64, 24576
    s_add_u32 s63, s63, 12288
    buffer_load_dwordx4 v14, s[28:31], s63 offen offset:0 sc1 lds
    buffer_load_dwordx4 v14, s[28:31], s63 offen offset:1024 sc1 lds
    buffer_load_dwordx4 v14, s[28:31], s63 offen offset:2048 sc1 lds
    s_add_u32 m0, s66, 16384
    s_nop 0
    buffer_load_dwordx4 v242, s[16:19], s65 offen lds
    s_add_u32 m0, s66, 24576
    s_nop 0
    buffer_load_dwordx4 v243, s[16:19], s65 offen lds
    ds_read_b128 v[20:23], v27 offset:0
    v_exp_f32 v44, v44
    v_exp_f32 v45, v45
    v_exp_f32 v46, v46
    v_exp_f32 v47, v47
    v_smfmac_f32_32x32x32_bf16 v[120:135], v[28:31], v[36:43], v26
    v_exp_f32 v48, v48
    v_exp_f32 v49, v49
    v_exp_f32 v50, v50
    v_exp_f32 v51, v51
    v_mfma_f32_32x32x4bf16_1k v[68:99], v[24:25], v[12:13], v[68:99]
    ds_read_b64 v[24:25], v102 offset:0
    v_exp_f32 v52, v52
    v_exp_f32 v53, v53
    v_exp_f32 v54, v54
    v_exp_f32 v55, v55
    v_exp_f32 v56, v56
    v_exp_f32 v57, v57
    v_exp_f32 v58, v58
    s_waitcnt lgkmcnt(2)
    v_smfmac_f32_32x32x32_bf16 v[120:135], v[32:35], v[44:51], v26
    v_exp_f32 v59, v59
    v_exp_f32 v60, v60
    v_exp_f32 v61, v61
    v_exp_f32 v62, v62
    v_smfmac_f32_32x32x32_bf16 v[136:151], v[28:31], v[52:59], v26
    ds_read_b128 v[28:31], v103 offset:39936
    v_exp_f32 v63, v63
    v_exp_f32 v64, v64
    v_exp_f32 v65, v65
    v_exp_f32 v66, v66
    v_exp_f32 v67, v67
    v_exp_f32 v68, v68
    v_exp_f32 v69, v69
    s_waitcnt lgkmcnt(0)
    v_smfmac_f32_32x32x32_bf16 v[136:151], v[32:35], v[60:67], v26
    ds_read_b128 v[32:35], v103 offset:40640
    v_exp_f32 v70, v70
    v_exp_f32 v71, v71
    v_exp_f32 v72, v72
    v_mfma_f32_32x32x16_bf16 v[36:51], v[20:23], v[4:7], v[152:167]
    v_exp_f32 v73, v73
    v_exp_f32 v74, v74
    v_exp_f32 v75, v75
    v_mfma_f32_32x32x16_bf16 v[52:67], v[20:23], v[8:11], v[168:183]
    ds_read_b128 v[20:23], v27 offset:3072
    v_exp_f32 v76, v76
    v_exp_f32 v77, v77
    v_exp_f32 v78, v78
    v_exp_f32 v79, v79
    v_smfmac_f32_32x32x32_bf16 v[120:135], v[28:31], v[68:75], v26
    v_exp_f32 v80, v80
    v_exp_f32 v81, v81
    v_exp_f32 v82, v82
    v_exp_f32 v83, v83
    v_mfma_f32_32x32x4bf16_1k v[36:67], v[24:25], v[12:13], v[36:67]
    ds_read_b64 v[24:25], v102 offset:3072
    v_exp_f32 v84, v84
    v_exp_f32 v85, v85
    v_exp_f32 v86, v86
    v_exp_f32 v87, v87
    v_exp_f32 v88, v88
    v_exp_f32 v89, v89
    v_exp_f32 v90, v90
    s_waitcnt lgkmcnt(2)
    v_smfmac_f32_32x32x32_bf16 v[120:135], v[32:35], v[76:83], v26
    v_exp_f32 v91, v91
    v_exp_f32 v92, v92
    v_exp_f32 v93, v93
    v_exp_f32 v94, v94
    v_smfmac_f32_32x32x32_bf16 v[136:151], v[28:31], v[84:91], v26
    ds_read_b128 v[28:31], v103 offset:0
    v_exp_f32 v95, v95
    v_exp_f32 v96, v96
    v_exp_f32 v97, v97
    v_exp_f32 v98, v98
    v_exp_f32 v99, v99
    v_exp_f32 v36, v36
    v_exp_f32 v37, v37
    s_waitcnt lgkmcnt(0)
    v_smfmac_f32_32x32x32_bf16 v[136:151], v[32:35], v[92:99], v26
    ds_read_b128 v[32:35], v103 offset:704
    v_exp_f32 v38, v38
    v_exp_f32 v39, v39
    v_exp_f32 v40, v40
    v_mfma_f32_32x32x16_bf16 v[68:83], v[20:23], v[4:7], v[152:167]
    v_exp_f32 v41, v41
    v_exp_f32 v42, v42
    v_exp_f32 v43, v43
    v_mfma_f32_32x32x16_bf16 v[84:99], v[20:23], v[8:11], v[168:183]
    s_barrier
    ds_read_b128 v[20:23], v27 offset:12288
    v_exp_f32 v44, v44
    v_exp_f32 v45, v45
    v_exp_f32 v46, v46
    v_exp_f32 v47, v47
    v_smfmac_f32_32x32x32_bf16 v[120:135], v[28:31], v[36:43], v26
    v_exp_f32 v48, v48
    v_exp_f32 v49, v49
    v_exp_f32 v50, v50
    v_exp_f32 v51, v51
    v_mfma_f32_32x32x4bf16_1k v[68:99], v[24:25], v[12:13], v[68:99]
    ds_read_b64 v[24:25], v102 offset:12288
    v_exp_f32 v52, v52
    v_exp_f32 v53, v53
    v_exp_f32 v54, v54
    v_exp_f32 v55, v55
    v_exp_f32 v56, v56
    v_exp_f32 v57, v57
    v_exp_f32 v58, v58
    s_waitcnt lgkmcnt(2)
    v_smfmac_f32_32x32x32_bf16 v[120:135], v[32:35], v[44:51], v26
    v_exp_f32 v59, v59
    v_exp_f32 v60, v60
    v_exp_f32 v61, v61
    v_exp_f32 v62, v62
    v_smfmac_f32_32x32x32_bf16 v[136:151], v[28:31], v[52:59], v26
    ds_read_b128 v[28:31], v103 offset:3072
    v_exp_f32 v63, v63
    v_exp_f32 v64, v64
    v_exp_f32 v65, v65
    v_exp_f32 v66, v66
    v_exp_f32 v67, v67
    v_exp_f32 v68, v68
    v_exp_f32 v69, v69
    s_waitcnt lgkmcnt(0)
    v_smfmac_f32_32x32x32_bf16 v[136:151], v[32:35], v[60:67], v26
    ds_read_b128 v[32:35], v103 offset:3776
    v_exp_f32 v70, v70
    v_exp_f32 v71, v71
    v_exp_f32 v72, v72
    v_mfma_f32_32x32x16_bf16 v[36:51], v[20:23], v[4:7], v[152:167]
    v_exp_f32 v73, v73
    v_exp_f32 v74, v74
    v_exp_f32 v75, v75
    v_mfma_f32_32x32x16_bf16 v[52:67], v[20:23], v[8:11], v[168:183]
    ds_read_b128 v[20:23], v27 offset:15360
    v_exp_f32 v76, v76
    v_exp_f32 v77, v77
    v_exp_f32 v78, v78
    v_exp_f32 v79, v79
    v_smfmac_f32_32x32x32_bf16 v[120:135], v[28:31], v[68:75], v26
    v_exp_f32 v80, v80
    v_exp_f32 v81, v81
    v_exp_f32 v82, v82
    v_exp_f32 v83, v83
    v_mfma_f32_32x32x4bf16_1k v[36:67], v[24:25], v[12:13], v[36:67]
    ds_read_b64 v[24:25], v102 offset:15360
    v_exp_f32 v84, v84
    v_exp_f32 v85, v85
    v_exp_f32 v86, v86
    v_exp_f32 v87, v87
    v_exp_f32 v88, v88
    v_exp_f32 v89, v89
    v_exp_f32 v90, v90
    s_waitcnt lgkmcnt(2)
    v_smfmac_f32_32x32x32_bf16 v[120:135], v[32:35], v[76:83], v26
    v_exp_f32 v91, v91
    v_exp_f32 v92, v92
    v_exp_f32 v93, v93
    v_exp_f32 v94, v94
    v_smfmac_f32_32x32x32_bf16 v[136:151], v[28:31], v[84:91], v26
    ds_read_b128 v[28:31], v103 offset:12288
    v_exp_f32 v95, v95
    v_exp_f32 v96, v96
    v_exp_f32 v97, v97
    v_exp_f32 v98, v98
    v_exp_f32 v99, v99
    v_exp_f32 v36, v36
    v_exp_f32 v37, v37
    s_waitcnt lgkmcnt(0)
    v_smfmac_f32_32x32x32_bf16 v[136:151], v[32:35], v[92:99], v26
    ds_read_b128 v[32:35], v103 offset:12992
    v_exp_f32 v38, v38
    v_exp_f32 v39, v39
    v_exp_f32 v40, v40
    v_mfma_f32_32x32x16_bf16 v[68:83], v[20:23], v[4:7], v[152:167]
    v_exp_f32 v41, v41
    v_exp_f32 v42, v42
    v_exp_f32 v43, v43
    v_mfma_f32_32x32x16_bf16 v[84:99], v[20:23], v[8:11], v[168:183]
    s_waitcnt vmcnt(2)
    s_barrier
    s_add_u32 m0, s64, 0
    s_add_u32 s63, s63, 12288
    buffer_load_dwordx4 v14, s[28:31], s63 offen offset:0 sc1 lds
    buffer_load_dwordx4 v14, s[28:31], s63 offen offset:1024 sc1 lds
    buffer_load_dwordx4 v14, s[28:31], s63 offen offset:2048 sc1 lds
    s_add_u32 m0, s66, 32768
    s_nop 0
    buffer_load_dwordx4 v244, s[16:19], s65 offen lds
    s_add_u32 s65, s65, 327680
    s_add_u32 m0, s66, 40960
    s_nop 0
    buffer_load_dwordx4 v240, s[16:19], s65 offen lds
    ds_read_b128 v[20:23], v27 offset:24576
    v_exp_f32 v44, v44
    v_exp_f32 v45, v45
    v_exp_f32 v46, v46
    v_exp_f32 v47, v47
    v_smfmac_f32_32x32x32_bf16 v[120:135], v[28:31], v[36:43], v26
    v_exp_f32 v48, v48
    v_exp_f32 v49, v49
    v_exp_f32 v50, v50
    v_exp_f32 v51, v51
    v_mfma_f32_32x32x4bf16_1k v[68:99], v[24:25], v[12:13], v[68:99]
    ds_read_b64 v[24:25], v102 offset:24576
    v_exp_f32 v52, v52
    v_exp_f32 v53, v53
    v_exp_f32 v54, v54
    v_exp_f32 v55, v55
    v_exp_f32 v56, v56
    v_exp_f32 v57, v57
    v_exp_f32 v58, v58
    s_waitcnt lgkmcnt(2)
    v_smfmac_f32_32x32x32_bf16 v[120:135], v[32:35], v[44:51], v26
    v_exp_f32 v59, v59
    v_exp_f32 v60, v60
    v_exp_f32 v61, v61
    v_exp_f32 v62, v62
    v_smfmac_f32_32x32x32_bf16 v[136:151], v[28:31], v[52:59], v26
    ds_read_b128 v[28:31], v103 offset:15360
    v_exp_f32 v63, v63
    v_exp_f32 v64, v64
    v_exp_f32 v65, v65
    v_exp_f32 v66, v66
    v_exp_f32 v67, v67
    v_exp_f32 v68, v68
    v_exp_f32 v69, v69
    s_waitcnt lgkmcnt(0)
    v_smfmac_f32_32x32x32_bf16 v[136:151], v[32:35], v[60:67], v26
    ds_read_b128 v[32:35], v103 offset:16064
    v_exp_f32 v70, v70
    v_exp_f32 v71, v71
    v_exp_f32 v72, v72
    v_mfma_f32_32x32x16_bf16 v[36:51], v[20:23], v[4:7], v[152:167]
    v_exp_f32 v73, v73
    v_exp_f32 v74, v74
    v_exp_f32 v75, v75
    v_mfma_f32_32x32x16_bf16 v[52:67], v[20:23], v[8:11], v[168:183]
    ds_read_b128 v[20:23], v27 offset:27648
    v_exp_f32 v76, v76
    v_exp_f32 v77, v77
    v_exp_f32 v78, v78
    v_exp_f32 v79, v79
    v_smfmac_f32_32x32x32_bf16 v[120:135], v[28:31], v[68:75], v26
    v_exp_f32 v80, v80
    v_exp_f32 v81, v81
    v_exp_f32 v82, v82
    v_exp_f32 v83, v83
    v_mfma_f32_32x32x4bf16_1k v[36:67], v[24:25], v[12:13], v[36:67]
    ds_read_b64 v[24:25], v102 offset:27648
    v_exp_f32 v84, v84
    v_exp_f32 v85, v85
    v_exp_f32 v86, v86
    v_exp_f32 v87, v87
    v_exp_f32 v88, v88
    v_exp_f32 v89, v89
    v_exp_f32 v90, v90
    s_waitcnt lgkmcnt(2)
    v_smfmac_f32_32x32x32_bf16 v[120:135], v[32:35], v[76:83], v26
    v_exp_f32 v91, v91
    v_exp_f32 v92, v92
    v_exp_f32 v93, v93
    v_exp_f32 v94, v94
    v_smfmac_f32_32x32x32_bf16 v[136:151], v[28:31], v[84:91], v26
    ds_read_b128 v[28:31], v103 offset:24576
    v_exp_f32 v95, v95
    v_exp_f32 v96, v96
    v_exp_f32 v97, v97
    v_exp_f32 v98, v98
    v_exp_f32 v99, v99
    v_exp_f32 v36, v36
    v_exp_f32 v37, v37
    s_waitcnt lgkmcnt(0)
    v_smfmac_f32_32x32x32_bf16 v[136:151], v[32:35], v[92:99], v26
    ds_read_b128 v[32:35], v103 offset:25280
    v_exp_f32 v38, v38
    v_exp_f32 v39, v39
    v_exp_f32 v40, v40
    v_mfma_f32_32x32x16_bf16 v[68:83], v[20:23], v[4:7], v[152:167]
    v_exp_f32 v41, v41
    v_exp_f32 v42, v42
    v_exp_f32 v43, v43
    v_mfma_f32_32x32x16_bf16 v[84:99], v[20:23], v[8:11], v[168:183]
    s_barrier
    ds_read_b128 v[20:23], v27 offset:36864
    v_exp_f32 v44, v44
    v_exp_f32 v45, v45
    v_exp_f32 v46, v46
    v_exp_f32 v47, v47
    v_smfmac_f32_32x32x32_bf16 v[120:135], v[28:31], v[36:43], v26
    v_exp_f32 v48, v48
    v_exp_f32 v49, v49
    v_exp_f32 v50, v50
    v_exp_f32 v51, v51
    v_mfma_f32_32x32x4bf16_1k v[68:99], v[24:25], v[12:13], v[68:99]
    ds_read_b64 v[24:25], v102 offset:36864
    v_exp_f32 v52, v52
    v_exp_f32 v53, v53
    v_exp_f32 v54, v54
    v_exp_f32 v55, v55
    v_exp_f32 v56, v56
    v_exp_f32 v57, v57
    v_exp_f32 v58, v58
    s_waitcnt lgkmcnt(2)
    v_smfmac_f32_32x32x32_bf16 v[120:135], v[32:35], v[44:51], v26
    v_exp_f32 v59, v59
    v_exp_f32 v60, v60
    v_exp_f32 v61, v61
    v_exp_f32 v62, v62
    v_smfmac_f32_32x32x32_bf16 v[136:151], v[28:31], v[52:59], v26
    ds_read_b128 v[28:31], v103 offset:27648
    v_exp_f32 v63, v63
    v_exp_f32 v64, v64
    v_exp_f32 v65, v65
    v_exp_f32 v66, v66
    v_exp_f32 v67, v67
    v_exp_f32 v68, v68
    v_exp_f32 v69, v69
    s_waitcnt lgkmcnt(0)
    v_smfmac_f32_32x32x32_bf16 v[136:151], v[32:35], v[60:67], v26
    ds_read_b128 v[32:35], v103 offset:28352
    v_exp_f32 v70, v70
    v_exp_f32 v71, v71
    v_exp_f32 v72, v72
    v_mfma_f32_32x32x16_bf16 v[36:51], v[20:23], v[4:7], v[152:167]
    v_exp_f32 v73, v73
    v_exp_f32 v74, v74
    v_exp_f32 v75, v75
    v_mfma_f32_32x32x16_bf16 v[52:67], v[20:23], v[8:11], v[168:183]
    ds_read_b128 v[20:23], v27 offset:39936
    v_exp_f32 v76, v76
    v_exp_f32 v77, v77
    v_exp_f32 v78, v78
    v_exp_f32 v79, v79
    v_smfmac_f32_32x32x32_bf16 v[120:135], v[28:31], v[68:75], v26
    v_exp_f32 v80, v80
    v_exp_f32 v81, v81
    v_exp_f32 v82, v82
    v_exp_f32 v83, v83
    v_mfma_f32_32x32x4bf16_1k v[36:67], v[24:25], v[12:13], v[36:67]
    ds_read_b64 v[24:25], v102 offset:39936
    v_exp_f32 v84, v84
    v_exp_f32 v85, v85
    v_exp_f32 v86, v86
    v_exp_f32 v87, v87
    v_exp_f32 v88, v88
    v_exp_f32 v89, v89
    v_exp_f32 v90, v90
    s_waitcnt lgkmcnt(2)
    v_smfmac_f32_32x32x32_bf16 v[120:135], v[32:35], v[76:83], v26
    v_exp_f32 v91, v91
    v_exp_f32 v92, v92
    v_exp_f32 v93, v93
    v_exp_f32 v94, v94
    v_smfmac_f32_32x32x32_bf16 v[136:151], v[28:31], v[84:91], v26
    ds_read_b128 v[28:31], v103 offset:36864
    v_exp_f32 v95, v95
    v_exp_f32 v96, v96
    v_exp_f32 v97, v97
    v_exp_f32 v98, v98
    v_exp_f32 v99, v99
    v_exp_f32 v36, v36
    v_exp_f32 v37, v37
    s_waitcnt lgkmcnt(0)
    v_smfmac_f32_32x32x32_bf16 v[136:151], v[32:35], v[92:99], v26
    ds_read_b128 v[32:35], v103 offset:37568
    v_exp_f32 v38, v38
    v_exp_f32 v39, v39
    v_exp_f32 v40, v40
    v_mfma_f32_32x32x16_bf16 v[68:83], v[20:23], v[4:7], v[152:167]
    v_exp_f32 v41, v41
    v_exp_f32 v42, v42
    v_exp_f32 v43, v43
    v_mfma_f32_32x32x16_bf16 v[84:99], v[20:23], v[8:11], v[168:183]
    s_waitcnt vmcnt(2)
    s_barrier
    s_add_u32 m0, s64, 24576
    s_add_u32 s63, s63, 12288
    buffer_load_dwordx4 v14, s[28:31], s63 offen offset:0 sc1 lds
    buffer_load_dwordx4 v14, s[28:31], s63 offen offset:1024 sc1 lds
    buffer_load_dwordx4 v14, s[28:31], s63 offen offset:2048 sc1 lds
    s_add_u32 m0, s66, 49152
    s_nop 0
    buffer_load_dwordx4 v241, s[16:19], s65 offen lds
    s_add_u32 m0, s66, 57344
    s_nop 0
    buffer_load_dwordx4 v242, s[16:19], s65 offen lds
    ds_read_b128 v[20:23], v27 offset:0
    v_exp_f32 v44, v44
    v_exp_f32 v45, v45
    v_exp_f32 v46, v46
    v_exp_f32 v47, v47
    v_smfmac_f32_32x32x32_bf16 v[120:135], v[28:31], v[36:43], v26
    v_exp_f32 v48, v48
    v_exp_f32 v49, v49
    v_exp_f32 v50, v50
    v_exp_f32 v51, v51
    v_mfma_f32_32x32x4bf16_1k v[68:99], v[24:25], v[12:13], v[68:99]
    ds_read_b64 v[24:25], v102 offset:0
    v_exp_f32 v52, v52
    v_exp_f32 v53, v53
    v_exp_f32 v54, v54
    v_exp_f32 v55, v55
    v_exp_f32 v56, v56
    v_exp_f32 v57, v57
    v_exp_f32 v58, v58
    s_waitcnt lgkmcnt(2)
    v_smfmac_f32_32x32x32_bf16 v[120:135], v[32:35], v[44:51], v26
    v_exp_f32 v59, v59
    v_exp_f32 v60, v60
    v_exp_f32 v61, v61
    v_exp_f32 v62, v62
    v_smfmac_f32_32x32x32_bf16 v[136:151], v[28:31], v[52:59], v26
    ds_read_b128 v[28:31], v103 offset:39936
    v_exp_f32 v63, v63
    v_exp_f32 v64, v64
    v_exp_f32 v65, v65
    v_exp_f32 v66, v66
    v_exp_f32 v67, v67
    v_exp_f32 v68, v68
    v_exp_f32 v69, v69
    s_waitcnt lgkmcnt(0)
    v_smfmac_f32_32x32x32_bf16 v[136:151], v[32:35], v[60:67], v26
    ds_read_b128 v[32:35], v103 offset:40640
    v_exp_f32 v70, v70
    v_exp_f32 v71, v71
    v_exp_f32 v72, v72
    v_mfma_f32_32x32x16_bf16 v[36:51], v[20:23], v[4:7], v[152:167]
    v_exp_f32 v73, v73
    v_exp_f32 v74, v74
    v_exp_f32 v75, v75
    v_mfma_f32_32x32x16_bf16 v[52:67], v[20:23], v[8:11], v[168:183]
    ds_read_b128 v[20:23], v27 offset:3072
    v_exp_f32 v76, v76
    v_exp_f32 v77, v77
    v_exp_f32 v78, v78
    v_exp_f32 v79, v79
    v_smfmac_f32_32x32x32_bf16 v[120:135], v[28:31], v[68:75], v26
    v_exp_f32 v80, v80
    v_exp_f32 v81, v81
    v_exp_f32 v82, v82
    v_exp_f32 v83, v83
    v_mfma_f32_32x32x4bf16_1k v[36:67], v[24:25], v[12:13], v[36:67]
    ds_read_b64 v[24:25], v102 offset:3072
    v_exp_f32 v84, v84
    v_exp_f32 v85, v85
    v_exp_f32 v86, v86
    v_exp_f32 v87, v87
    v_exp_f32 v88, v88
    v_exp_f32 v89, v89
    v_exp_f32 v90, v90
    s_waitcnt lgkmcnt(2)
    v_smfmac_f32_32x32x32_bf16 v[120:135], v[32:35], v[76:83], v26
    v_exp_f32 v91, v91
    v_exp_f32 v92, v92
    v_exp_f32 v93, v93
    v_exp_f32 v94, v94
    v_smfmac_f32_32x32x32_bf16 v[136:151], v[28:31], v[84:91], v26
    ds_read_b128 v[28:31], v103 offset:0
    v_exp_f32 v95, v95
    v_exp_f32 v96, v96
    v_exp_f32 v97, v97
    v_exp_f32 v98, v98
    v_exp_f32 v99, v99
    v_exp_f32 v36, v36
    v_exp_f32 v37, v37
    s_waitcnt lgkmcnt(0)
    v_smfmac_f32_32x32x32_bf16 v[136:151], v[32:35], v[92:99], v26
    ds_read_b128 v[32:35], v103 offset:704
    v_exp_f32 v38, v38
    v_exp_f32 v39, v39
    v_exp_f32 v40, v40
    v_mfma_f32_32x32x16_bf16 v[68:83], v[20:23], v[4:7], v[152:167]
    v_exp_f32 v41, v41
    v_exp_f32 v42, v42
    v_exp_f32 v43, v43
    v_mfma_f32_32x32x16_bf16 v[84:99], v[20:23], v[8:11], v[168:183]
    s_barrier
    ds_read_b128 v[20:23], v27 offset:12288
    v_exp_f32 v44, v44
    v_exp_f32 v45, v45
    v_exp_f32 v46, v46
    v_exp_f32 v47, v47
    v_smfmac_f32_32x32x32_bf16 v[120:135], v[28:31], v[36:43], v26
    v_exp_f32 v48, v48
    v_exp_f32 v49, v49
    v_exp_f32 v50, v50
    v_exp_f32 v51, v51
    v_mfma_f32_32x32x4bf16_1k v[68:99], v[24:25], v[12:13], v[68:99]
    ds_read_b64 v[24:25], v102 offset:12288
    v_exp_f32 v52, v52
    v_exp_f32 v53, v53
    v_exp_f32 v54, v54
    v_exp_f32 v55, v55
    v_exp_f32 v56, v56
    v_exp_f32 v57, v57
    v_exp_f32 v58, v58
    s_waitcnt lgkmcnt(2)
    v_smfmac_f32_32x32x32_bf16 v[120:135], v[32:35], v[44:51], v26
    v_exp_f32 v59, v59
    v_exp_f32 v60, v60
    v_exp_f32 v61, v61
    v_exp_f32 v62, v62
    v_smfmac_f32_32x32x32_bf16 v[136:151], v[28:31], v[52:59], v26
    ds_read_b128 v[28:31], v103 offset:3072
    v_exp_f32 v63, v63
    v_exp_f32 v64, v64
    v_exp_f32 v65, v65
    v_exp_f32 v66, v66
    v_exp_f32 v67, v67
    v_exp_f32 v68, v68
    v_exp_f32 v69, v69
    s_waitcnt lgkmcnt(0)
    v_smfmac_f32_32x32x32_bf16 v[136:151], v[32:35], v[60:67], v26
    ds_read_b128 v[32:35], v103 offset:3776
    v_exp_f32 v70, v70
    v_exp_f32 v71, v71
    v_exp_f32 v72, v72
    v_mfma_f32_32x32x16_bf16 v[36:51], v[20:23], v[4:7], v[152:167]
    v_exp_f32 v73, v73
    v_exp_f32 v74, v74
    v_exp_f32 v75, v75
    v_mfma_f32_32x32x16_bf16 v[52:67], v[20:23], v[8:11], v[168:183]
    ds_read_b128 v[20:23], v27 offset:15360
    v_exp_f32 v76, v76
    v_exp_f32 v77, v77
    v_exp_f32 v78, v78
    v_exp_f32 v79, v79
    v_smfmac_f32_32x32x32_bf16 v[120:135], v[28:31], v[68:75], v26
    v_exp_f32 v80, v80
    v_exp_f32 v81, v81
    v_exp_f32 v82, v82
    v_exp_f32 v83, v83
    v_mfma_f32_32x32x4bf16_1k v[36:67], v[24:25], v[12:13], v[36:67]
    ds_read_b64 v[24:25], v102 offset:15360
    v_exp_f32 v84, v84
    v_exp_f32 v85, v85
    v_exp_f32 v86, v86
    v_exp_f32 v87, v87
    v_exp_f32 v88, v88
    v_exp_f32 v89, v89
    v_exp_f32 v90, v90
    s_waitcnt lgkmcnt(2)
    v_smfmac_f32_32x32x32_bf16 v[120:135], v[32:35], v[76:83], v26
    v_exp_f32 v91, v91
    v_exp_f32 v92, v92
    v_exp_f32 v93, v93
    v_exp_f32 v94, v94
    v_smfmac_f32_32x32x32_bf16 v[136:151], v[28:31], v[84:91], v26
    ds_read_b128 v[28:31], v103 offset:12288
    v_exp_f32 v95, v95
    v_exp_f32 v96, v96
    v_exp_f32 v97, v97
    v_exp_f32 v98, v98
    v_exp_f32 v99, v99
    v_exp_f32 v36, v36
    v_exp_f32 v37, v37
    s_waitcnt lgkmcnt(0)
    v_smfmac_f32_32x32x32_bf16 v[136:151], v[32:35], v[92:99], v26
    ds_read_b128 v[32:35], v103 offset:12992
    v_exp_f32 v38, v38
    v_exp_f32 v39, v39
    v_exp_f32 v40, v40
    v_mfma_f32_32x32x16_bf16 v[68:83], v[20:23], v[4:7], v[152:167]
    v_exp_f32 v41, v41
    v_exp_f32 v42, v42
    v_exp_f32 v43, v43
    v_mfma_f32_32x32x16_bf16 v[84:99], v[20:23], v[8:11], v[168:183]
    s_waitcnt vmcnt(2)
    s_barrier
    s_add_u32 m0, s64, 0
    s_add_u32 s63, s63, 12288
    buffer_load_dwordx4 v14, s[28:31], s63 offen offset:0 sc1 lds
    buffer_load_dwordx4 v14, s[28:31], s63 offen offset:1024 sc1 lds
    buffer_load_dwordx4 v14, s[28:31], s63 offen offset:2048 sc1 lds
    s_add_u32 m0, s66, 65536
    s_nop 0
    buffer_load_dwordx4 v243, s[16:19], s65 offen lds
    s_add_u32 m0, s66, 73728
    s_nop 0
    buffer_load_dwordx4 v244, s[16:19], s65 offen lds
    ds_read_b128 v[20:23], v27 offset:24576
    v_exp_f32 v44, v44
    v_exp_f32 v45, v45
    v_exp_f32 v46, v46
    v_exp_f32 v47, v47
    v_smfmac_f32_32x32x32_bf16 v[120:135], v[28:31], v[36:43], v26
    v_exp_f32 v48, v48
    v_exp_f32 v49, v49
    v_exp_f32 v50, v50
    v_exp_f32 v51, v51
    v_mfma_f32_32x32x4bf16_1k v[68:99], v[24:25], v[12:13], v[68:99]
    ds_read_b64 v[24:25], v102 offset:24576
    v_exp_f32 v52, v52
    v_exp_f32 v53, v53
    v_exp_f32 v54, v54
    v_exp_f32 v55, v55
    v_exp_f32 v56, v56
    v_exp_f32 v57, v57
    v_exp_f32 v58, v58
    s_waitcnt lgkmcnt(2)
    v_smfmac_f32_32x32x32_bf16 v[120:135], v[32:35], v[44:51], v26
    v_exp_f32 v59, v59
    v_exp_f32 v60, v60
    v_exp_f32 v61, v61
    v_exp_f32 v62, v62
    v_smfmac_f32_32x32x32_bf16 v[136:151], v[28:31], v[52:59], v26
    ds_read_b128 v[28:31], v103 offset:15360
    v_exp_f32 v63, v63
    v_exp_f32 v64, v64
    v_exp_f32 v65, v65
    v_exp_f32 v66, v66
    v_exp_f32 v67, v67
    v_exp_f32 v68, v68
    v_exp_f32 v69, v69
    s_waitcnt lgkmcnt(0)
    v_smfmac_f32_32x32x32_bf16 v[136:151], v[32:35], v[60:67], v26
    ds_read_b128 v[32:35], v103 offset:16064
    v_exp_f32 v70, v70
    v_exp_f32 v71, v71
    v_exp_f32 v72, v72
    v_mfma_f32_32x32x16_bf16 v[36:51], v[20:23], v[4:7], v[152:167]
    v_exp_f32 v73, v73
    v_exp_f32 v74, v74
    v_exp_f32 v75, v75
    v_mfma_f32_32x32x16_bf16 v[52:67], v[20:23], v[8:11], v[168:183]
    ds_read_b128 v[20:23], v27 offset:27648
    v_exp_f32 v76, v76
    v_exp_f32 v77, v77
    v_exp_f32 v78, v78
    v_exp_f32 v79, v79
    v_smfmac_f32_32x32x32_bf16 v[120:135], v[28:31], v[68:75], v26
    v_exp_f32 v80, v80
    v_exp_f32 v81, v81
    v_exp_f32 v82, v82
    v_exp_f32 v83, v83
    v_mfma_f32_32x32x4bf16_1k v[36:67], v[24:25], v[12:13], v[36:67]
    ds_read_b64 v[24:25], v102 offset:27648
    v_exp_f32 v84, v84
    v_exp_f32 v85, v85
    v_exp_f32 v86, v86
    v_exp_f32 v87, v87
    v_exp_f32 v88, v88
    v_exp_f32 v89, v89
    v_exp_f32 v90, v90
    s_waitcnt lgkmcnt(2)
    v_smfmac_f32_32x32x32_bf16 v[120:135], v[32:35], v[76:83], v26
    v_exp_f32 v91, v91
    v_exp_f32 v92, v92
    v_exp_f32 v93, v93
    v_exp_f32 v94, v94
    v_smfmac_f32_32x32x32_bf16 v[136:151], v[28:31], v[84:91], v26
    ds_read_b128 v[28:31], v103 offset:24576
    v_exp_f32 v95, v95
    v_exp_f32 v96, v96
    v_exp_f32 v97, v97
    v_exp_f32 v98, v98
    v_exp_f32 v99, v99
    v_exp_f32 v36, v36
    v_exp_f32 v37, v37
    s_waitcnt lgkmcnt(0)
    v_smfmac_f32_32x32x32_bf16 v[136:151], v[32:35], v[92:99], v26
    ds_read_b128 v[32:35], v103 offset:25280
    v_exp_f32 v38, v38
    v_exp_f32 v39, v39
    v_exp_f32 v40, v40
    v_mfma_f32_32x32x16_bf16 v[68:83], v[20:23], v[4:7], v[152:167]
    v_exp_f32 v41, v41
    v_exp_f32 v42, v42
    v_exp_f32 v43, v43
    v_mfma_f32_32x32x16_bf16 v[84:99], v[20:23], v[8:11], v[168:183]
    s_barrier
    ds_read_b128 v[20:23], v27 offset:36864
    v_exp_f32 v44, v44
    v_exp_f32 v45, v45
    v_exp_f32 v46, v46
    v_exp_f32 v47, v47
    v_smfmac_f32_32x32x32_bf16 v[120:135], v[28:31], v[36:43], v26
    v_exp_f32 v48, v48
    v_exp_f32 v49, v49
    v_exp_f32 v50, v50
    v_exp_f32 v51, v51
    v_mfma_f32_32x32x4bf16_1k v[68:99], v[24:25], v[12:13], v[68:99]
    ds_read_b64 v[24:25], v102 offset:36864
    v_exp_f32 v52, v52
    v_exp_f32 v53, v53
    v_exp_f32 v54, v54
    v_exp_f32 v55, v55
    v_exp_f32 v56, v56
    v_exp_f32 v57, v57
    v_exp_f32 v58, v58
    s_waitcnt lgkmcnt(2)
    v_smfmac_f32_32x32x32_bf16 v[120:135], v[32:35], v[44:51], v26
    v_exp_f32 v59, v59
    v_exp_f32 v60, v60
    v_exp_f32 v61, v61
    v_exp_f32 v62, v62
    v_smfmac_f32_32x32x32_bf16 v[136:151], v[28:31], v[52:59], v26
    ds_read_b128 v[28:31], v103 offset:27648
    v_exp_f32 v63, v63
    v_exp_f32 v64, v64
    v_exp_f32 v65, v65
    v_exp_f32 v66, v66
    v_exp_f32 v67, v67
    v_exp_f32 v68, v68
    v_exp_f32 v69, v69
    s_waitcnt lgkmcnt(0)
    v_smfmac_f32_32x32x32_bf16 v[136:151], v[32:35], v[60:67], v26
    ds_read_b128 v[32:35], v103 offset:28352
    v_exp_f32 v70, v70
    v_exp_f32 v71, v71
    v_exp_f32 v72, v72
    v_mfma_f32_32x32x16_bf16 v[36:51], v[20:23], v[4:7], v[152:167]
    v_exp_f32 v73, v73
    v_exp_f32 v74, v74
    v_exp_f32 v75, v75
    v_mfma_f32_32x32x16_bf16 v[52:67], v[20:23], v[8:11], v[168:183]
    ds_read_b128 v[20:23], v27 offset:39936
    v_exp_f32 v76, v76
    v_exp_f32 v77, v77
    v_exp_f32 v78, v78
    v_exp_f32 v79, v79
    v_smfmac_f32_32x32x32_bf16 v[120:135], v[28:31], v[68:75], v26
    v_exp_f32 v80, v80
    v_exp_f32 v81, v81
    v_exp_f32 v82, v82
    v_exp_f32 v83, v83
    v_mfma_f32_32x32x4bf16_1k v[36:67], v[24:25], v[12:13], v[36:67]
    ds_read_b64 v[24:25], v102 offset:39936
    v_exp_f32 v84, v84
    v_exp_f32 v85, v85
    v_exp_f32 v86, v86
    v_exp_f32 v87, v87
    v_exp_f32 v88, v88
    v_exp_f32 v89, v89
    v_exp_f32 v90, v90
    s_waitcnt lgkmcnt(2)
    v_smfmac_f32_32x32x32_bf16 v[120:135], v[32:35], v[76:83], v26
    v_exp_f32 v91, v91
    v_exp_f32 v92, v92
    v_exp_f32 v93, v93
    v_exp_f32 v94, v94
    v_smfmac_f32_32x32x32_bf16 v[136:151], v[28:31], v[84:91], v26
    ds_read_b128 v[28:31], v103 offset:36864
    v_exp_f32 v95, v95
    v_exp_f32 v96, v96
    v_exp_f32 v97, v97
    v_exp_f32 v98, v98
    v_exp_f32 v99, v99
    v_exp_f32 v36, v36
    v_exp_f32 v37, v37
    s_waitcnt lgkmcnt(0)
    v_smfmac_f32_32x32x32_bf16 v[136:151], v[32:35], v[92:99], v26
    ds_read_b128 v[32:35], v103 offset:37568
    v_exp_f32 v38, v38
    v_exp_f32 v39, v39
    v_exp_f32 v40, v40
    v_mfma_f32_32x32x16_bf16 v[68:83], v[20:23], v[4:7], v[152:167]
    v_exp_f32 v41, v41
    v_exp_f32 v42, v42
    v_exp_f32 v43, v43
    v_mfma_f32_32x32x16_bf16 v[84:99], v[20:23], v[8:11], v[168:183]
    s_waitcnt vmcnt(2)
    s_barrier
    s_add_u32 m0, s64, 24576
    s_add_u32 s63, s63, 12288
    buffer_load_dwordx4 v14, s[28:31], s63 offen offset:0 sc1 lds
    buffer_load_dwordx4 v14, s[28:31], s63 offen offset:1024 sc1 lds
    buffer_load_dwordx4 v14, s[28:31], s63 offen offset:2048 sc1 lds
    s_add_u32 s65, s65, 327680
    s_add_u32 m0, s66, 81920
    s_nop 0
    buffer_load_dwordx4 v240, s[16:19], s65 offen lds
    s_add_u32 m0, s66, 90112
    s_nop 0
    buffer_load_dwordx4 v241, s[16:19], s65 offen lds
    ds_read_b128 v[20:23], v27 offset:0
    v_exp_f32 v44, v44
    v_exp_f32 v45, v45
    v_exp_f32 v46, v46
    v_exp_f32 v47, v47
    v_smfmac_f32_32x32x32_bf16 v[120:135], v[28:31], v[36:43], v26
    v_exp_f32 v48, v48
    v_exp_f32 v49, v49
    v_exp_f32 v50, v50
    v_exp_f32 v51, v51
    v_mfma_f32_32x32x4bf16_1k v[68:99], v[24:25], v[12:13], v[68:99]
    ds_read_b64 v[24:25], v102 offset:0
    v_exp_f32 v52, v52
    v_exp_f32 v53, v53
    v_exp_f32 v54, v54
    v_exp_f32 v55, v55
    v_exp_f32 v56, v56
    v_exp_f32 v57, v57
    v_exp_f32 v58, v58
    s_waitcnt lgkmcnt(2)
    v_smfmac_f32_32x32x32_bf16 v[120:135], v[32:35], v[44:51], v26
    v_exp_f32 v59, v59
    v_exp_f32 v60, v60
    v_exp_f32 v61, v61
    v_exp_f32 v62, v62
    v_smfmac_f32_32x32x32_bf16 v[136:151], v[28:31], v[52:59], v26
    ds_read_b128 v[28:31], v103 offset:39936
    v_exp_f32 v63, v63
    v_exp_f32 v64, v64
    v_exp_f32 v65, v65
    v_exp_f32 v66, v66
    v_exp_f32 v67, v67
    v_exp_f32 v68, v68
    v_exp_f32 v69, v69
    s_waitcnt lgkmcnt(0)
    v_smfmac_f32_32x32x32_bf16 v[136:151], v[32:35], v[60:67], v26
    ds_read_b128 v[32:35], v103 offset:40640
    v_exp_f32 v70, v70
    v_exp_f32 v71, v71
    v_exp_f32 v72, v72
    v_mfma_f32_32x32x16_bf16 v[36:51], v[20:23], v[4:7], v[152:167]
    v_exp_f32 v73, v73
    v_exp_f32 v74, v74
    v_exp_f32 v75, v75
    v_mfma_f32_32x32x16_bf16 v[52:67], v[20:23], v[8:11], v[168:183]
    ds_read_b128 v[20:23], v27 offset:3072
    v_exp_f32 v76, v76
    v_exp_f32 v77, v77
    v_exp_f32 v78, v78
    v_exp_f32 v79, v79
    v_smfmac_f32_32x32x32_bf16 v[120:135], v[28:31], v[68:75], v26
    v_exp_f32 v80, v80
    v_exp_f32 v81, v81
    v_exp_f32 v82, v82
    v_exp_f32 v83, v83
    v_mfma_f32_32x32x4bf16_1k v[36:67], v[24:25], v[12:13], v[36:67]
    ds_read_b64 v[24:25], v102 offset:3072
    v_exp_f32 v84, v84
    v_exp_f32 v85, v85
    v_exp_f32 v86, v86
    v_exp_f32 v87, v87
    v_exp_f32 v88, v88
    v_exp_f32 v89, v89
    v_exp_f32 v90, v90
    s_waitcnt lgkmcnt(2)
    v_smfmac_f32_32x32x32_bf16 v[120:135], v[32:35], v[76:83], v26
    v_exp_f32 v91, v91
    v_exp_f32 v92, v92
    v_exp_f32 v93, v93
    v_exp_f32 v94, v94
    v_smfmac_f32_32x32x32_bf16 v[136:151], v[28:31], v[84:91], v26
    ds_read_b128 v[28:31], v103 offset:0
    v_exp_f32 v95, v95
    v_exp_f32 v96, v96
    v_exp_f32 v97, v97
    v_exp_f32 v98, v98
    v_exp_f32 v99, v99
    v_exp_f32 v36, v36
    v_exp_f32 v37, v37
    s_waitcnt lgkmcnt(0)
    v_smfmac_f32_32x32x32_bf16 v[136:151], v[32:35], v[92:99], v26
    ds_read_b128 v[32:35], v103 offset:704
    v_exp_f32 v38, v38
    v_exp_f32 v39, v39
    v_exp_f32 v40, v40
    v_mfma_f32_32x32x16_bf16 v[68:83], v[20:23], v[4:7], v[152:167]
    v_exp_f32 v41, v41
    v_exp_f32 v42, v42
    v_exp_f32 v43, v43
    v_mfma_f32_32x32x16_bf16 v[84:99], v[20:23], v[8:11], v[168:183]
    s_barrier
    ds_read_b128 v[20:23], v27 offset:12288
    v_exp_f32 v44, v44
    v_exp_f32 v45, v45
    v_exp_f32 v46, v46
    v_exp_f32 v47, v47
    v_smfmac_f32_32x32x32_bf16 v[120:135], v[28:31], v[36:43], v26
    v_exp_f32 v48, v48
    v_exp_f32 v49, v49
    v_exp_f32 v50, v50
    v_exp_f32 v51, v51
    v_mfma_f32_32x32x4bf16_1k v[68:99], v[24:25], v[12:13], v[68:99]
    ds_read_b64 v[24:25], v102 offset:12288
    v_exp_f32 v52, v52
    v_exp_f32 v53, v53
    v_exp_f32 v54, v54
    v_exp_f32 v55, v55
    v_exp_f32 v56, v56
    v_exp_f32 v57, v57
    v_exp_f32 v58, v58
    s_waitcnt lgkmcnt(2)
    v_smfmac_f32_32x32x32_bf16 v[120:135], v[32:35], v[44:51], v26
    v_exp_f32 v59, v59
    v_exp_f32 v60, v60
    v_exp_f32 v61, v61
    v_exp_f32 v62, v62
    v_smfmac_f32_32x32x32_bf16 v[136:151], v[28:31], v[52:59], v26
    ds_read_b128 v[28:31], v103 offset:3072
    v_exp_f32 v63, v63
    v_exp_f32 v64, v64
    v_exp_f32 v65, v65
    v_exp_f32 v66, v66
    v_exp_f32 v67, v67
    v_exp_f32 v68, v68
    v_exp_f32 v69, v69
    s_waitcnt lgkmcnt(0)
    v_smfmac_f32_32x32x32_bf16 v[136:151], v[32:35], v[60:67], v26
    ds_read_b128 v[32:35], v103 offset:3776
    v_exp_f32 v70, v70
    v_exp_f32 v71, v71
    v_exp_f32 v72, v72
    v_mfma_f32_32x32x16_bf16 v[36:51], v[20:23], v[4:7], v[152:167]
    v_exp_f32 v73, v73
    v_exp_f32 v74, v74
    v_exp_f32 v75, v75
    v_mfma_f32_32x32x16_bf16 v[52:67], v[20:23], v[8:11], v[168:183]
    ds_read_b128 v[20:23], v27 offset:15360
    v_exp_f32 v76, v76
    v_exp_f32 v77, v77
    v_exp_f32 v78, v78
    v_exp_f32 v79, v79
    v_smfmac_f32_32x32x32_bf16 v[120:135], v[28:31], v[68:75], v26
    v_exp_f32 v80, v80
    v_exp_f32 v81, v81
    v_exp_f32 v82, v82
    v_exp_f32 v83, v83
    v_mfma_f32_32x32x4bf16_1k v[36:67], v[24:25], v[12:13], v[36:67]
    ds_read_b64 v[24:25], v102 offset:15360
    v_exp_f32 v84, v84
    v_exp_f32 v85, v85
    v_exp_f32 v86, v86
    v_exp_f32 v87, v87
    v_exp_f32 v88, v88
    v_exp_f32 v89, v89
    v_exp_f32 v90, v90
    s_waitcnt lgkmcnt(2)
    v_smfmac_f32_32x32x32_bf16 v[120:135], v[32:35], v[76:83], v26
    v_exp_f32 v91, v91
    v_exp_f32 v92, v92
    v_exp_f32 v93, v93
    v_exp_f32 v94, v94
    v_smfmac_f32_32x32x32_bf16 v[136:151], v[28:31], v[84:91], v26
    ds_read_b128 v[28:31], v103 offset:12288
    v_exp_f32 v95, v95
    v_exp_f32 v96, v96
    v_exp_f32 v97, v97
    v_exp_f32 v98, v98
    v_exp_f32 v99, v99
    v_exp_f32 v36, v36
    v_exp_f32 v37, v37
    s_waitcnt lgkmcnt(0)
    v_smfmac_f32_32x32x32_bf16 v[136:151], v[32:35], v[92:99], v26
    ds_read_b128 v[32:35], v103 offset:12992
    v_exp_f32 v38, v38
    v_exp_f32 v39, v39
    v_exp_f32 v40, v40
    v_mfma_f32_32x32x16_bf16 v[68:83], v[20:23], v[4:7], v[152:167]
    v_exp_f32 v41, v41
    v_exp_f32 v42, v42
    v_exp_f32 v43, v43
    v_mfma_f32_32x32x16_bf16 v[84:99], v[20:23], v[8:11], v[168:183]
    s_waitcnt vmcnt(2)
    s_barrier
    s_add_u32 m0, s66, 98304
    s_nop 0
    buffer_load_dwordx4 v242, s[16:19], s65 offen lds
    ds_read_b128 v[20:23], v27 offset:24576
    v_exp_f32 v44, v44
    v_exp_f32 v45, v45
    v_exp_f32 v46, v46
    v_exp_f32 v47, v47
    v_smfmac_f32_32x32x32_bf16 v[120:135], v[28:31], v[36:43], v26
    v_exp_f32 v48, v48
    v_exp_f32 v49, v49
    v_exp_f32 v50, v50
    v_exp_f32 v51, v51
    v_mfma_f32_32x32x4bf16_1k v[68:99], v[24:25], v[12:13], v[68:99]
    ds_read_b64 v[24:25], v102 offset:24576
    v_exp_f32 v52, v52
    v_exp_f32 v53, v53
    v_exp_f32 v54, v54
    v_exp_f32 v55, v55
    v_exp_f32 v56, v56
    v_exp_f32 v57, v57
    v_exp_f32 v58, v58
    s_waitcnt lgkmcnt(2)
    v_smfmac_f32_32x32x32_bf16 v[120:135], v[32:35], v[44:51], v26
    v_exp_f32 v59, v59
    v_exp_f32 v60, v60
    v_exp_f32 v61, v61
    v_exp_f32 v62, v62
    v_smfmac_f32_32x32x32_bf16 v[136:151], v[28:31], v[52:59], v26
    ds_read_b128 v[28:31], v103 offset:15360
    v_exp_f32 v63, v63
    v_exp_f32 v64, v64
    v_exp_f32 v65, v65
    v_exp_f32 v66, v66
    v_exp_f32 v67, v67
    v_exp_f32 v68, v68
    v_exp_f32 v69, v69
    s_waitcnt lgkmcnt(0)
    v_smfmac_f32_32x32x32_bf16 v[136:151], v[32:35], v[60:67], v26
    ds_read_b128 v[32:35], v103 offset:16064
    v_exp_f32 v70, v70
    v_exp_f32 v71, v71
    v_exp_f32 v72, v72
    v_mfma_f32_32x32x16_bf16 v[36:51], v[20:23], v[4:7], v[152:167]
    v_exp_f32 v73, v73
    v_exp_f32 v74, v74
    v_exp_f32 v75, v75
    v_mfma_f32_32x32x16_bf16 v[52:67], v[20:23], v[8:11], v[168:183]
    ds_read_b128 v[20:23], v27 offset:27648
    v_exp_f32 v76, v76
    v_exp_f32 v77, v77
    v_exp_f32 v78, v78
    v_exp_f32 v79, v79
    v_smfmac_f32_32x32x32_bf16 v[120:135], v[28:31], v[68:75], v26
    v_exp_f32 v80, v80
    v_exp_f32 v81, v81
    v_exp_f32 v82, v82
    v_exp_f32 v83, v83
    v_mfma_f32_32x32x4bf16_1k v[36:67], v[24:25], v[12:13], v[36:67]
    ds_read_b64 v[24:25], v102 offset:27648
    v_exp_f32 v84, v84
    v_exp_f32 v85, v85
    v_exp_f32 v86, v86
    v_exp_f32 v87, v87
    v_exp_f32 v88, v88
    v_exp_f32 v89, v89
    v_exp_f32 v90, v90
    s_waitcnt lgkmcnt(2)
    v_smfmac_f32_32x32x32_bf16 v[120:135], v[32:35], v[76:83], v26
    v_exp_f32 v91, v91
    v_exp_f32 v92, v92
    v_exp_f32 v93, v93
    v_exp_f32 v94, v94
    v_smfmac_f32_32x32x32_bf16 v[136:151], v[28:31], v[84:91], v26
    ds_read_b128 v[28:31], v103 offset:24576
    v_exp_f32 v95, v95
    v_exp_f32 v96, v96
    v_exp_f32 v97, v97
    v_exp_f32 v98, v98
    v_exp_f32 v99, v99
    v_exp_f32 v36, v36
    v_exp_f32 v37, v37
    s_waitcnt lgkmcnt(0)
    v_smfmac_f32_32x32x32_bf16 v[136:151], v[32:35], v[92:99], v26
    ds_read_b128 v[32:35], v103 offset:25280
    v_exp_f32 v38, v38
    v_exp_f32 v39, v39
    v_exp_f32 v40, v40
    v_mfma_f32_32x32x16_bf16 v[68:83], v[20:23], v[4:7], v[152:167]
    v_exp_f32 v41, v41
    v_exp_f32 v42, v42
    v_exp_f32 v43, v43
    v_mfma_f32_32x32x16_bf16 v[84:99], v[20:23], v[8:11], v[168:183]
    s_barrier
    ds_read_b128 v[20:23], v27 offset:36864
    v_exp_f32 v44, v44
    v_exp_f32 v45, v45
    v_exp_f32 v46, v46
    v_exp_f32 v47, v47
    v_smfmac_f32_32x32x32_bf16 v[120:135], v[28:31], v[36:43], v26
    v_exp_f32 v48, v48
    v_exp_f32 v49, v49
    v_exp_f32 v50, v50
    v_exp_f32 v51, v51
    v_mfma_f32_32x32x4bf16_1k v[68:99], v[24:25], v[12:13], v[68:99]
    ds_read_b64 v[24:25], v102 offset:36864
    v_exp_f32 v52, v52
    v_exp_f32 v53, v53
    v_exp_f32 v54, v54
    v_exp_f32 v55, v55
    v_exp_f32 v56, v56
    v_exp_f32 v57, v57
    v_exp_f32 v58, v58
    s_waitcnt lgkmcnt(2)
    v_smfmac_f32_32x32x32_bf16 v[120:135], v[32:35], v[44:51], v26
    v_exp_f32 v59, v59
    v_exp_f32 v60, v60
    v_exp_f32 v61, v61
    v_exp_f32 v62, v62
    v_smfmac_f32_32x32x32_bf16 v[136:151], v[28:31], v[52:59], v26
    ds_read_b128 v[28:31], v103 offset:27648
    v_exp_f32 v63, v63
    v_exp_f32 v64, v64
    v_exp_f32 v65, v65
    v_exp_f32 v66, v66
    v_exp_f32 v67, v67
    v_exp_f32 v68, v68
    v_exp_f32 v69, v69
    s_waitcnt lgkmcnt(0)
    v_smfmac_f32_32x32x32_bf16 v[136:151], v[32:35], v[60:67], v26
    ds_read_b128 v[32:35], v103 offset:28352
    v_exp_f32 v70, v70
    v_exp_f32 v71, v71
    v_exp_f32 v72, v72
    v_mfma_f32_32x32x16_bf16 v[36:51], v[20:23], v[4:7], v[152:167]
    v_exp_f32 v73, v73
    v_exp_f32 v74, v74
    v_exp_f32 v75, v75
    v_mfma_f32_32x32x16_bf16 v[52:67], v[20:23], v[8:11], v[168:183]
    ds_read_b128 v[20:23], v27 offset:39936
    v_exp_f32 v76, v76
    v_exp_f32 v77, v77
    v_exp_f32 v78, v78
    v_exp_f32 v79, v79
    v_smfmac_f32_32x32x32_bf16 v[120:135], v[28:31], v[68:75], v26
    v_exp_f32 v80, v80
    v_exp_f32 v81, v81
    v_exp_f32 v82, v82
    v_exp_f32 v83, v83
    v_mfma_f32_32x32x4bf16_1k v[36:67], v[24:25], v[12:13], v[36:67]
    ds_read_b64 v[24:25], v102 offset:39936
    v_exp_f32 v84, v84
    v_exp_f32 v85, v85
    v_exp_f32 v86, v86
    v_exp_f32 v87, v87
    v_exp_f32 v88, v88
    v_exp_f32 v89, v89
    v_exp_f32 v90, v90
    s_waitcnt lgkmcnt(2)
    v_smfmac_f32_32x32x32_bf16 v[120:135], v[32:35], v[76:83], v26
    v_exp_f32 v91, v91
    v_exp_f32 v92, v92
    v_exp_f32 v93, v93
    v_exp_f32 v94, v94
    v_smfmac_f32_32x32x32_bf16 v[136:151], v[28:31], v[84:91], v26
    ds_read_b128 v[28:31], v103 offset:36864
    v_exp_f32 v95, v95
    v_exp_f32 v96, v96
    v_exp_f32 v97, v97
    v_exp_f32 v98, v98
    v_exp_f32 v99, v99
    v_exp_f32 v36, v36
    v_exp_f32 v37, v37
    s_waitcnt lgkmcnt(0)
    v_smfmac_f32_32x32x32_bf16 v[136:151], v[32:35], v[92:99], v26
    ds_read_b128 v[32:35], v103 offset:37568
    v_exp_f32 v38, v38
    v_exp_f32 v39, v39
    v_exp_f32 v40, v40
    v_mfma_f32_32x32x16_bf16 v[68:83], v[20:23], v[4:7], v[152:167]
    v_exp_f32 v41, v41
    v_exp_f32 v42, v42
    v_exp_f32 v43, v43
    v_mfma_f32_32x32x16_bf16 v[84:99], v[20:23], v[8:11], v[168:183]
    v_exp_f32 v44, v44
    v_exp_f32 v45, v45
    v_exp_f32 v46, v46
    v_exp_f32 v47, v47
    v_smfmac_f32_32x32x32_bf16 v[120:135], v[28:31], v[36:43], v26
    v_exp_f32 v48, v48
    v_exp_f32 v49, v49
    v_exp_f32 v50, v50
    v_exp_f32 v51, v51
    s_nop 0
    v_mfma_f32_32x32x4bf16_1k v[68:99], v[24:25], v[12:13], v[68:99]
    v_exp_f32 v52, v52
    v_exp_f32 v53, v53
    v_exp_f32 v54, v54
    v_exp_f32 v55, v55
    v_exp_f32 v56, v56
    v_exp_f32 v57, v57
    v_exp_f32 v58, v58
    s_waitcnt lgkmcnt(0)
    v_smfmac_f32_32x32x32_bf16 v[120:135], v[32:35], v[44:51], v26
    v_exp_f32 v59, v59
    v_exp_f32 v60, v60
    v_exp_f32 v61, v61
    v_exp_f32 v62, v62
    v_smfmac_f32_32x32x32_bf16 v[136:151], v[28:31], v[52:59], v26
    ds_read_b128 v[28:31], v103 offset:39936
    v_exp_f32 v63, v63
    v_exp_f32 v64, v64
    v_exp_f32 v65, v65
    v_exp_f32 v66, v66
    v_exp_f32 v67, v67
    v_exp_f32 v68, v68
    v_exp_f32 v69, v69
    s_waitcnt lgkmcnt(0)
    v_smfmac_f32_32x32x32_bf16 v[136:151], v[32:35], v[60:67], v26
    ds_read_b128 v[32:35], v103 offset:40640
    v_exp_f32 v70, v70
    v_exp_f32 v71, v71
    v_exp_f32 v72, v72
    v_exp_f32 v73, v73
    v_exp_f32 v74, v74
    v_exp_f32 v75, v75
    v_exp_f32 v76, v76
    v_exp_f32 v77, v77
    v_exp_f32 v78, v78
    v_exp_f32 v79, v79
    v_smfmac_f32_32x32x32_bf16 v[120:135], v[28:31], v[68:75], v26
    v_exp_f32 v80, v80
    v_exp_f32 v81, v81
    v_exp_f32 v82, v82
    v_exp_f32 v83, v83
    v_exp_f32 v84, v84
    v_exp_f32 v85, v85
    v_exp_f32 v86, v86
    v_exp_f32 v87, v87
    v_exp_f32 v88, v88
    v_exp_f32 v89, v89
    v_exp_f32 v90, v90
    s_waitcnt lgkmcnt(0)
    v_smfmac_f32_32x32x32_bf16 v[120:135], v[32:35], v[76:83], v26
    v_exp_f32 v91, v91
    v_exp_f32 v92, v92
    v_exp_f32 v93, v93
    v_exp_f32 v94, v94
    v_smfmac_f32_32x32x32_bf16 v[136:151], v[28:31], v[84:91], v26
    v_exp_f32 v95, v95
    v_exp_f32 v96, v96
    v_exp_f32 v97, v97
    v_exp_f32 v98, v98
    v_exp_f32 v99, v99
    s_lshl_b32 s63, s56, 1
    s_and_b32 s63, s63, 6
    s_mul_i32 s63, s63, 3072
    v_smfmac_f32_32x32x32_bf16 v[136:151], v[32:35], v[92:99], v26
    s_setprio 0
    v_add_u32 v1, s63, v14
    s_nop 9
    ds_write_b128 v1, v[136:139] offset:0
    ds_write_b128 v1, v[140:143] offset:1024
    ds_write_b128 v1, v[144:147] offset:2048
    s_waitcnt lgkmcnt(0)
    s_barrier
    ds_read_b128 v[36:39], v1 offset:3072
    ds_read_b128 v[40:43], v1 offset:4096
    ds_read_b128 v[44:47], v1 offset:5120
    s_mul_i32 s63, s57, 81920
    s_add_u32 s63, s63, 1048576
    s_add_u32 s64, s63, 65536
    s_and_b32 s65, s56, 3
    s_lshl_b32 s66, s58, 2
    s_add_u32 s66, s66, s65
    s_lshl_b32 s67, s66, 9
    s_add_u32 s63, s63, s67
    s_lshl_b32 s67, s66, 7
    s_add_u32 s64, s64, s67
    v_and_b32 v1, 15, v0
    v_bfe_u32 v2, v0, 4, 1
    v_lshrrev_b32 v3, 5, v0
    v_lshlrev_b32 v232, 4, v1
    v_lshl_add_u32 v232, v3, 8, v232
    v_lshl_add_u32 v232, v2, 14, v232
    v_lshlrev_b32 v233, 3, v1
    v_lshl_add_u32 v233, v2, 12, v233
    s_waitcnt lgkmcnt(0)
    v_mov_b32 v1, 60416
    v_mov_b32 v2, 1
    s_mov_b64 exec, 1
    ds_add_u32 v1, v2 offset:48
    s_mov_b64 exec, -1
    v_add_f32 v234, v128, v44
    v_add_f32 v235, v128, v44
    v_pk_add_f32 v[120:121], v[120:121], v[36:37]
    v_pk_add_f32 v[122:123], v[122:123], v[38:39]
    v_pk_add_f32 v[124:125], v[124:125], v[40:41]
    v_pk_add_f32 v[126:127], v[126:127], v[42:43]
    v_pk_add_f32 v[128:129], v[128:129], v[44:45]
    v_pk_add_f32 v[130:131], v[130:131], v[46:47]
    v_permlane32_swap_b32 v234, v235
    v_rcp_f32 v235, v235
    s_nop 0
    v_mul_f32 v120, v120, v235
    v_mul_f32 v121, v121, v235
    v_mul_f32 v122, v122, v235
    v_mul_f32 v123, v123, v235
    v_mul_f32 v124, v124, v235
    v_mul_f32 v125, v125, v235
    v_mul_f32 v126, v126, v235
    v_mul_f32 v127, v127, v235
    v_mul_f32 v128, v128, v235
    v_mul_f32 v129, v129, v235
    v_mul_f32 v130, v130, v235
    v_mul_f32 v131, v131, v235
    v_cvt_pk_bf16_f32 v224, v120, v121
    v_cvt_pk_bf16_f32 v225, v122, v123
    v_cvt_pk_bf16_f32 v226, v124, v125
    v_cvt_pk_bf16_f32 v227, v126, v127
    v_cvt_pk_bf16_f32 v228, v128, v129
    v_cvt_pk_bf16_f32 v229, v130, v131
    buffer_store_dwordx4 v[224:227], v232, s[28:31], s63 offen sc1
    s_mov_b32 exec_hi, 0
    buffer_store_dwordx2 v[228:229], v233, s[28:31], s64 offen sc1
    s_mov_b32 exec_hi, -1
    v_lshrrev_b32 v2, 4, v0
    v_bfe_u32 v3, v0, 2, 2
    v_and_b32 v1, 3, v0
    v_lshlrev_b32 v1, 3, v1
    v_lshrrev_b32 v224, 1, v2
    v_and_b32 v2, 1, v2
    v_mul_u32_u24 v225, 20, v224
    v_lshl_add_u32 v225, v2, 2, v225
    v_add_u32 v225, v225, v3
    v_mul_u32_u24 v225, 160, v225
    v_add_u32 v225, v225, v1
    v_add_u32 v236, 61440, v225
    v_add_u32 v237, 125440, v225
    v_mul_u32_u24 v225, 80, v224
    v_mul_u32_u24 v226, 40, v2
    v_add3_u32 v225, v225, v226, v3
    v_mul_u32_u24 v225, 160, v225
    v_add_u32 v225, v225, v1
    v_add_u32 v238, 64000, v225
    v_add_u32 v239, 115200, v225
    v_and_b32 v1, 15, v0
    v_lshlrev_b32 v240, 3, v1
    v_lshl_add_u32 v240, v224, 9, v240
    v_lshl_add_u32 v240, v2, 8, v240
    v_mul_u32_u24 v241, 2560, v1
    v_lshrrev_b32 v3, 4, v0
    v_lshl_add_u32 v242, v3, 3, v241
    v_lshl_add_u32 v241, v2, 5, v241
    v_lshl_add_u32 v241, v224, 4, v241
    v_and_b32 v1, 7, v0
    v_lshlrev_b32 v243, 7, v1
    s_lshl_b32 s67, s57, 10
    s_add_u32 s67, s67, 4194304
    s_waitcnt vmcnt(0)
    v_mov_b32 v1, 60416
    v_mov_b32 v2, 1
    s_mov_b64 exec, 1
    ds_add_u32 v1, v2 offset:36
    s_mov_b64 exec, -1
    v_mov_b32 v1, 60416
    s_mov_b32 s69, 200000
L_lw_17:
    ds_read_b32 v2, v1 offset:36
    s_sub_u32 s69, s69, 1
    s_waitcnt lgkmcnt(0)
    v_readfirstlane_b32 s65, v2
    s_cmp_ge_u32 s65, 8
    s_cbranch_scc1 L_lg_18
    s_sleep 1
    s_cmp_lg_u32 s69, 0
    s_cbranch_scc1 L_lw_17
L_lg_18:
    s_cmp_lg_u32 s56, 0
    s_cbranch_scc1 L_noof
    s_lshl_b32 s63, s58, 7
    s_add_u32 s63, s63, s67
    v_mov_b32 v2, s61
    v_mov_b32 v3, 0
    v_mov_b32 v1, 0
    s_mov_b64 exec, 1
    buffer_store_dwordx2 v[2:3], v1, s[28:31], s63 offen sc1
    s_mov_b64 exec, -1
L_noof:
    ds_read_b64_tr_b16 v[200:201], v236 offset:0
    ds_read_b64_tr_b16 v[202:203], v236 offset:1280
    ds_read_b64_tr_b16 v[204:205], v236 offset:32
    ds_read_b64_tr_b16 v[206:207], v236 offset:1312
    ds_read_b64_tr_b16 v[208:209], v236 offset:64
    ds_read_b64_tr_b16 v[210:211], v236 offset:1344
    ds_read_b64_tr_b16 v[212:213], v236 offset:96
    ds_read_b64_tr_b16 v[214:215], v236 offset:1376
    ds_read_b64_tr_b16 v[216:217], v236 offset:128
    ds_read_b64_tr_b16 v[218:219], v236 offset:1408
    s_cmp_lg_u32 s56, 0
    s_cbranch_scc1 L_owait
    s_mov_b32 s69, 200000
    s_mov_b64 exec, 0xff
L_opoll:
    buffer_load_dword v1, v243, s[28:31], s67 offen sc1
    s_sub_u32 s69, s69, 1
    s_waitcnt vmcnt(0)
    v_cmp_ne_u32 vcc, s61, v1
    s_cbranch_vccz L_oready
    s_mov_b64 exec, vcc
    s_cmp_eq_u32 s69, 0
    s_cbranch_scc1 L_oready
    s_sleep 1
    s_branch L_opoll
L_oready:
    s_mov_b64 exec, -1
    v_mov_b32 v1, 60416
    v_mov_b32 v2, 1
    s_mov_b64 exec, 1
    ds_add_u32 v1, v2 offset:44
    s_mov_b64 exec, -1
    s_branch L_ogo
L_owait:
    v_mov_b32 v1, 60416
    s_mov_b32 s69, 200000
L_lw_19:
    ds_read_b32 v2, v1 offset:44
    s_sub_u32 s69, s69, 1
    s_waitcnt lgkmcnt(0)
    v_readfirstlane_b32 s65, v2
    s_cmp_ge_u32 s65, 1
    s_cbranch_scc1 L_lg_20
    s_sleep 1
    s_cmp_lg_u32 s69, 0
    s_cbranch_scc1 L_lw_19
L_lg_20:
L_ogo:
    s_waitcnt lgkmcnt(0)
    s_setprio 0
    s_mul_i32 s63, s57, 81920
    s_lshl_b32 s64, s56, 14
    s_add_u32 s64, s64, s63
    s_add_u32 s64, s64, 1048576
    s_lshl_b32 s65, s56, 12
    s_add_u32 s65, s65, s63
    s_add_u32 s65, s65, 1114112
    buffer_load_dwordx4 v[120:123], v14, s[28:31], s64 offen offset:0 sc1
    buffer_load_dwordx4 v[124:127], v14, s[28:31], s64 offen offset:1024 sc1
    buffer_load_dwordx4 v[128:131], v14, s[28:31], s64 offen offset:2048 sc1
    buffer_load_dwordx4 v[132:135], v14, s[28:31], s64 offen offset:3072 sc1
    s_add_u32 s64, s64, 4096
    buffer_load_dwordx4 v[136:139], v14, s[28:31], s64 offen offset:0 sc1
    buffer_load_dwordx4 v[140:143], v14, s[28:31], s64 offen offset:1024 sc1
    buffer_load_dwordx4 v[144:147], v14, s[28:31], s64 offen offset:2048 sc1
    buffer_load_dwordx4 v[148:151], v14, s[28:31], s64 offen offset:3072 sc1
    s_add_u32 s64, s64, 4096
    buffer_load_dwordx4 v[152:155], v14, s[28:31], s64 offen offset:0 sc1
    buffer_load_dwordx4 v[156:159], v14, s[28:31], s64 offen offset:1024 sc1
    buffer_load_dwordx4 v[160:163], v14, s[28:31], s64 offen offset:2048 sc1
    buffer_load_dwordx4 v[164:167], v14, s[28:31], s64 offen offset:3072 sc1
    s_add_u32 s64, s64, 4096
    buffer_load_dwordx4 v[168:171], v14, s[28:31], s64 offen offset:0 sc1
    buffer_load_dwordx4 v[172:175], v14, s[28:31], s64 offen offset:1024 sc1
    buffer_load_dwordx4 v[176:179], v14, s[28:31], s64 offen offset:2048 sc1
    buffer_load_dwordx4 v[180:183], v14, s[28:31], s64 offen offset:3072 sc1
    buffer_load_dwordx2 v[184:185], v240, s[28:31], s65 offen offset:0 sc1
    buffer_load_dwordx2 v[186:187], v240, s[28:31], s65 offen offset:128 sc1
    buffer_load_dwordx2 v[188:189], v240, s[28:31], s65 offen offset:1024 sc1
    buffer_load_dwordx2 v[190:191], v240, s[28:31], s65 offen offset:1152 sc1
    buffer_load_dwordx2 v[192:193], v240, s[28:31], s65 offen offset:2048 sc1
    buffer_load_dwordx2 v[194:195], v240, s[28:31], s65 offen offset:2176 sc1
    buffer_load_dwordx2 v[196:197], v240, s[28:31], s65 offen offset:3072 sc1
    buffer_load_dwordx2 v[198:199], v240, s[28:31], s65 offen offset:3200 sc1
    s_waitcnt vmcnt(23)
    v_mfma_f32_16x16x32_bf16 v[36:39], v[200:203], v[120:123], 0
    ds_read_b64_tr_b16 v[200:201], v236 offset:6400
    ds_read_b64_tr_b16 v[202:203], v236 offset:7680
    v_mfma_f32_16x16x32_bf16 v[40:43], v[204:207], v[120:123], 0
    ds_read_b64_tr_b16 v[204:205], v236 offset:6432
    ds_read_b64_tr_b16 v[206:207], v236 offset:7712
    v_mfma_f32_16x16x32_bf16 v[44:47], v[208:211], v[120:123], 0
    ds_read_b64_tr_b16 v[208:209], v236 offset:6464
    ds_read_b64_tr_b16 v[210:211], v236 offset:7744
    v_mfma_f32_16x16x32_bf16 v[48:51], v[212:215], v[120:123], 0
    ds_read_b64_tr_b16 v[212:213], v236 offset:6496
    ds_read_b64_tr_b16 v[214:215], v236 offset:7776
    v_mfma_f32_16x16x32_bf16 v[52:55], v[216:219], v[120:123], 0
    ds_read_b64_tr_b16 v[216:217], v236 offset:6528
    ds_read_b64_tr_b16 v[218:219], v236 offset:7808
    s_waitcnt vmcnt(22)
    s_waitcnt lgkmcnt(8)
    v_mfma_f32_16x16x32_bf16 v[36:39], v[200:203], v[124:127], v[36:39]
    ds_read_b64_tr_b16 v[200:201], v236 offset:12800
    ds_read_b64_tr_b16 v[202:203], v236 offset:14080
    s_waitcnt lgkmcnt(8)
    v_mfma_f32_16x16x32_bf16 v[40:43], v[204:207], v[124:127], v[40:43]
    ds_read_b64_tr_b16 v[204:205], v236 offset:12832
    ds_read_b64_tr_b16 v[206:207], v236 offset:14112
    s_waitcnt lgkmcnt(8)
    v_mfma_f32_16x16x32_bf16 v[44:47], v[208:211], v[124:127], v[44:47]
    ds_read_b64_tr_b16 v[208:209], v236 offset:12864
    ds_read_b64_tr_b16 v[210:211], v236 offset:14144
    s_waitcnt lgkmcnt(8)
    v_mfma_f32_16x16x32_bf16 v[48:51], v[212:215], v[124:127], v[48:51]
    ds_read_b64_tr_b16 v[212:213], v236 offset:12896
    ds_read_b64_tr_b16 v[214:215], v236 offset:14176
    s_waitcnt lgkmcnt(8)
    v_mfma_f32_16x16x32_bf16 v[52:55], v[216:219], v[124:127], v[52:55]
    ds_read_b64_tr_b16 v[216:217], v236 offset:12928
    ds_read_b64_tr_b16 v[218:219], v236 offset:14208
    s_waitcnt vmcnt(21)
    s_waitcnt lgkmcnt(8)
    v_mfma_f32_16x16x32_bf16 v[36:39], v[200:203], v[128:131], v[36:39]
    ds_read_b64_tr_b16 v[200:201], v236 offset:19200
    ds_read_b64_tr_b16 v[202:203], v236 offset:20480
    s_waitcnt lgkmcnt(8)
    v_mfma_f32_16x16x32_bf16 v[40:43], v[204:207], v[128:131], v[40:43]
    ds_read_b64_tr_b16 v[204:205], v236 offset:19232
    ds_read_b64_tr_b16 v[206:207], v236 offset:20512
    s_waitcnt lgkmcnt(8)
    v_mfma_f32_16x16x32_bf16 v[44:47], v[208:211], v[128:131], v[44:47]
    ds_read_b64_tr_b16 v[208:209], v236 offset:19264
    ds_read_b64_tr_b16 v[210:211], v236 offset:20544
    s_waitcnt lgkmcnt(8)
    v_mfma_f32_16x16x32_bf16 v[48:51], v[212:215], v[128:131], v[48:51]
    ds_read_b64_tr_b16 v[212:213], v236 offset:19296
    ds_read_b64_tr_b16 v[214:215], v236 offset:20576
    s_waitcnt lgkmcnt(8)
    v_mfma_f32_16x16x32_bf16 v[52:55], v[216:219], v[128:131], v[52:55]
    ds_read_b64_tr_b16 v[216:217], v236 offset:19328
    ds_read_b64_tr_b16 v[218:219], v236 offset:20608
    s_waitcnt vmcnt(20)
    s_waitcnt lgkmcnt(8)
    v_mfma_f32_16x16x32_bf16 v[36:39], v[200:203], v[132:135], v[36:39]
    ds_read_b64_tr_b16 v[200:201], v236 offset:25600
    ds_read_b64_tr_b16 v[202:203], v236 offset:26880
    s_waitcnt lgkmcnt(8)
    v_mfma_f32_16x16x32_bf16 v[40:43], v[204:207], v[132:135], v[40:43]
    ds_read_b64_tr_b16 v[204:205], v236 offset:25632
    ds_read_b64_tr_b16 v[206:207], v236 offset:26912
    s_waitcnt lgkmcnt(8)
    v_mfma_f32_16x16x32_bf16 v[44:47], v[208:211], v[132:135], v[44:47]
    ds_read_b64_tr_b16 v[208:209], v236 offset:25664
    ds_read_b64_tr_b16 v[210:211], v236 offset:26944
    s_waitcnt lgkmcnt(8)
    v_mfma_f32_16x16x32_bf16 v[48:51], v[212:215], v[132:135], v[48:51]
    ds_read_b64_tr_b16 v[212:213], v236 offset:25696
    ds_read_b64_tr_b16 v[214:215], v236 offset:26976
    s_waitcnt lgkmcnt(8)
    v_mfma_f32_16x16x32_bf16 v[52:55], v[216:219], v[132:135], v[52:55]
    ds_read_b64_tr_b16 v[216:217], v236 offset:25728
    ds_read_b64_tr_b16 v[218:219], v236 offset:27008
    s_waitcnt vmcnt(19)
    s_waitcnt lgkmcnt(8)
    v_mfma_f32_16x16x32_bf16 v[36:39], v[200:203], v[136:139], v[36:39]
    ds_read_b64_tr_b16 v[200:201], v236 offset:32000
    ds_read_b64_tr_b16 v[202:203], v236 offset:33280
    s_waitcnt lgkmcnt(8)
    v_mfma_f32_16x16x32_bf16 v[40:43], v[204:207], v[136:139], v[40:43]
    ds_read_b64_tr_b16 v[204:205], v236 offset:32032
    ds_read_b64_tr_b16 v[206:207], v236 offset:33312
    s_waitcnt lgkmcnt(8)
    v_mfma_f32_16x16x32_bf16 v[44:47], v[208:211], v[136:139], v[44:47]
    ds_read_b64_tr_b16 v[208:209], v236 offset:32064
    ds_read_b64_tr_b16 v[210:211], v236 offset:33344
    s_waitcnt lgkmcnt(8)
    v_mfma_f32_16x16x32_bf16 v[48:51], v[212:215], v[136:139], v[48:51]
    ds_read_b64_tr_b16 v[212:213], v236 offset:32096
    ds_read_b64_tr_b16 v[214:215], v236 offset:33376
    s_waitcnt lgkmcnt(8)
    v_mfma_f32_16x16x32_bf16 v[52:55], v[216:219], v[136:139], v[52:55]
    ds_read_b64_tr_b16 v[216:217], v236 offset:32128
    ds_read_b64_tr_b16 v[218:219], v236 offset:33408
    s_waitcnt vmcnt(18)
    s_waitcnt lgkmcnt(8)
    v_mfma_f32_16x16x32_bf16 v[36:39], v[200:203], v[140:143], v[36:39]
    ds_read_b64_tr_b16 v[200:201], v236 offset:38400
    ds_read_b64_tr_b16 v[202:203], v236 offset:39680
    s_waitcnt lgkmcnt(8)
    v_mfma_f32_16x16x32_bf16 v[40:43], v[204:207], v[140:143], v[40:43]
    ds_read_b64_tr_b16 v[204:205], v236 offset:38432
    ds_read_b64_tr_b16 v[206:207], v236 offset:39712
    s_waitcnt lgkmcnt(8)
    v_mfma_f32_16x16x32_bf16 v[44:47], v[208:211], v[140:143], v[44:47]
    ds_read_b64_tr_b16 v[208:209], v236 offset:38464
    ds_read_b64_tr_b16 v[210:211], v236 offset:39744
    s_waitcnt lgkmcnt(8)
    v_mfma_f32_16x16x32_bf16 v[48:51], v[212:215], v[140:143], v[48:51]
    ds_read_b64_tr_b16 v[212:213], v236 offset:38496
    ds_read_b64_tr_b16 v[214:215], v236 offset:39776
    s_waitcnt lgkmcnt(8)
    v_mfma_f32_16x16x32_bf16 v[52:55], v[216:219], v[140:143], v[52:55]
    ds_read_b64_tr_b16 v[216:217], v236 offset:38528
    ds_read_b64_tr_b16 v[218:219], v236 offset:39808
    s_waitcnt vmcnt(17)
    s_waitcnt lgkmcnt(8)
    v_mfma_f32_16x16x32_bf16 v[36:39], v[200:203], v[144:147], v[36:39]
    ds_read_b64_tr_b16 v[200:201], v236 offset:44800
    ds_read_b64_tr_b16 v[202:203], v236 offset:46080
    s_waitcnt lgkmcnt(8)
    v_mfma_f32_16x16x32_bf16 v[40:43], v[204:207], v[144:147], v[40:43]
    ds_read_b64_tr_b16 v[204:205], v236 offset:44832
    ds_read_b64_tr_b16 v[206:207], v236 offset:46112
    s_waitcnt lgkmcnt(8)
    v_mfma_f32_16x16x32_bf16 v[44:47], v[208:211], v[144:147], v[44:47]
    ds_read_b64_tr_b16 v[208:209], v236 offset:44864
    ds_read_b64_tr_b16 v[210:211], v236 offset:46144
    s_waitcnt lgkmcnt(8)
    v_mfma_f32_16x16x32_bf16 v[48:51], v[212:215], v[144:147], v[48:51]
    ds_read_b64_tr_b16 v[212:213], v236 offset:44896
    ds_read_b64_tr_b16 v[214:215], v236 offset:46176
    s_waitcnt lgkmcnt(8)
    v_mfma_f32_16x16x32_bf16 v[52:55], v[216:219], v[144:147], v[52:55]
    ds_read_b64_tr_b16 v[216:217], v236 offset:44928
    ds_read_b64_tr_b16 v[218:219], v236 offset:46208
    s_waitcnt vmcnt(16)
    s_waitcnt lgkmcnt(8)
    v_mfma_f32_16x16x32_bf16 v[36:39], v[200:203], v[148:151], v[36:39]
    ds_read_b64_tr_b16 v[200:201], v236 offset:51200
    ds_read_b64_tr_b16 v[202:203], v236 offset:52480
    s_waitcnt lgkmcnt(8)
    v_mfma_f32_16x16x32_bf16 v[40:43], v[204:207], v[148:151], v[40:43]
    ds_read_b64_tr_b16 v[204:205], v236 offset:51232
    ds_read_b64_tr_b16 v[206:207], v236 offset:52512
    s_waitcnt lgkmcnt(8)
    v_mfma_f32_16x16x32_bf16 v[44:47], v[208:211], v[148:151], v[44:47]
    ds_read_b64_tr_b16 v[208:209], v236 offset:51264
    ds_read_b64_tr_b16 v[210:211], v236 offset:52544
    s_waitcnt lgkmcnt(8)
    v_mfma_f32_16x16x32_bf16 v[48:51], v[212:215], v[148:151], v[48:51]
    ds_read_b64_tr_b16 v[212:213], v236 offset:51296
    ds_read_b64_tr_b16 v[214:215], v236 offset:52576
    s_waitcnt lgkmcnt(8)
    v_mfma_f32_16x16x32_bf16 v[52:55], v[216:219], v[148:151], v[52:55]
    ds_read_b64_tr_b16 v[216:217], v236 offset:51328
    ds_read_b64_tr_b16 v[218:219], v236 offset:52608
    s_waitcnt vmcnt(15)
    s_waitcnt lgkmcnt(8)
    v_mfma_f32_16x16x32_bf16 v[36:39], v[200:203], v[152:155], v[36:39]
    ds_read_b64_tr_b16 v[200:201], v236 offset:57600
    ds_read_b64_tr_b16 v[202:203], v236 offset:58880
    s_waitcnt lgkmcnt(8)
    v_mfma_f32_16x16x32_bf16 v[40:43], v[204:207], v[152:155], v[40:43]
    ds_read_b64_tr_b16 v[204:205], v236 offset:57632
    ds_read_b64_tr_b16 v[206:207], v236 offset:58912
    s_waitcnt lgkmcnt(8)
    v_mfma_f32_16x16x32_bf16 v[44:47], v[208:211], v[152:155], v[44:47]
    ds_read_b64_tr_b16 v[208:209], v236 offset:57664
    ds_read_b64_tr_b16 v[210:211], v236 offset:58944
    s_waitcnt lgkmcnt(8)
    v_mfma_f32_16x16x32_bf16 v[48:51], v[212:215], v[152:155], v[48:51]
    ds_read_b64_tr_b16 v[212:213], v236 offset:57696
    ds_read_b64_tr_b16 v[214:215], v236 offset:58976
    s_waitcnt lgkmcnt(8)
    v_mfma_f32_16x16x32_bf16 v[52:55], v[216:219], v[152:155], v[52:55]
    ds_read_b64_tr_b16 v[216:217], v236 offset:57728
    ds_read_b64_tr_b16 v[218:219], v236 offset:59008
    s_waitcnt vmcnt(14)
    s_waitcnt lgkmcnt(8)
    v_mfma_f32_16x16x32_bf16 v[36:39], v[200:203], v[156:159], v[36:39]
    ds_read_b64_tr_b16 v[200:201], v237 offset:0
    ds_read_b64_tr_b16 v[202:203], v237 offset:1280
    s_waitcnt lgkmcnt(8)
    v_mfma_f32_16x16x32_bf16 v[40:43], v[204:207], v[156:159], v[40:43]
    ds_read_b64_tr_b16 v[204:205], v237 offset:32
    ds_read_b64_tr_b16 v[206:207], v237 offset:1312
    s_waitcnt lgkmcnt(8)
    v_mfma_f32_16x16x32_bf16 v[44:47], v[208:211], v[156:159], v[44:47]
    ds_read_b64_tr_b16 v[208:209], v237 offset:64
    ds_read_b64_tr_b16 v[210:211], v237 offset:1344
    s_waitcnt lgkmcnt(8)
    v_mfma_f32_16x16x32_bf16 v[48:51], v[212:215], v[156:159], v[48:51]
    ds_read_b64_tr_b16 v[212:213], v237 offset:96
    ds_read_b64_tr_b16 v[214:215], v237 offset:1376
    s_waitcnt lgkmcnt(8)
    v_mfma_f32_16x16x32_bf16 v[52:55], v[216:219], v[156:159], v[52:55]
    ds_read_b64_tr_b16 v[216:217], v237 offset:128
    ds_read_b64_tr_b16 v[218:219], v237 offset:1408
    s_waitcnt vmcnt(13)
    s_waitcnt lgkmcnt(8)
    v_mfma_f32_16x16x32_bf16 v[36:39], v[200:203], v[160:163], v[36:39]
    ds_read_b64_tr_b16 v[200:201], v237 offset:6400
    ds_read_b64_tr_b16 v[202:203], v237 offset:7680
    s_waitcnt lgkmcnt(8)
    v_mfma_f32_16x16x32_bf16 v[40:43], v[204:207], v[160:163], v[40:43]
    ds_read_b64_tr_b16 v[204:205], v237 offset:6432
    ds_read_b64_tr_b16 v[206:207], v237 offset:7712
    s_waitcnt lgkmcnt(8)
    v_mfma_f32_16x16x32_bf16 v[44:47], v[208:211], v[160:163], v[44:47]
    ds_read_b64_tr_b16 v[208:209], v237 offset:6464
    ds_read_b64_tr_b16 v[210:211], v237 offset:7744
    s_waitcnt lgkmcnt(8)
    v_mfma_f32_16x16x32_bf16 v[48:51], v[212:215], v[160:163], v[48:51]
    ds_read_b64_tr_b16 v[212:213], v237 offset:6496
    ds_read_b64_tr_b16 v[214:215], v237 offset:7776
    s_waitcnt lgkmcnt(8)
    v_mfma_f32_16x16x32_bf16 v[52:55], v[216:219], v[160:163], v[52:55]
    ds_read_b64_tr_b16 v[216:217], v237 offset:6528
    ds_read_b64_tr_b16 v[218:219], v237 offset:7808
    s_waitcnt vmcnt(12)
    s_waitcnt lgkmcnt(8)
    v_mfma_f32_16x16x32_bf16 v[36:39], v[200:203], v[164:167], v[36:39]
    ds_read_b64_tr_b16 v[200:201], v237 offset:12800
    ds_read_b64_tr_b16 v[202:203], v237 offset:14080
    s_waitcnt lgkmcnt(8)
    v_mfma_f32_16x16x32_bf16 v[40:43], v[204:207], v[164:167], v[40:43]
    ds_read_b64_tr_b16 v[204:205], v237 offset:12832
    ds_read_b64_tr_b16 v[206:207], v237 offset:14112
    s_waitcnt lgkmcnt(8)
    v_mfma_f32_16x16x32_bf16 v[44:47], v[208:211], v[164:167], v[44:47]
    ds_read_b64_tr_b16 v[208:209], v237 offset:12864
    ds_read_b64_tr_b16 v[210:211], v237 offset:14144
    s_waitcnt lgkmcnt(8)
    v_mfma_f32_16x16x32_bf16 v[48:51], v[212:215], v[164:167], v[48:51]
    ds_read_b64_tr_b16 v[212:213], v237 offset:12896
    ds_read_b64_tr_b16 v[214:215], v237 offset:14176
    s_waitcnt lgkmcnt(8)
    v_mfma_f32_16x16x32_bf16 v[52:55], v[216:219], v[164:167], v[52:55]
    ds_read_b64_tr_b16 v[216:217], v237 offset:12928
    ds_read_b64_tr_b16 v[218:219], v237 offset:14208
    s_waitcnt vmcnt(11)
    s_waitcnt lgkmcnt(8)
    v_mfma_f32_16x16x32_bf16 v[36:39], v[200:203], v[168:171], v[36:39]
    ds_read_b64_tr_b16 v[200:201], v237 offset:19200
    ds_read_b64_tr_b16 v[202:203], v237 offset:20480
    s_waitcnt lgkmcnt(8)
    v_mfma_f32_16x16x32_bf16 v[40:43], v[204:207], v[168:171], v[40:43]
    ds_read_b64_tr_b16 v[204:205], v237 offset:19232
    ds_read_b64_tr_b16 v[206:207], v237 offset:20512
    s_waitcnt lgkmcnt(8)
    v_mfma_f32_16x16x32_bf16 v[44:47], v[208:211], v[168:171], v[44:47]
    ds_read_b64_tr_b16 v[208:209], v237 offset:19264
    ds_read_b64_tr_b16 v[210:211], v237 offset:20544
    s_waitcnt lgkmcnt(8)
    v_mfma_f32_16x16x32_bf16 v[48:51], v[212:215], v[168:171], v[48:51]
    ds_read_b64_tr_b16 v[212:213], v237 offset:19296
    ds_read_b64_tr_b16 v[214:215], v237 offset:20576
    s_waitcnt lgkmcnt(8)
    v_mfma_f32_16x16x32_bf16 v[52:55], v[216:219], v[168:171], v[52:55]
    ds_read_b64_tr_b16 v[216:217], v237 offset:19328
    ds_read_b64_tr_b16 v[218:219], v237 offset:20608
    s_waitcnt vmcnt(10)
    s_waitcnt lgkmcnt(8)
    v_mfma_f32_16x16x32_bf16 v[36:39], v[200:203], v[172:175], v[36:39]
    ds_read_b64_tr_b16 v[200:201], v237 offset:25600
    ds_read_b64_tr_b16 v[202:203], v237 offset:26880
    s_waitcnt lgkmcnt(8)
    v_mfma_f32_16x16x32_bf16 v[40:43], v[204:207], v[172:175], v[40:43]
    ds_read_b64_tr_b16 v[204:205], v237 offset:25632
    ds_read_b64_tr_b16 v[206:207], v237 offset:26912
    s_waitcnt lgkmcnt(8)
    v_mfma_f32_16x16x32_bf16 v[44:47], v[208:211], v[172:175], v[44:47]
    ds_read_b64_tr_b16 v[208:209], v237 offset:25664
    ds_read_b64_tr_b16 v[210:211], v237 offset:26944
    s_waitcnt lgkmcnt(8)
    v_mfma_f32_16x16x32_bf16 v[48:51], v[212:215], v[172:175], v[48:51]
    ds_read_b64_tr_b16 v[212:213], v237 offset:25696
    ds_read_b64_tr_b16 v[214:215], v237 offset:26976
    s_waitcnt lgkmcnt(8)
    v_mfma_f32_16x16x32_bf16 v[52:55], v[216:219], v[172:175], v[52:55]
    ds_read_b64_tr_b16 v[216:217], v237 offset:25728
    ds_read_b64_tr_b16 v[218:219], v237 offset:27008
    s_waitcnt vmcnt(9)
    s_waitcnt lgkmcnt(8)
    v_mfma_f32_16x16x32_bf16 v[36:39], v[200:203], v[176:179], v[36:39]
    ds_read_b64_tr_b16 v[200:201], v237 offset:32000
    ds_read_b64_tr_b16 v[202:203], v237 offset:33280
    s_waitcnt lgkmcnt(8)
    v_mfma_f32_16x16x32_bf16 v[40:43], v[204:207], v[176:179], v[40:43]
    ds_read_b64_tr_b16 v[204:205], v237 offset:32032
    ds_read_b64_tr_b16 v[206:207], v237 offset:33312
    s_waitcnt lgkmcnt(8)
    v_mfma_f32_16x16x32_bf16 v[44:47], v[208:211], v[176:179], v[44:47]
    ds_read_b64_tr_b16 v[208:209], v237 offset:32064
    ds_read_b64_tr_b16 v[210:211], v237 offset:33344
    s_waitcnt lgkmcnt(8)
    v_mfma_f32_16x16x32_bf16 v[48:51], v[212:215], v[176:179], v[48:51]
    ds_read_b64_tr_b16 v[212:213], v237 offset:32096
    ds_read_b64_tr_b16 v[214:215], v237 offset:33376
    s_waitcnt lgkmcnt(8)
    v_mfma_f32_16x16x32_bf16 v[52:55], v[216:219], v[176:179], v[52:55]
    ds_read_b64_tr_b16 v[216:217], v237 offset:32128
    ds_read_b64_tr_b16 v[218:219], v237 offset:33408
    s_waitcnt vmcnt(8)
    s_waitcnt lgkmcnt(8)
    v_mfma_f32_16x16x32_bf16 v[36:39], v[200:203], v[180:183], v[36:39]
    ds_read_b64_tr_b16 v[200:201], v238 offset:0
    ds_read_b64_tr_b16 v[202:203], v238 offset:3200
    s_waitcnt lgkmcnt(8)
    v_mfma_f32_16x16x32_bf16 v[40:43], v[204:207], v[180:183], v[40:43]
    ds_read_b64_tr_b16 v[204:205], v238 offset:32
    ds_read_b64_tr_b16 v[206:207], v238 offset:3232
    s_waitcnt lgkmcnt(8)
    v_mfma_f32_16x16x32_bf16 v[44:47], v[208:211], v[180:183], v[44:47]
    ds_read_b64_tr_b16 v[208:209], v238 offset:64
    ds_read_b64_tr_b16 v[210:211], v238 offset:3264
    s_waitcnt lgkmcnt(8)
    v_mfma_f32_16x16x32_bf16 v[48:51], v[212:215], v[180:183], v[48:51]
    ds_read_b64_tr_b16 v[212:213], v238 offset:96
    ds_read_b64_tr_b16 v[214:215], v238 offset:3296
    s_waitcnt lgkmcnt(8)
    v_mfma_f32_16x16x32_bf16 v[52:55], v[216:219], v[180:183], v[52:55]
    ds_read_b64_tr_b16 v[216:217], v238 offset:128
    ds_read_b64_tr_b16 v[218:219], v238 offset:3328
    s_waitcnt vmcnt(6)
    s_waitcnt lgkmcnt(8)
    v_mfma_f32_16x16x32_bf16 v[36:39], v[200:203], v[184:187], v[36:39]
    ds_read_b64_tr_b16 v[200:201], v238 offset:25600
    ds_read_b64_tr_b16 v[202:203], v238 offset:28800
    s_waitcnt lgkmcnt(8)
    v_mfma_f32_16x16x32_bf16 v[40:43], v[204:207], v[184:187], v[40:43]
    ds_read_b64_tr_b16 v[204:205], v238 offset:25632
    ds_read_b64_tr_b16 v[206:207], v238 offset:28832
    s_waitcnt lgkmcnt(8)
    v_mfma_f32_16x16x32_bf16 v[44:47], v[208:211], v[184:187], v[44:47]
    ds_read_b64_tr_b16 v[208:209], v238 offset:25664
    ds_read_b64_tr_b16 v[210:211], v238 offset:28864
    s_waitcnt lgkmcnt(8)
    v_mfma_f32_16x16x32_bf16 v[48:51], v[212:215], v[184:187], v[48:51]
    ds_read_b64_tr_b16 v[212:213], v238 offset:25696
    ds_read_b64_tr_b16 v[214:215], v238 offset:28896
    s_waitcnt lgkmcnt(8)
    v_mfma_f32_16x16x32_bf16 v[52:55], v[216:219], v[184:187], v[52:55]
    ds_read_b64_tr_b16 v[216:217], v238 offset:25728
    ds_read_b64_tr_b16 v[218:219], v238 offset:28928
    s_waitcnt vmcnt(4)
    s_waitcnt lgkmcnt(8)
    v_mfma_f32_16x16x32_bf16 v[36:39], v[200:203], v[188:191], v[36:39]
    ds_read_b64_tr_b16 v[200:201], v239 offset:0
    ds_read_b64_tr_b16 v[202:203], v239 offset:3200
    s_waitcnt lgkmcnt(8)
    v_mfma_f32_16x16x32_bf16 v[40:43], v[204:207], v[188:191], v[40:43]
    ds_read_b64_tr_b16 v[204:205], v239 offset:32
    ds_read_b64_tr_b16 v[206:207], v239 offset:3232
    s_waitcnt lgkmcnt(8)
    v_mfma_f32_16x16x32_bf16 v[44:47], v[208:211], v[188:191], v[44:47]
    ds_read_b64_tr_b16 v[208:209], v239 offset:64
    ds_read_b64_tr_b16 v[210:211], v239 offset:3264
    s_waitcnt lgkmcnt(8)
    v_mfma_f32_16x16x32_bf16 v[48:51], v[212:215], v[188:191], v[48:51]
    ds_read_b64_tr_b16 v[212:213], v239 offset:96
    ds_read_b64_tr_b16 v[214:215], v239 offset:3296
    s_waitcnt lgkmcnt(8)
    v_mfma_f32_16x16x32_bf16 v[52:55], v[216:219], v[188:191], v[52:55]
    ds_read_b64_tr_b16 v[216:217], v239 offset:128
    ds_read_b64_tr_b16 v[218:219], v239 offset:3328
    s_waitcnt vmcnt(2)
    s_waitcnt lgkmcnt(8)
    v_mfma_f32_16x16x32_bf16 v[36:39], v[200:203], v[192:195], v[36:39]
    ds_read_b64_tr_b16 v[200:201], v239 offset:25600
    ds_read_b64_tr_b16 v[202:203], v239 offset:28800
    s_waitcnt lgkmcnt(8)
    v_mfma_f32_16x16x32_bf16 v[40:43], v[204:207], v[192:195], v[40:43]
    ds_read_b64_tr_b16 v[204:205], v239 offset:25632
    ds_read_b64_tr_b16 v[206:207], v239 offset:28832
    s_waitcnt lgkmcnt(8)
    v_mfma_f32_16x16x32_bf16 v[44:47], v[208:211], v[192:195], v[44:47]
    ds_read_b64_tr_b16 v[208:209], v239 offset:25664
    ds_read_b64_tr_b16 v[210:211], v239 offset:28864
    s_waitcnt lgkmcnt(8)
    v_mfma_f32_16x16x32_bf16 v[48:51], v[212:215], v[192:195], v[48:51]
    ds_read_b64_tr_b16 v[212:213], v239 offset:25696
    ds_read_b64_tr_b16 v[214:215], v239 offset:28896
    s_waitcnt lgkmcnt(8)
    v_mfma_f32_16x16x32_bf16 v[52:55], v[216:219], v[192:195], v[52:55]
    ds_read_b64_tr_b16 v[216:217], v239 offset:25728
    ds_read_b64_tr_b16 v[218:219], v239 offset:28928
    s_waitcnt vmcnt(0)
    s_waitcnt lgkmcnt(8)
    v_mfma_f32_16x16x32_bf16 v[36:39], v[200:203], v[196:199], v[36:39]
    s_waitcnt lgkmcnt(6)
    v_mfma_f32_16x16x32_bf16 v[40:43], v[204:207], v[196:199], v[40:43]
    s_waitcnt lgkmcnt(4)
    v_mfma_f32_16x16x32_bf16 v[44:47], v[208:211], v[196:199], v[44:47]
    s_waitcnt lgkmcnt(2)
    v_mfma_f32_16x16x32_bf16 v[48:51], v[212:215], v[196:199], v[48:51]
    s_waitcnt lgkmcnt(0)
    v_mfma_f32_16x16x32_bf16 v[52:55], v[216:219], v[196:199], v[52:55]
    s_lshl_b32 s63, s57, 2
    s_add_u32 s63, s63, s56
    s_mul_i32 s63, s63, 40960
    s_mul_i32 s64, s58, 160
    s_add_u32 s63, s63, s64
    v_cvt_pk_bf16_f32 v200, v36, v37
    v_cvt_pk_bf16_f32 v201, v38, v39
    v_cvt_pk_bf16_f32 v202, v40, v41
    v_cvt_pk_bf16_f32 v203, v42, v43
    v_cvt_pk_bf16_f32 v204, v44, v45
    v_cvt_pk_bf16_f32 v205, v46, v47
    v_cvt_pk_bf16_f32 v206, v48, v49
    v_cvt_pk_bf16_f32 v207, v50, v51
    v_cvt_pk_bf16_f32 v208, v52, v53
    v_cvt_pk_bf16_f32 v209, v54, v55
    v_permlane16_swap_b32 v200, v202
    v_permlane16_swap_b32 v201, v203
    buffer_store_dwordx4 v[200:203], v241, s[24:27], s63 offen offset:0
    v_permlane16_swap_b32 v204, v206
    v_permlane16_swap_b32 v205, v207
    buffer_store_dwordx4 v[204:207], v241, s[24:27], s63 offen offset:64
    buffer_store_dwordx2 v[208:209], v242, s[24:27], s63 offen offset:128
    s_lshl_b32 s63, s2, 3
    s_add_u32 s63, s63, s56
    s_cmp_lg_u32 s63, 2040
    s_cbranch_scc1 L_nog
    v_lshlrev_b32 v1, 9, v0
    s_mov_b32 s63, 4194304
    s_mov_b32 s69, 200000
L_gpoll:
    buffer_load_dword v224, v1, s[28:31], s63 offen offset:0 sc1
    buffer_load_dword v225, v1, s[28:31], s63 offen offset:128 sc1
    buffer_load_dword v226, v1, s[28:31], s63 offen offset:256 sc1
    buffer_load_dword v227, v1, s[28:31], s63 offen offset:384 sc1
    s_sub_u32 s69, s69, 1
    s_waitcnt vmcnt(0)
    v_xor_b32 v224, s61, v224
    v_xor_b32 v225, s61, v225
    v_xor_b32 v226, s61, v226
    v_xor_b32 v227, s61, v227
    v_or3_b32 v224, v224, v225, v226
    v_or_b32 v224, v224, v227
    v_cmp_ne_u32 vcc, 0, v224
    s_cbranch_vccz L_gset
    s_sleep 8
    s_cmp_lg_u32 s69, 0
    s_cbranch_scc1 L_gpoll
L_gset:
    v_mov_b32 v1, 0
    v_mov_b32 v2, s61
    s_mov_b64 exec, 1
    buffer_store_dword v2, v1, s[28:31], 0 offen sc1
    s_mov_b64 exec, -1
L_nog:
    s_endpgm
L_pathB:
    ds_read_b32 v224, v230 offset:8
    ds_read_b32 v225, v230 offset:52
    ds_read_b64 v[4:5], v228
    ds_read_b64 v[6:7], v228 offset:16
    ds_read_b64 v[8:9], v228 offset:5376
    ds_read_b64 v[10:11], v228 offset:5392
    ds_read_b64 v[12:13], v229 offset:32
    ds_read_b128 v[20:23], v27
    ds_read_b64 v[24:25], v102
    s_mov_b32 s64, 0xbf828f5c
    s_mov_b32 s65, 0xc2000000
    s_waitcnt lgkmcnt(7)
    v_mul_f32 v224, v224, v225
    v_sqrt_f32 v224, v224
    s_nop 0
    v_mul_f32 v152, s64, v224
    v_cmp_nle_f32 vcc, s65, v152
    v_mov_b32 v153, v152
    v_mov_b32 v154, v152
    v_mov_b32 v155, v152
    v_mov_b32 v156, v152
    v_mov_b32 v157, v152
    v_mov_b32 v158, v152
    v_mov_b32 v159, v152
    v_mov_b32 v160, v152
    v_mov_b32 v161, v152
    v_mov_b32 v162, v152
    v_mov_b32 v163, v152
    v_mov_b32 v164, v152
    v_mov_b32 v165, v152
    v_mov_b32 v166, v152
    v_mov_b32 v167, v152
    v_mov_b32 v224, v152
    s_cbranch_vccz L_goB
    s_waitcnt lgkmcnt(0)
    s_waitcnt vmcnt(0)
    s_barrier
    v_mov_b32 v226, 0xff800000
    v_mov_b32 v227, 0xff800000
    s_mov_b32 s69, 0
    s_and_b32 s63, s56, 3
    s_mul_i32 s63, s63, 3072
    s_add_u32 s64, s63, 36864
    s_add_u32 s63, s63, 65536
L_maxloopB:
    s_barrier
    ds_read_b128 v[20:23], v27 offset:30720
    ds_read_b64 v[24:25], v102 offset:30720
    s_waitcnt lgkmcnt(0)
    v_mfma_f32_32x32x16_bf16 v[36:51], v[20:23], v[4:7], 0
    v_mfma_f32_32x32x16_bf16 v[52:67], v[20:23], v[8:11], 0
    s_nop 9
    v_mfma_f32_32x32x4bf16_1k v[36:67], v[24:25], v[12:13], v[36:67]
    s_nop 15
    s_nop 3
    v_max3_f32 v226, v226, v36, v37
    v_max3_f32 v227, v227, v52, v53
    v_max3_f32 v226, v226, v38, v39
    v_max3_f32 v227, v227, v54, v55
    v_max3_f32 v226, v226, v40, v41
    v_max3_f32 v227, v227, v56, v57
    v_max3_f32 v226, v226, v42, v43
    v_max3_f32 v227, v227, v58, v59
    v_max3_f32 v226, v226, v44, v45
    v_max3_f32 v227, v227, v60, v61
    v_max3_f32 v226, v226, v46, v47
    v_max3_f32 v227, v227, v62, v63
    v_max3_f32 v226, v226, v48, v49
    v_max3_f32 v227, v227, v64, v65
    v_max3_f32 v226, v226, v50, v51
    v_max3_f32 v227, v227, v66, v67
    ds_read_b128 v[20:23], v27 offset:33792
    ds_read_b64 v[24:25], v102 offset:33792
    s_waitcnt lgkmcnt(0)
    v_mfma_f32_32x32x16_bf16 v[36:51], v[20:23], v[4:7], 0
    v_mfma_f32_32x32x16_bf16 v[52:67], v[20:23], v[8:11], 0
    s_nop 9
    v_mfma_f32_32x32x4bf16_1k v[36:67], v[24:25], v[12:13], v[36:67]
    s_nop 15
    s_nop 3
    v_max3_f32 v226, v226, v36, v37
    v_max3_f32 v227, v227, v52, v53
    v_max3_f32 v226, v226, v38, v39
    v_max3_f32 v227, v227, v54, v55
    v_max3_f32 v226, v226, v40, v41
    v_max3_f32 v227, v227, v56, v57
    v_max3_f32 v226, v226, v42, v43
    v_max3_f32 v227, v227, v58, v59
    v_max3_f32 v226, v226, v44, v45
    v_max3_f32 v227, v227, v60, v61
    v_max3_f32 v226, v226, v46, v47
    v_max3_f32 v227, v227, v62, v63
    v_max3_f32 v226, v226, v48, v49
    v_max3_f32 v227, v227, v64, v65
    v_max3_f32 v226, v226, v50, v51
    v_max3_f32 v227, v227, v66, v67
    ds_read_b128 v[20:23], v27 offset:36864
    ds_read_b64 v[24:25], v102 offset:36864
    s_waitcnt lgkmcnt(0)
    v_mfma_f32_32x32x16_bf16 v[36:51], v[20:23], v[4:7], 0
    v_mfma_f32_32x32x16_bf16 v[52:67], v[20:23], v[8:11], 0
    s_nop 9
    v_mfma_f32_32x32x4bf16_1k v[36:67], v[24:25], v[12:13], v[36:67]
    s_nop 15
    s_nop 3
    v_max3_f32 v226, v226, v36, v37
    v_max3_f32 v227, v227, v52, v53
    v_max3_f32 v226, v226, v38, v39
    v_max3_f32 v227, v227, v54, v55
    v_max3_f32 v226, v226, v40, v41
    v_max3_f32 v227, v227, v56, v57
    v_max3_f32 v226, v226, v42, v43
    v_max3_f32 v227, v227, v58, v59
    v_max3_f32 v226, v226, v44, v45
    v_max3_f32 v227, v227, v60, v61
    v_max3_f32 v226, v226, v46, v47
    v_max3_f32 v227, v227, v62, v63
    v_max3_f32 v226, v226, v48, v49
    v_max3_f32 v227, v227, v64, v65
    v_max3_f32 v226, v226, v50, v51
    v_max3_f32 v227, v227, v66, v67
    ds_read_b128 v[20:23], v27 offset:39936
    ds_read_b64 v[24:25], v102 offset:39936
    s_waitcnt lgkmcnt(0)
    v_mfma_f32_32x32x16_bf16 v[36:51], v[20:23], v[4:7], 0
    v_mfma_f32_32x32x16_bf16 v[52:67], v[20:23], v[8:11], 0
    s_nop 9
    v_mfma_f32_32x32x4bf16_1k v[36:67], v[24:25], v[12:13], v[36:67]
    s_nop 15
    s_nop 3
    v_max3_f32 v226, v226, v36, v37
    v_max3_f32 v227, v227, v52, v53
    v_max3_f32 v226, v226, v38, v39
    v_max3_f32 v227, v227, v54, v55
    v_max3_f32 v226, v226, v40, v41
    v_max3_f32 v227, v227, v56, v57
    v_max3_f32 v226, v226, v42, v43
    v_max3_f32 v227, v227, v58, v59
    v_max3_f32 v226, v226, v44, v45
    v_max3_f32 v227, v227, v60, v61
    v_max3_f32 v226, v226, v46, v47
    v_max3_f32 v227, v227, v62, v63
    v_max3_f32 v226, v226, v48, v49
    v_max3_f32 v227, v227, v64, v65
    v_max3_f32 v226, v226, v50, v51
    v_max3_f32 v227, v227, v66, v67
    s_barrier
    s_add_u32 s63, s63, 12288
    s_add_u32 s69, s69, 1
    s_cmp_lt_u32 s69, 16
    s_cbranch_scc1 L_maxloopB
    v_mov_b32 v230, v226
    v_mov_b32 v231, v227
    s_nop 0
    v_permlane32_swap_b32 v226, v230
    v_permlane32_swap_b32 v227, v231
    v_max_f32 v226, v226, v230
    v_max_f32 v227, v227, v231
    v_sub_f32 v152, 0, v226
    v_sub_f32 v153, 0, v226
    v_sub_f32 v154, 0, v226
    v_sub_f32 v155, 0, v226
    v_sub_f32 v156, 0, v226
    v_sub_f32 v157, 0, v226
    v_sub_f32 v158, 0, v226
    v_sub_f32 v159, 0, v226
    v_sub_f32 v160, 0, v226
    v_sub_f32 v161, 0, v226
    v_sub_f32 v162, 0, v226
    v_sub_f32 v163, 0, v226
    v_sub_f32 v164, 0, v226
    v_sub_f32 v165, 0, v226
    v_sub_f32 v166, 0, v226
    v_sub_f32 v167, 0, v226
    v_sub_f32 v224, 0, v227
    ds_read_b128 v[20:23], v27
    ds_read_b64 v[24:25], v102
L_goB:
    s_setprio 0
    s_waitcnt lgkmcnt(0)
    v_mfma_f32_32x32x16_bf16 v[36:51], v[20:23], v[4:7], v[152:167]
    v_mov_b32 v168, v224
    v_mov_b32 v169, v224
    v_mov_b32 v170, v224
    v_mov_b32 v171, v224
    v_mov_b32 v172, v224
    v_mov_b32 v173, v224
    v_mov_b32 v174, v224
    v_mov_b32 v175, v224
    v_mov_b32 v176, v224
    v_mov_b32 v177, v224
    v_mov_b32 v178, v224
    v_mov_b32 v179, v224
    v_mov_b32 v180, v224
    v_mov_b32 v181, v224
    v_mov_b32 v182, v224
    v_mov_b32 v183, v224
    s_nop 1
    v_mfma_f32_32x32x16_bf16 v[52:67], v[20:23], v[8:11], v[168:183]
    ds_read_b128 v[20:23], v27 offset:3072
    ds_read_b128 v[28:31], v103 offset:0
    s_and_b32 s64, s56, 3
    s_and_b32 s63, s56, 1
    s_bitcmp1_b32 s56, 1
    s_cselect_b32 s65, 32, 0
    s_add_u32 s63, s63, s65
    s_mul_i32 s63, s63, 3072
    s_add_u32 s63, s63, 71680
    s_mul_i32 s64, s64, 3072
    s_add_u32 s64, s64, 0
    s_mul_i32 s65, s58, 160
    s_lshl_b32 s66, s56, 10
    s_add_u32 s66, s66, 61440
    v_mfma_f32_32x32x4bf16_1k v[36:67], v[24:25], v[12:13], v[36:67]
    ds_read_b64 v[24:25], v102 offset:3072
    s_sub_u32 s67, s56, 4
    s_mul_i32 s67, s67, 655360
    s_lshl_b32 s68, s60, 1
    s_add_u32 s67, s67, s68
    v_mul_u32_u24 v238, 5120, v0
    s_nop 13
    v_exp_f32 v36, v36
    v_exp_f32 v37, v37
    s_waitcnt lgkmcnt(0)
    ds_read_b128 v[32:35], v103 offset:704
    v_exp_f32 v38, v38
    v_exp_f32 v39, v39
    v_exp_f32 v40, v40
    v_mfma_f32_32x32x16_bf16 v[68:83], v[20:23], v[4:7], v[152:167]
    v_exp_f32 v41, v41
    v_exp_f32 v42, v42
    v_exp_f32 v43, v43
    v_mfma_f32_32x32x16_bf16 v[84:99], v[20:23], v[8:11], v[168:183]
    s_waitcnt vmcnt(3)
    s_barrier
    s_add_u32 m0, s64, 36864
    s_add_u32 s63, s63, 12288
    buffer_load_dwordx4 v14, s[28:31], s63 offen offset:0 sc1 lds
    buffer_load_dwordx4 v14, s[28:31], s63 offen offset:1024 sc1 lds
    buffer_load_dwordx4 v14, s[28:31], s63 offen offset:2048 sc1 lds
    s_add_u32 m0, s66, 0
    s_nop 0
    buffer_load_dwordx4 v15, s[16:19], s65 offen lds
    s_add_u32 m0, s66, 8192
    s_nop 0
    buffer_load_dwordx4 v16, s[16:19], s65 offen lds
    buffer_load_dwordx2 v[104:105], v238, s[20:23], s67 offen offset:0
    buffer_load_dwordx2 v[106:107], v238, s[20:23], s67 offen offset:1280
    ds_read_b128 v[20:23], v27 offset:12288
    v_exp_f32 v44, v44
    v_exp_f32 v45, v45
    v_exp_f32 v46, v46
    v_exp_f32 v47, v47
    v_smfmac_f32_32x32x32_bf16 v[120:135], v[28:31], v[36:43], v26
    v_exp_f32 v48, v48
    v_exp_f32 v49, v49
    v_exp_f32 v50, v50
    v_exp_f32 v51, v51
    v_mfma_f32_32x32x4bf16_1k v[68:99], v[24:25], v[12:13], v[68:99]
    ds_read_b64 v[24:25], v102 offset:12288
    v_exp_f32 v52, v52
    v_exp_f32 v53, v53
    v_exp_f32 v54, v54
    v_exp_f32 v55, v55
    v_exp_f32 v56, v56
    v_exp_f32 v57, v57
    v_exp_f32 v58, v58
    s_waitcnt lgkmcnt(2)
    v_smfmac_f32_32x32x32_bf16 v[120:135], v[32:35], v[44:51], v26
    v_exp_f32 v59, v59
    v_exp_f32 v60, v60
    v_exp_f32 v61, v61
    v_exp_f32 v62, v62
    v_smfmac_f32_32x32x32_bf16 v[136:151], v[28:31], v[52:59], v26
    ds_read_b128 v[28:31], v103 offset:3072
    v_exp_f32 v63, v63
    v_exp_f32 v64, v64
    v_exp_f32 v65, v65
    v_exp_f32 v66, v66
    v_exp_f32 v67, v67
    v_exp_f32 v68, v68
    v_exp_f32 v69, v69
    s_waitcnt lgkmcnt(0)
    v_smfmac_f32_32x32x32_bf16 v[136:151], v[32:35], v[60:67], v26
    ds_read_b128 v[32:35], v103 offset:3776
    v_exp_f32 v70, v70
    v_exp_f32 v71, v71
    v_exp_f32 v72, v72
    v_mfma_f32_32x32x16_bf16 v[36:51], v[20:23], v[4:7], v[152:167]
    v_exp_f32 v73, v73
    v_exp_f32 v74, v74
    v_exp_f32 v75, v75
    v_mfma_f32_32x32x16_bf16 v[52:67], v[20:23], v[8:11], v[168:183]
    ds_read_b128 v[20:23], v27 offset:15360
    v_exp_f32 v76, v76
    v_exp_f32 v77, v77
    v_exp_f32 v78, v78
    v_exp_f32 v79, v79
    v_smfmac_f32_32x32x32_bf16 v[120:135], v[28:31], v[68:75], v26
    v_exp_f32 v80, v80
    v_exp_f32 v81, v81
    v_exp_f32 v82, v82
    v_exp_f32 v83, v83
    v_mfma_f32_32x32x4bf16_1k v[36:67], v[24:25], v[12:13], v[36:67]
    ds_read_b64 v[24:25], v102 offset:15360
    v_exp_f32 v84, v84
    v_exp_f32 v85, v85
    v_exp_f32 v86, v86
    v_exp_f32 v87, v87
    v_exp_f32 v88, v88
    v_exp_f32 v89, v89
    v_exp_f32 v90, v90
    s_waitcnt lgkmcnt(2)
    v_smfmac_f32_32x32x32_bf16 v[120:135], v[32:35], v[76:83], v26
    v_exp_f32 v91, v91
    v_exp_f32 v92, v92
    v_exp_f32 v93, v93
    v_exp_f32 v94, v94
    v_smfmac_f32_32x32x32_bf16 v[136:151], v[28:31], v[84:91], v26
    ds_read_b128 v[28:31], v103 offset:12288
    v_exp_f32 v95, v95
    v_exp_f32 v96, v96
    v_exp_f32 v97, v97
    v_exp_f32 v98, v98
    v_exp_f32 v99, v99
    v_exp_f32 v36, v36
    v_exp_f32 v37, v37
    s_waitcnt lgkmcnt(0)
    v_smfmac_f32_32x32x32_bf16 v[136:151], v[32:35], v[92:99], v26
    ds_read_b128 v[32:35], v103 offset:12992
    v_exp_f32 v38, v38
    v_exp_f32 v39, v39
    v_exp_f32 v40, v40
    v_mfma_f32_32x32x16_bf16 v[68:83], v[20:23], v[4:7], v[152:167]
    v_exp_f32 v41, v41
    v_exp_f32 v42, v42
    v_exp_f32 v43, v43
    v_mfma_f32_32x32x16_bf16 v[84:99], v[20:23], v[8:11], v[168:183]
    s_waitcnt vmcnt(7)
    s_barrier
    ds_read_b128 v[20:23], v27 offset:24576
    v_exp_f32 v44, v44
    v_exp_f32 v45, v45
    v_exp_f32 v46, v46
    v_exp_f32 v47, v47
    v_smfmac_f32_32x32x32_bf16 v[120:135], v[28:31], v[36:43], v26
    v_exp_f32 v48, v48
    v_exp_f32 v49, v49
    v_exp_f32 v50, v50
    v_exp_f32 v51, v51
    v_mfma_f32_32x32x4bf16_1k v[68:99], v[24:25], v[12:13], v[68:99]
    ds_read_b64 v[24:25], v102 offset:24576
    v_exp_f32 v52, v52
    v_exp_f32 v53, v53
    v_exp_f32 v54, v54
    v_exp_f32 v55, v55
    v_exp_f32 v56, v56
    v_exp_f32 v57, v57
    v_exp_f32 v58, v58
    s_waitcnt lgkmcnt(2)
    v_smfmac_f32_32x32x32_bf16 v[120:135], v[32:35], v[44:51], v26
    v_exp_f32 v59, v59
    v_exp_f32 v60, v60
    v_exp_f32 v61, v61
    v_exp_f32 v62, v62
    v_smfmac_f32_32x32x32_bf16 v[136:151], v[28:31], v[52:59], v26
    ds_read_b128 v[28:31], v103 offset:15360
    v_exp_f32 v63, v63
    v_exp_f32 v64, v64
    v_exp_f32 v65, v65
    v_exp_f32 v66, v66
    v_exp_f32 v67, v67
    v_exp_f32 v68, v68
    v_exp_f32 v69, v69
    s_waitcnt lgkmcnt(0)
    v_smfmac_f32_32x32x32_bf16 v[136:151], v[32:35], v[60:67], v26
    ds_read_b128 v[32:35], v103 offset:16064
    v_exp_f32 v70, v70
    v_exp_f32 v71, v71
    v_exp_f32 v72, v72
    v_mfma_f32_32x32x16_bf16 v[36:51], v[20:23], v[4:7], v[152:167]
    v_exp_f32 v73, v73
    v_exp_f32 v74, v74
    v_exp_f32 v75, v75
    v_mfma_f32_32x32x16_bf16 v[52:67], v[20:23], v[8:11], v[168:183]
    ds_read_b128 v[20:23], v27 offset:27648
    v_exp_f32 v76, v76
    v_exp_f32 v77, v77
    v_exp_f32 v78, v78
    v_exp_f32 v79, v79
    v_smfmac_f32_32x32x32_bf16 v[120:135], v[28:31], v[68:75], v26
    v_exp_f32 v80, v80
    v_exp_f32 v81, v81
    v_exp_f32 v82, v82
    v_exp_f32 v83, v83
    v_mfma_f32_32x32x4bf16_1k v[36:67], v[24:25], v[12:13], v[36:67]
    ds_read_b64 v[24:25], v102 offset:27648
    v_exp_f32 v84, v84
    v_exp_f32 v85, v85
    v_exp_f32 v86, v86
    v_exp_f32 v87, v87
    v_exp_f32 v88, v88
    v_exp_f32 v89, v89
    v_exp_f32 v90, v90
    s_waitcnt lgkmcnt(2)
    v_smfmac_f32_32x32x32_bf16 v[120:135], v[32:35], v[76:83], v26
    v_exp_f32 v91, v91
    v_exp_f32 v92, v92
    v_exp_f32 v93, v93
    v_exp_f32 v94, v94
    v_smfmac_f32_32x32x32_bf16 v[136:151], v[28:31], v[84:91], v26
    ds_read_b128 v[28:31], v103 offset:24576
    v_exp_f32 v95, v95
    v_exp_f32 v96, v96
    v_exp_f32 v97, v97
    v_exp_f32 v98, v98
    v_exp_f32 v99, v99
    v_exp_f32 v36, v36
    v_exp_f32 v37, v37
    s_waitcnt lgkmcnt(0)
    v_smfmac_f32_32x32x32_bf16 v[136:151], v[32:35], v[92:99], v26
    ds_read_b128 v[32:35], v103 offset:25280
    v_exp_f32 v38, v38
    v_exp_f32 v39, v39
    v_exp_f32 v40, v40
    v_mfma_f32_32x32x16_bf16 v[68:83], v[20:23], v[4:7], v[152:167]
    v_exp_f32 v41, v41
    v_exp_f32 v42, v42
    v_exp_f32 v43, v43
    v_mfma_f32_32x32x16_bf16 v[84:99], v[20:23], v[8:11], v[168:183]
    s_waitcnt vmcnt(4)
    s_barrier
    s_add_u32 m0, s64, 12288
    s_add_u32 s63, s63, 12288
    buffer_load_dwordx4 v14, s[28:31], s63 offen offset:0 sc1 lds
    buffer_load_dwordx4 v14, s[28:31], s63 offen offset:1024 sc1 lds
    buffer_load_dwordx4 v14, s[28:31], s63 offen offset:2048 sc1 lds
    s_add_u32 m0, s66, 16384
    s_nop 0
    buffer_load_dwordx4 v17, s[16:19], s65 offen lds
    s_add_u32 m0, s66, 24576
    s_nop 0
    buffer_load_dwordx4 v18, s[16:19], s65 offen lds
    buffer_load_dwordx2 v[108:109], v238, s[20:23], s67 offen offset:2560
    ds_read_b128 v[20:23], v27 offset:36864
    v_exp_f32 v44, v44
    v_exp_f32 v45, v45
    v_exp_f32 v46, v46
    v_exp_f32 v47, v47
    v_smfmac_f32_32x32x32_bf16 v[120:135], v[28:31], v[36:43], v26
    v_exp_f32 v48, v48
    v_exp_f32 v49, v49
    v_exp_f32 v50, v50
    v_exp_f32 v51, v51
    v_mfma_f32_32x32x4bf16_1k v[68:99], v[24:25], v[12:13], v[68:99]
    ds_read_b64 v[24:25], v102 offset:36864
    v_exp_f32 v52, v52
    v_exp_f32 v53, v53
    v_exp_f32 v54, v54
    v_exp_f32 v55, v55
    v_exp_f32 v56, v56
    v_exp_f32 v57, v57
    v_exp_f32 v58, v58
    s_waitcnt lgkmcnt(2)
    v_smfmac_f32_32x32x32_bf16 v[120:135], v[32:35], v[44:51], v26
    v_exp_f32 v59, v59
    v_exp_f32 v60, v60
    v_exp_f32 v61, v61
    v_exp_f32 v62, v62
    v_smfmac_f32_32x32x32_bf16 v[136:151], v[28:31], v[52:59], v26
    ds_read_b128 v[28:31], v103 offset:27648
    v_exp_f32 v63, v63
    v_exp_f32 v64, v64
    v_exp_f32 v65, v65
    v_exp_f32 v66, v66
    v_exp_f32 v67, v67
    v_exp_f32 v68, v68
    v_exp_f32 v69, v69
    s_waitcnt lgkmcnt(0)
    v_smfmac_f32_32x32x32_bf16 v[136:151], v[32:35], v[60:67], v26
    ds_read_b128 v[32:35], v103 offset:28352
    v_exp_f32 v70, v70
    v_exp_f32 v71, v71
    v_exp_f32 v72, v72
    v_mfma_f32_32x32x16_bf16 v[36:51], v[20:23], v[4:7], v[152:167]
    v_exp_f32 v73, v73
    v_exp_f32 v74, v74
    v_exp_f32 v75, v75
    v_mfma_f32_32x32x16_bf16 v[52:67], v[20:23], v[8:11], v[168:183]
    ds_read_b128 v[20:23], v27 offset:39936
    v_exp_f32 v76, v76
    v_exp_f32 v77, v77
    v_exp_f32 v78, v78
    v_exp_f32 v79, v79
    v_smfmac_f32_32x32x32_bf16 v[120:135], v[28:31], v[68:75], v26
    v_exp_f32 v80, v80
    v_exp_f32 v81, v81
    v_exp_f32 v82, v82
    v_exp_f32 v83, v83
    v_mfma_f32_32x32x4bf16_1k v[36:67], v[24:25], v[12:13], v[36:67]
    ds_read_b64 v[24:25], v102 offset:39936
    v_exp_f32 v84, v84
    v_exp_f32 v85, v85
    v_exp_f32 v86, v86
    v_exp_f32 v87, v87
    v_exp_f32 v88, v88
    v_exp_f32 v89, v89
    v_exp_f32 v90, v90
    s_waitcnt lgkmcnt(2)
    v_smfmac_f32_32x32x32_bf16 v[120:135], v[32:35], v[76:83], v26
    v_exp_f32 v91, v91
    v_exp_f32 v92, v92
    v_exp_f32 v93, v93
    v_exp_f32 v94, v94
    v_smfmac_f32_32x32x32_bf16 v[136:151], v[28:31], v[84:91], v26
    ds_read_b128 v[28:31], v103 offset:36864
    v_exp_f32 v95, v95
    v_exp_f32 v96, v96
    v_exp_f32 v97, v97
    v_exp_f32 v98, v98
    v_exp_f32 v99, v99
    v_exp_f32 v36, v36
    v_exp_f32 v37, v37
    s_waitcnt lgkmcnt(0)
    v_smfmac_f32_32x32x32_bf16 v[136:151], v[32:35], v[92:99], v26
    ds_read_b128 v[32:35], v103 offset:37568
    v_exp_f32 v38, v38
    v_exp_f32 v39, v39
    v_exp_f32 v40, v40
    v_mfma_f32_32x32x16_bf16 v[68:83], v[20:23], v[4:7], v[152:167]
    v_exp_f32 v41, v41
    v_exp_f32 v42, v42
    v_exp_f32 v43, v43
    v_mfma_f32_32x32x16_bf16 v[84:99], v[20:23], v[8:11], v[168:183]
    s_barrier
    ds_read_b128 v[20:23], v27 offset:0
    v_exp_f32 v44, v44
    v_exp_f32 v45, v45
    v_exp_f32 v46, v46
    v_exp_f32 v47, v47
    v_smfmac_f32_32x32x32_bf16 v[120:135], v[28:31], v[36:43], v26
    v_exp_f32 v48, v48
    v_exp_f32 v49, v49
    v_exp_f32 v50, v50
    v_exp_f32 v51, v51
    v_mfma_f32_32x32x4bf16_1k v[68:99], v[24:25], v[12:13], v[68:99]
    ds_read_b64 v[24:25], v102 offset:0
    v_exp_f32 v52, v52
    v_exp_f32 v53, v53
    v_exp_f32 v54, v54
    v_exp_f32 v55, v55
    v_exp_f32 v56, v56
    v_exp_f32 v57, v57
    v_exp_f32 v58, v58
    s_waitcnt lgkmcnt(2)
    v_smfmac_f32_32x32x32_bf16 v[120:135], v[32:35], v[44:51], v26
    v_exp_f32 v59, v59
    v_exp_f32 v60, v60
    v_exp_f32 v61, v61
    v_exp_f32 v62, v62
    v_smfmac_f32_32x32x32_bf16 v[136:151], v[28:31], v[52:59], v26
    ds_read_b128 v[28:31], v103 offset:39936
    v_exp_f32 v63, v63
    v_exp_f32 v64, v64
    v_exp_f32 v65, v65
    v_exp_f32 v66, v66
    v_exp_f32 v67, v67
    v_exp_f32 v68, v68
    v_exp_f32 v69, v69
    s_waitcnt lgkmcnt(0)
    v_smfmac_f32_32x32x32_bf16 v[136:151], v[32:35], v[60:67], v26
    ds_read_b128 v[32:35], v103 offset:40640
    v_exp_f32 v70, v70
    v_exp_f32 v71, v71
    v_exp_f32 v72, v72
    v_mfma_f32_32x32x16_bf16 v[36:51], v[20:23], v[4:7], v[152:167]
    v_exp_f32 v73, v73
    v_exp_f32 v74, v74
    v_exp_f32 v75, v75
    v_mfma_f32_32x32x16_bf16 v[52:67], v[20:23], v[8:11], v[168:183]
    ds_read_b128 v[20:23], v27 offset:3072
    v_exp_f32 v76, v76
    v_exp_f32 v77, v77
    v_exp_f32 v78, v78
    v_exp_f32 v79, v79
    v_smfmac_f32_32x32x32_bf16 v[120:135], v[28:31], v[68:75], v26
    v_exp_f32 v80, v80
    v_exp_f32 v81, v81
    v_exp_f32 v82, v82
    v_exp_f32 v83, v83
    v_mfma_f32_32x32x4bf16_1k v[36:67], v[24:25], v[12:13], v[36:67]
    ds_read_b64 v[24:25], v102 offset:3072
    v_exp_f32 v84, v84
    v_exp_f32 v85, v85
    v_exp_f32 v86, v86
    v_exp_f32 v87, v87
    v_exp_f32 v88, v88
    v_exp_f32 v89, v89
    v_exp_f32 v90, v90
    s_waitcnt lgkmcnt(2)
    v_smfmac_f32_32x32x32_bf16 v[120:135], v[32:35], v[76:83], v26
    v_exp_f32 v91, v91
    v_exp_f32 v92, v92
    v_exp_f32 v93, v93
    v_exp_f32 v94, v94
    v_smfmac_f32_32x32x32_bf16 v[136:151], v[28:31], v[84:91], v26
    ds_read_b128 v[28:31], v103 offset:0
    v_exp_f32 v95, v95
    v_exp_f32 v96, v96
    v_exp_f32 v97, v97
    v_exp_f32 v98, v98
    v_exp_f32 v99, v99
    v_exp_f32 v36, v36
    v_exp_f32 v37, v37
    s_waitcnt lgkmcnt(0)
    v_smfmac_f32_32x32x32_bf16 v[136:151], v[32:35], v[92:99], v26
    ds_read_b128 v[32:35], v103 offset:704
    v_exp_f32 v38, v38
    v_exp_f32 v39, v39
    v_exp_f32 v40, v40
    v_mfma_f32_32x32x16_bf16 v[68:83], v[20:23], v[4:7], v[152:167]
    v_exp_f32 v41, v41
    v_exp_f32 v42, v42
    v_exp_f32 v43, v43
    v_mfma_f32_32x32x16_bf16 v[84:99], v[20:23], v[8:11], v[168:183]
    s_waitcnt vmcnt(3)
    s_barrier
    s_add_u32 m0, s64, 36864
    s_add_u32 s63, s63, 12288
    buffer_load_dwordx4 v14, s[28:31], s63 offen offset:0 sc1 lds
    buffer_load_dwordx4 v14, s[28:31], s63 offen offset:1024 sc1 lds
    buffer_load_dwordx4 v14, s[28:31], s63 offen offset:2048 sc1 lds
    s_add_u32 m0, s66, 32768
    s_nop 0
    buffer_load_dwordx4 v19, s[16:19], s65 offen lds
    s_add_u32 s65, s65, 327680
    s_add_u32 m0, s66, 40960
    s_nop 0
    buffer_load_dwordx4 v15, s[16:19], s65 offen lds
    buffer_load_dwordx2 v[110:111], v238, s[20:23], s67 offen offset:3840
    ds_read_b128 v[20:23], v27 offset:12288
    v_exp_f32 v44, v44
    v_exp_f32 v45, v45
    v_exp_f32 v46, v46
    v_exp_f32 v47, v47
    v_smfmac_f32_32x32x32_bf16 v[120:135], v[28:31], v[36:43], v26
    v_exp_f32 v48, v48
    v_exp_f32 v49, v49
    v_exp_f32 v50, v50
    v_exp_f32 v51, v51
    v_mfma_f32_32x32x4bf16_1k v[68:99], v[24:25], v[12:13], v[68:99]
    ds_read_b64 v[24:25], v102 offset:12288
    v_exp_f32 v52, v52
    v_exp_f32 v53, v53
    v_exp_f32 v54, v54
    v_exp_f32 v55, v55
    v_exp_f32 v56, v56
    v_exp_f32 v57, v57
    v_exp_f32 v58, v58
    s_waitcnt lgkmcnt(2)
    v_smfmac_f32_32x32x32_bf16 v[120:135], v[32:35], v[44:51], v26
    v_exp_f32 v59, v59
    v_exp_f32 v60, v60
    v_exp_f32 v61, v61
    v_exp_f32 v62, v62
    v_smfmac_f32_32x32x32_bf16 v[136:151], v[28:31], v[52:59], v26
    ds_read_b128 v[28:31], v103 offset:3072
    v_exp_f32 v63, v63
    v_exp_f32 v64, v64
    v_exp_f32 v65, v65
    v_exp_f32 v66, v66
    v_exp_f32 v67, v67
    v_exp_f32 v68, v68
    v_exp_f32 v69, v69
    s_waitcnt lgkmcnt(0)
    v_smfmac_f32_32x32x32_bf16 v[136:151], v[32:35], v[60:67], v26
    ds_read_b128 v[32:35], v103 offset:3776
    v_exp_f32 v70, v70
    v_exp_f32 v71, v71
    v_exp_f32 v72, v72
    v_mfma_f32_32x32x16_bf16 v[36:51], v[20:23], v[4:7], v[152:167]
    v_exp_f32 v73, v73
    v_exp_f32 v74, v74
    v_exp_f32 v75, v75
    v_mfma_f32_32x32x16_bf16 v[52:67], v[20:23], v[8:11], v[168:183]
    ds_read_b128 v[20:23], v27 offset:15360
    v_exp_f32 v76, v76
    v_exp_f32 v77, v77
    v_exp_f32 v78, v78
    v_exp_f32 v79, v79
    v_smfmac_f32_32x32x32_bf16 v[120:135], v[28:31], v[68:75], v26
    v_exp_f32 v80, v80
    v_exp_f32 v81, v81
    v_exp_f32 v82, v82
    v_exp_f32 v83, v83
    v_mfma_f32_32x32x4bf16_1k v[36:67], v[24:25], v[12:13], v[36:67]
    ds_read_b64 v[24:25], v102 offset:15360
    v_exp_f32 v84, v84
    v_exp_f32 v85, v85
    v_exp_f32 v86, v86
    v_exp_f32 v87, v87
    v_exp_f32 v88, v88
    v_exp_f32 v89, v89
    v_exp_f32 v90, v90
    s_waitcnt lgkmcnt(2)
    v_smfmac_f32_32x32x32_bf16 v[120:135], v[32:35], v[76:83], v26
    v_exp_f32 v91, v91
    v_exp_f32 v92, v92
    v_exp_f32 v93, v93
    v_exp_f32 v94, v94
    v_smfmac_f32_32x32x32_bf16 v[136:151], v[28:31], v[84:91], v26
    ds_read_b128 v[28:31], v103 offset:12288
    v_exp_f32 v95, v95
    v_exp_f32 v96, v96
    v_exp_f32 v97, v97
    v_exp_f32 v98, v98
    v_exp_f32 v99, v99
    v_exp_f32 v36, v36
    v_exp_f32 v37, v37
    s_waitcnt lgkmcnt(0)
    v_smfmac_f32_32x32x32_bf16 v[136:151], v[32:35], v[92:99], v26
    ds_read_b128 v[32:35], v103 offset:12992
    v_exp_f32 v38, v38
    v_exp_f32 v39, v39
    v_exp_f32 v40, v40
    v_mfma_f32_32x32x16_bf16 v[68:83], v[20:23], v[4:7], v[152:167]
    v_exp_f32 v41, v41
    v_exp_f32 v42, v42
    v_exp_f32 v43, v43
    v_mfma_f32_32x32x16_bf16 v[84:99], v[20:23], v[8:11], v[168:183]
    s_barrier
    ds_read_b128 v[20:23], v27 offset:24576
    v_exp_f32 v44, v44
    v_exp_f32 v45, v45
    v_exp_f32 v46, v46
    v_exp_f32 v47, v47
    v_smfmac_f32_32x32x32_bf16 v[120:135], v[28:31], v[36:43], v26
    v_exp_f32 v48, v48
    v_exp_f32 v49, v49
    v_exp_f32 v50, v50
    v_exp_f32 v51, v51
    v_mfma_f32_32x32x4bf16_1k v[68:99], v[24:25], v[12:13], v[68:99]
    ds_read_b64 v[24:25], v102 offset:24576
    v_exp_f32 v52, v52
    v_exp_f32 v53, v53
    v_exp_f32 v54, v54
    v_exp_f32 v55, v55
    v_exp_f32 v56, v56
    v_exp_f32 v57, v57
    v_exp_f32 v58, v58
    s_waitcnt lgkmcnt(2)
    v_smfmac_f32_32x32x32_bf16 v[120:135], v[32:35], v[44:51], v26
    v_exp_f32 v59, v59
    v_exp_f32 v60, v60
    v_exp_f32 v61, v61
    v_exp_f32 v62, v62
    v_smfmac_f32_32x32x32_bf16 v[136:151], v[28:31], v[52:59], v26
    ds_read_b128 v[28:31], v103 offset:15360
    v_exp_f32 v63, v63
    v_exp_f32 v64, v64
    v_exp_f32 v65, v65
    v_exp_f32 v66, v66
    v_exp_f32 v67, v67
    v_exp_f32 v68, v68
    v_exp_f32 v69, v69
    s_waitcnt lgkmcnt(0)
    v_smfmac_f32_32x32x32_bf16 v[136:151], v[32:35], v[60:67], v26
    ds_read_b128 v[32:35], v103 offset:16064
    v_exp_f32 v70, v70
    v_exp_f32 v71, v71
    v_exp_f32 v72, v72
    v_mfma_f32_32x32x16_bf16 v[36:51], v[20:23], v[4:7], v[152:167]
    v_exp_f32 v73, v73
    v_exp_f32 v74, v74
    v_exp_f32 v75, v75
    v_mfma_f32_32x32x16_bf16 v[52:67], v[20:23], v[8:11], v[168:183]
    ds_read_b128 v[20:23], v27 offset:27648
    v_exp_f32 v76, v76
    v_exp_f32 v77, v77
    v_exp_f32 v78, v78
    v_exp_f32 v79, v79
    v_smfmac_f32_32x32x32_bf16 v[120:135], v[28:31], v[68:75], v26
    v_exp_f32 v80, v80
    v_exp_f32 v81, v81
    v_exp_f32 v82, v82
    v_exp_f32 v83, v83
    v_mfma_f32_32x32x4bf16_1k v[36:67], v[24:25], v[12:13], v[36:67]
    ds_read_b64 v[24:25], v102 offset:27648
    v_exp_f32 v84, v84
    v_exp_f32 v85, v85
    v_exp_f32 v86, v86
    v_exp_f32 v87, v87
    v_exp_f32 v88, v88
    v_exp_f32 v89, v89
    v_exp_f32 v90, v90
    s_waitcnt lgkmcnt(2)
    v_smfmac_f32_32x32x32_bf16 v[120:135], v[32:35], v[76:83], v26
    v_exp_f32 v91, v91
    v_exp_f32 v92, v92
    v_exp_f32 v93, v93
    v_exp_f32 v94, v94
    v_smfmac_f32_32x32x32_bf16 v[136:151], v[28:31], v[84:91], v26
    ds_read_b128 v[28:31], v103 offset:24576
    v_exp_f32 v95, v95
    v_exp_f32 v96, v96
    v_exp_f32 v97, v97
    v_exp_f32 v98, v98
    v_exp_f32 v99, v99
    v_exp_f32 v36, v36
    v_exp_f32 v37, v37
    s_waitcnt lgkmcnt(0)
    v_smfmac_f32_32x32x32_bf16 v[136:151], v[32:35], v[92:99], v26
    ds_read_b128 v[32:35], v103 offset:25280
    v_exp_f32 v38, v38
    v_exp_f32 v39, v39
    v_exp_f32 v40, v40
    v_mfma_f32_32x32x16_bf16 v[68:83], v[20:23], v[4:7], v[152:167]
    v_exp_f32 v41, v41
    v_exp_f32 v42, v42
    v_exp_f32 v43, v43
    v_mfma_f32_32x32x16_bf16 v[84:99], v[20:23], v[8:11], v[168:183]
    s_waitcnt vmcnt(3)
    s_barrier
    s_add_u32 m0, s64, 12288
    s_add_u32 s63, s63, 12288
    buffer_load_dwordx4 v14, s[28:31], s63 offen offset:0 sc1 lds
    buffer_load_dwordx4 v14, s[28:31], s63 offen offset:1024 sc1 lds
    buffer_load_dwordx4 v14, s[28:31], s63 offen offset:2048 sc1 lds
    s_add_u32 m0, s66, 49152
    s_nop 0
    buffer_load_dwordx4 v16, s[16:19], s65 offen lds
    s_add_u32 m0, s66, 57344
    s_nop 0
    buffer_load_dwordx4 v17, s[16:19], s65 offen lds
    s_add_u32 s67, s67, 327680
    buffer_load_dwordx2 v[112:113], v238, s[20:23], s67 offen offset:0
    ds_read_b128 v[20:23], v27 offset:36864
    v_exp_f32 v44, v44
    v_exp_f32 v45, v45
    v_exp_f32 v46, v46
    v_exp_f32 v47, v47
    v_smfmac_f32_32x32x32_bf16 v[120:135], v[28:31], v[36:43], v26
    v_exp_f32 v48, v48
    v_exp_f32 v49, v49
    v_exp_f32 v50, v50
    v_exp_f32 v51, v51
    v_mfma_f32_32x32x4bf16_1k v[68:99], v[24:25], v[12:13], v[68:99]
    ds_read_b64 v[24:25], v102 offset:36864
    v_exp_f32 v52, v52
    v_exp_f32 v53, v53
    v_exp_f32 v54, v54
    v_exp_f32 v55, v55
    v_exp_f32 v56, v56
    v_exp_f32 v57, v57
    v_exp_f32 v58, v58
    s_waitcnt lgkmcnt(2)
    v_smfmac_f32_32x32x32_bf16 v[120:135], v[32:35], v[44:51], v26
    v_exp_f32 v59, v59
    v_exp_f32 v60, v60
    v_exp_f32 v61, v61
    v_exp_f32 v62, v62
    v_smfmac_f32_32x32x32_bf16 v[136:151], v[28:31], v[52:59], v26
    ds_read_b128 v[28:31], v103 offset:27648
    v_exp_f32 v63, v63
    v_exp_f32 v64, v64
    v_exp_f32 v65, v65
    v_exp_f32 v66, v66
    v_exp_f32 v67, v67
    v_exp_f32 v68, v68
    v_exp_f32 v69, v69
    s_waitcnt lgkmcnt(0)
    v_smfmac_f32_32x32x32_bf16 v[136:151], v[32:35], v[60:67], v26
    ds_read_b128 v[32:35], v103 offset:28352
    v_exp_f32 v70, v70
    v_exp_f32 v71, v71
    v_exp_f32 v72, v72
    v_mfma_f32_32x32x16_bf16 v[36:51], v[20:23], v[4:7], v[152:167]
    v_exp_f32 v73, v73
    v_exp_f32 v74, v74
    v_exp_f32 v75, v75
    v_mfma_f32_32x32x16_bf16 v[52:67], v[20:23], v[8:11], v[168:183]
    ds_read_b128 v[20:23], v27 offset:39936
    v_exp_f32 v76, v76
    v_exp_f32 v77, v77
    v_exp_f32 v78, v78
    v_exp_f32 v79, v79
    v_smfmac_f32_32x32x32_bf16 v[120:135], v[28:31], v[68:75], v26
    v_exp_f32 v80, v80
    v_exp_f32 v81, v81
    v_exp_f32 v82, v82
    v_exp_f32 v83, v83
    v_mfma_f32_32x32x4bf16_1k v[36:67], v[24:25], v[12:13], v[36:67]
    ds_read_b64 v[24:25], v102 offset:39936
    v_exp_f32 v84, v84
    v_exp_f32 v85, v85
    v_exp_f32 v86, v86
    v_exp_f32 v87, v87
    v_exp_f32 v88, v88
    v_exp_f32 v89, v89
    v_exp_f32 v90, v90
    s_waitcnt lgkmcnt(2)
    v_smfmac_f32_32x32x32_bf16 v[120:135], v[32:35], v[76:83], v26
    v_exp_f32 v91, v91
    v_exp_f32 v92, v92
    v_exp_f32 v93, v93
    v_exp_f32 v94, v94
    v_smfmac_f32_32x32x32_bf16 v[136:151], v[28:31], v[84:91], v26
    ds_read_b128 v[28:31], v103 offset:36864
    v_exp_f32 v95, v95
    v_exp_f32 v96, v96
    v_exp_f32 v97, v97
    v_exp_f32 v98, v98
    v_exp_f32 v99, v99
    v_exp_f32 v36, v36
    v_exp_f32 v37, v37
    s_waitcnt lgkmcnt(0)
    v_smfmac_f32_32x32x32_bf16 v[136:151], v[32:35], v[92:99], v26
    ds_read_b128 v[32:35], v103 offset:37568
    v_exp_f32 v38, v38
    v_exp_f32 v39, v39
    v_exp_f32 v40, v40
    v_mfma_f32_32x32x16_bf16 v[68:83], v[20:23], v[4:7], v[152:167]
    v_exp_f32 v41, v41
    v_exp_f32 v42, v42
    v_exp_f32 v43, v43
    v_mfma_f32_32x32x16_bf16 v[84:99], v[20:23], v[8:11], v[168:183]
    s_barrier
    ds_read_b128 v[20:23], v27 offset:0
    v_exp_f32 v44, v44
    v_exp_f32 v45, v45
    v_exp_f32 v46, v46
    v_exp_f32 v47, v47
    v_smfmac_f32_32x32x32_bf16 v[120:135], v[28:31], v[36:43], v26
    v_exp_f32 v48, v48
    v_exp_f32 v49, v49
    v_exp_f32 v50, v50
    v_exp_f32 v51, v51
    v_mfma_f32_32x32x4bf16_1k v[68:99], v[24:25], v[12:13], v[68:99]
    ds_read_b64 v[24:25], v102 offset:0
    v_exp_f32 v52, v52
    v_exp_f32 v53, v53
    v_exp_f32 v54, v54
    v_exp_f32 v55, v55
    v_exp_f32 v56, v56
    v_exp_f32 v57, v57
    v_exp_f32 v58, v58
    s_waitcnt lgkmcnt(2)
    v_smfmac_f32_32x32x32_bf16 v[120:135], v[32:35], v[44:51], v26
    v_exp_f32 v59, v59
    v_exp_f32 v60, v60
    v_exp_f32 v61, v61
    v_exp_f32 v62, v62
    v_smfmac_f32_32x32x32_bf16 v[136:151], v[28:31], v[52:59], v26
    ds_read_b128 v[28:31], v103 offset:39936
    v_exp_f32 v63, v63
    v_exp_f32 v64, v64
    v_exp_f32 v65, v65
    v_exp_f32 v66, v66
    v_exp_f32 v67, v67
    v_exp_f32 v68, v68
    v_exp_f32 v69, v69
    s_waitcnt lgkmcnt(0)
    v_smfmac_f32_32x32x32_bf16 v[136:151], v[32:35], v[60:67], v26
    ds_read_b128 v[32:35], v103 offset:40640
    v_exp_f32 v70, v70
    v_exp_f32 v71, v71
    v_exp_f32 v72, v72
    v_mfma_f32_32x32x16_bf16 v[36:51], v[20:23], v[4:7], v[152:167]
    v_exp_f32 v73, v73
    v_exp_f32 v74, v74
    v_exp_f32 v75, v75
    v_mfma_f32_32x32x16_bf16 v[52:67], v[20:23], v[8:11], v[168:183]
    ds_read_b128 v[20:23], v27 offset:3072
    v_exp_f32 v76, v76
    v_exp_f32 v77, v77
    v_exp_f32 v78, v78
    v_exp_f32 v79, v79
    v_smfmac_f32_32x32x32_bf16 v[120:135], v[28:31], v[68:75], v26
    v_exp_f32 v80, v80
    v_exp_f32 v81, v81
    v_exp_f32 v82, v82
    v_exp_f32 v83, v83
    v_mfma_f32_32x32x4bf16_1k v[36:67], v[24:25], v[12:13], v[36:67]
    ds_read_b64 v[24:25], v102 offset:3072
    v_exp_f32 v84, v84
    v_exp_f32 v85, v85
    v_exp_f32 v86, v86
    v_exp_f32 v87, v87
    v_exp_f32 v88, v88
    v_exp_f32 v89, v89
    v_exp_f32 v90, v90
    s_waitcnt lgkmcnt(2)
    v_smfmac_f32_32x32x32_bf16 v[120:135], v[32:35], v[76:83], v26
    v_exp_f32 v91, v91
    v_exp_f32 v92, v92
    v_exp_f32 v93, v93
    v_exp_f32 v94, v94
    v_smfmac_f32_32x32x32_bf16 v[136:151], v[28:31], v[84:91], v26
    ds_read_b128 v[28:31], v103 offset:0
    v_exp_f32 v95, v95
    v_exp_f32 v96, v96
    v_exp_f32 v97, v97
    v_exp_f32 v98, v98
    v_exp_f32 v99, v99
    v_exp_f32 v36, v36
    v_exp_f32 v37, v37
    s_waitcnt lgkmcnt(0)
    v_smfmac_f32_32x32x32_bf16 v[136:151], v[32:35], v[92:99], v26
    ds_read_b128 v[32:35], v103 offset:704
    v_exp_f32 v38, v38
    v_exp_f32 v39, v39
    v_exp_f32 v40, v40
    v_mfma_f32_32x32x16_bf16 v[68:83], v[20:23], v[4:7], v[152:167]
    v_exp_f32 v41, v41
    v_exp_f32 v42, v42
    v_exp_f32 v43, v43
    v_mfma_f32_32x32x16_bf16 v[84:99], v[20:23], v[8:11], v[168:183]
    s_waitcnt vmcnt(3)
    s_barrier
    s_add_u32 m0, s64, 36864
    s_add_u32 s63, s63, 12288
    buffer_load_dwordx4 v14, s[28:31], s63 offen offset:0 sc1 lds
    buffer_load_dwordx4 v14, s[28:31], s63 offen offset:1024 sc1 lds
    buffer_load_dwordx4 v14, s[28:31], s63 offen offset:2048 sc1 lds
    s_add_u32 m0, s66, 65536
    s_nop 0
    buffer_load_dwordx4 v18, s[16:19], s65 offen lds
    s_add_u32 m0, s66, 73728
    s_nop 0
    buffer_load_dwordx4 v19, s[16:19], s65 offen lds
    buffer_load_dwordx2 v[114:115], v238, s[20:23], s67 offen offset:1280
    ds_read_b128 v[20:23], v27 offset:12288
    v_exp_f32 v44, v44
    v_exp_f32 v45, v45
    v_exp_f32 v46, v46
    v_exp_f32 v47, v47
    v_smfmac_f32_32x32x32_bf16 v[120:135], v[28:31], v[36:43], v26
    v_exp_f32 v48, v48
    v_exp_f32 v49, v49
    v_exp_f32 v50, v50
    v_exp_f32 v51, v51
    v_mfma_f32_32x32x4bf16_1k v[68:99], v[24:25], v[12:13], v[68:99]
    ds_read_b64 v[24:25], v102 offset:12288
    v_exp_f32 v52, v52
    v_exp_f32 v53, v53
    v_exp_f32 v54, v54
    v_exp_f32 v55, v55
    v_exp_f32 v56, v56
    v_exp_f32 v57, v57
    v_exp_f32 v58, v58
    s_waitcnt lgkmcnt(2)
    v_smfmac_f32_32x32x32_bf16 v[120:135], v[32:35], v[44:51], v26
    v_exp_f32 v59, v59
    v_exp_f32 v60, v60
    v_exp_f32 v61, v61
    v_exp_f32 v62, v62
    v_smfmac_f32_32x32x32_bf16 v[136:151], v[28:31], v[52:59], v26
    ds_read_b128 v[28:31], v103 offset:3072
    v_exp_f32 v63, v63
    v_exp_f32 v64, v64
    v_exp_f32 v65, v65
    v_exp_f32 v66, v66
    v_exp_f32 v67, v67
    v_exp_f32 v68, v68
    v_exp_f32 v69, v69
    s_waitcnt lgkmcnt(0)
    v_smfmac_f32_32x32x32_bf16 v[136:151], v[32:35], v[60:67], v26
    ds_read_b128 v[32:35], v103 offset:3776
    v_exp_f32 v70, v70
    v_exp_f32 v71, v71
    v_exp_f32 v72, v72
    v_mfma_f32_32x32x16_bf16 v[36:51], v[20:23], v[4:7], v[152:167]
    v_exp_f32 v73, v73
    v_exp_f32 v74, v74
    v_exp_f32 v75, v75
    v_mfma_f32_32x32x16_bf16 v[52:67], v[20:23], v[8:11], v[168:183]
    ds_read_b128 v[20:23], v27 offset:15360
    v_exp_f32 v76, v76
    v_exp_f32 v77, v77
    v_exp_f32 v78, v78
    v_exp_f32 v79, v79
    v_smfmac_f32_32x32x32_bf16 v[120:135], v[28:31], v[68:75], v26
    v_exp_f32 v80, v80
    v_exp_f32 v81, v81
    v_exp_f32 v82, v82
    v_exp_f32 v83, v83
    v_mfma_f32_32x32x4bf16_1k v[36:67], v[24:25], v[12:13], v[36:67]
    ds_read_b64 v[24:25], v102 offset:15360
    v_exp_f32 v84, v84
    v_exp_f32 v85, v85
    v_exp_f32 v86, v86
    v_exp_f32 v87, v87
    v_exp_f32 v88, v88
    v_exp_f32 v89, v89
    v_exp_f32 v90, v90
    s_waitcnt lgkmcnt(2)
    v_smfmac_f32_32x32x32_bf16 v[120:135], v[32:35], v[76:83], v26
    v_exp_f32 v91, v91
    v_exp_f32 v92, v92
    v_exp_f32 v93, v93
    v_exp_f32 v94, v94
    v_smfmac_f32_32x32x32_bf16 v[136:151], v[28:31], v[84:91], v26
    ds_read_b128 v[28:31], v103 offset:12288
    v_exp_f32 v95, v95
    v_exp_f32 v96, v96
    v_exp_f32 v97, v97
    v_exp_f32 v98, v98
    v_exp_f32 v99, v99
    v_exp_f32 v36, v36
    v_exp_f32 v37, v37
    s_waitcnt lgkmcnt(0)
    v_smfmac_f32_32x32x32_bf16 v[136:151], v[32:35], v[92:99], v26
    ds_read_b128 v[32:35], v103 offset:12992
    v_exp_f32 v38, v38
    v_exp_f32 v39, v39
    v_exp_f32 v40, v40
    v_mfma_f32_32x32x16_bf16 v[68:83], v[20:23], v[4:7], v[152:167]
    v_exp_f32 v41, v41
    v_exp_f32 v42, v42
    v_exp_f32 v43, v43
    v_mfma_f32_32x32x16_bf16 v[84:99], v[20:23], v[8:11], v[168:183]
    s_barrier
    ds_read_b128 v[20:23], v27 offset:24576
    v_exp_f32 v44, v44
    v_exp_f32 v45, v45
    v_exp_f32 v46, v46
    v_exp_f32 v47, v47
    v_smfmac_f32_32x32x32_bf16 v[120:135], v[28:31], v[36:43], v26
    v_exp_f32 v48, v48
    v_exp_f32 v49, v49
    v_exp_f32 v50, v50
    v_exp_f32 v51, v51
    v_mfma_f32_32x32x4bf16_1k v[68:99], v[24:25], v[12:13], v[68:99]
    ds_read_b64 v[24:25], v102 offset:24576
    v_exp_f32 v52, v52
    v_exp_f32 v53, v53
    v_exp_f32 v54, v54
    v_exp_f32 v55, v55
    v_exp_f32 v56, v56
    v_exp_f32 v57, v57
    v_exp_f32 v58, v58
    s_waitcnt lgkmcnt(2)
    v_smfmac_f32_32x32x32_bf16 v[120:135], v[32:35], v[44:51], v26
    v_exp_f32 v59, v59
    v_exp_f32 v60, v60
    v_exp_f32 v61, v61
    v_exp_f32 v62, v62
    v_smfmac_f32_32x32x32_bf16 v[136:151], v[28:31], v[52:59], v26
    ds_read_b128 v[28:31], v103 offset:15360
    v_exp_f32 v63, v63
    v_exp_f32 v64, v64
    v_exp_f32 v65, v65
    v_exp_f32 v66, v66
    v_exp_f32 v67, v67
    v_exp_f32 v68, v68
    v_exp_f32 v69, v69
    s_waitcnt lgkmcnt(0)
    v_smfmac_f32_32x32x32_bf16 v[136:151], v[32:35], v[60:67], v26
    ds_read_b128 v[32:35], v103 offset:16064
    v_exp_f32 v70, v70
    v_exp_f32 v71, v71
    v_exp_f32 v72, v72
    v_mfma_f32_32x32x16_bf16 v[36:51], v[20:23], v[4:7], v[152:167]
    v_exp_f32 v73, v73
    v_exp_f32 v74, v74
    v_exp_f32 v75, v75
    v_mfma_f32_32x32x16_bf16 v[52:67], v[20:23], v[8:11], v[168:183]
    ds_read_b128 v[20:23], v27 offset:27648
    v_exp_f32 v76, v76
    v_exp_f32 v77, v77
    v_exp_f32 v78, v78
    v_exp_f32 v79, v79
    v_smfmac_f32_32x32x32_bf16 v[120:135], v[28:31], v[68:75], v26
    v_exp_f32 v80, v80
    v_exp_f32 v81, v81
    v_exp_f32 v82, v82
    v_exp_f32 v83, v83
    v_mfma_f32_32x32x4bf16_1k v[36:67], v[24:25], v[12:13], v[36:67]
    ds_read_b64 v[24:25], v102 offset:27648
    v_exp_f32 v84, v84
    v_exp_f32 v85, v85
    v_exp_f32 v86, v86
    v_exp_f32 v87, v87
    v_exp_f32 v88, v88
    v_exp_f32 v89, v89
    v_exp_f32 v90, v90
    s_waitcnt lgkmcnt(2)
    v_smfmac_f32_32x32x32_bf16 v[120:135], v[32:35], v[76:83], v26
    v_exp_f32 v91, v91
    v_exp_f32 v92, v92
    v_exp_f32 v93, v93
    v_exp_f32 v94, v94
    v_smfmac_f32_32x32x32_bf16 v[136:151], v[28:31], v[84:91], v26
    ds_read_b128 v[28:31], v103 offset:24576
    v_exp_f32 v95, v95
    v_exp_f32 v96, v96
    v_exp_f32 v97, v97
    v_exp_f32 v98, v98
    v_exp_f32 v99, v99
    v_exp_f32 v36, v36
    v_exp_f32 v37, v37
    s_waitcnt lgkmcnt(0)
    v_smfmac_f32_32x32x32_bf16 v[136:151], v[32:35], v[92:99], v26
    ds_read_b128 v[32:35], v103 offset:25280
    v_exp_f32 v38, v38
    v_exp_f32 v39, v39
    v_exp_f32 v40, v40
    v_mfma_f32_32x32x16_bf16 v[68:83], v[20:23], v[4:7], v[152:167]
    v_exp_f32 v41, v41
    v_exp_f32 v42, v42
    v_exp_f32 v43, v43
    v_mfma_f32_32x32x16_bf16 v[84:99], v[20:23], v[8:11], v[168:183]
    s_waitcnt vmcnt(3)
    s_barrier
    s_add_u32 m0, s64, 12288
    s_add_u32 s63, s63, 12288
    buffer_load_dwordx4 v14, s[28:31], s63 offen offset:0 sc1 lds
    buffer_load_dwordx4 v14, s[28:31], s63 offen offset:1024 sc1 lds
    buffer_load_dwordx4 v14, s[28:31], s63 offen offset:2048 sc1 lds
    s_add_u32 s65, s65, 327680
    s_add_u32 m0, s66, 81920
    s_nop 0
    buffer_load_dwordx4 v15, s[16:19], s65 offen lds
    s_add_u32 m0, s66, 90112
    s_nop 0
    buffer_load_dwordx4 v16, s[16:19], s65 offen lds
    buffer_load_dwordx2 v[116:117], v238, s[20:23], s67 offen offset:2560
    ds_read_b128 v[20:23], v27 offset:36864
    v_exp_f32 v44, v44
    v_exp_f32 v45, v45
    v_exp_f32 v46, v46
    v_exp_f32 v47, v47
    v_smfmac_f32_32x32x32_bf16 v[120:135], v[28:31], v[36:43], v26
    v_exp_f32 v48, v48
    v_exp_f32 v49, v49
    v_exp_f32 v50, v50
    v_exp_f32 v51, v51
    v_mfma_f32_32x32x4bf16_1k v[68:99], v[24:25], v[12:13], v[68:99]
    ds_read_b64 v[24:25], v102 offset:36864
    v_exp_f32 v52, v52
    v_exp_f32 v53, v53
    v_exp_f32 v54, v54
    v_exp_f32 v55, v55
    v_exp_f32 v56, v56
    v_exp_f32 v57, v57
    v_exp_f32 v58, v58
    s_waitcnt lgkmcnt(2)
    v_smfmac_f32_32x32x32_bf16 v[120:135], v[32:35], v[44:51], v26
    v_exp_f32 v59, v59
    v_exp_f32 v60, v60
    v_exp_f32 v61, v61
    v_exp_f32 v62, v62
    v_smfmac_f32_32x32x32_bf16 v[136:151], v[28:31], v[52:59], v26
    ds_read_b128 v[28:31], v103 offset:27648
    v_exp_f32 v63, v63
    v_exp_f32 v64, v64
    v_exp_f32 v65, v65
    v_exp_f32 v66, v66
    v_exp_f32 v67, v67
    v_exp_f32 v68, v68
    v_exp_f32 v69, v69
    s_waitcnt lgkmcnt(0)
    v_smfmac_f32_32x32x32_bf16 v[136:151], v[32:35], v[60:67], v26
    ds_read_b128 v[32:35], v103 offset:28352
    v_exp_f32 v70, v70
    v_exp_f32 v71, v71
    v_exp_f32 v72, v72
    v_mfma_f32_32x32x16_bf16 v[36:51], v[20:23], v[4:7], v[152:167]
    v_exp_f32 v73, v73
    v_exp_f32 v74, v74
    v_exp_f32 v75, v75
    v_mfma_f32_32x32x16_bf16 v[52:67], v[20:23], v[8:11], v[168:183]
    ds_read_b128 v[20:23], v27 offset:39936
    v_exp_f32 v76, v76
    v_exp_f32 v77, v77
    v_exp_f32 v78, v78
    v_exp_f32 v79, v79
    v_smfmac_f32_32x32x32_bf16 v[120:135], v[28:31], v[68:75], v26
    v_exp_f32 v80, v80
    v_exp_f32 v81, v81
    v_exp_f32 v82, v82
    v_exp_f32 v83, v83
    v_mfma_f32_32x32x4bf16_1k v[36:67], v[24:25], v[12:13], v[36:67]
    ds_read_b64 v[24:25], v102 offset:39936
    v_exp_f32 v84, v84
    v_exp_f32 v85, v85
    v_exp_f32 v86, v86
    v_exp_f32 v87, v87
    v_exp_f32 v88, v88
    v_exp_f32 v89, v89
    v_exp_f32 v90, v90
    s_waitcnt lgkmcnt(2)
    v_smfmac_f32_32x32x32_bf16 v[120:135], v[32:35], v[76:83], v26
    v_exp_f32 v91, v91
    v_exp_f32 v92, v92
    v_exp_f32 v93, v93
    v_exp_f32 v94, v94
    v_smfmac_f32_32x32x32_bf16 v[136:151], v[28:31], v[84:91], v26
    ds_read_b128 v[28:31], v103 offset:36864
    v_exp_f32 v95, v95
    v_exp_f32 v96, v96
    v_exp_f32 v97, v97
    v_exp_f32 v98, v98
    v_exp_f32 v99, v99
    v_exp_f32 v36, v36
    v_exp_f32 v37, v37
    s_waitcnt lgkmcnt(0)
    v_smfmac_f32_32x32x32_bf16 v[136:151], v[32:35], v[92:99], v26
    ds_read_b128 v[32:35], v103 offset:37568
    v_exp_f32 v38, v38
    v_exp_f32 v39, v39
    v_exp_f32 v40, v40
    v_mfma_f32_32x32x16_bf16 v[68:83], v[20:23], v[4:7], v[152:167]
    v_exp_f32 v41, v41
    v_exp_f32 v42, v42
    v_exp_f32 v43, v43
    v_mfma_f32_32x32x16_bf16 v[84:99], v[20:23], v[8:11], v[168:183]
    s_barrier
    ds_read_b128 v[20:23], v27 offset:0
    v_exp_f32 v44, v44
    v_exp_f32 v45, v45
    v_exp_f32 v46, v46
    v_exp_f32 v47, v47
    v_smfmac_f32_32x32x32_bf16 v[120:135], v[28:31], v[36:43], v26
    v_exp_f32 v48, v48
    v_exp_f32 v49, v49
    v_exp_f32 v50, v50
    v_exp_f32 v51, v51
    v_mfma_f32_32x32x4bf16_1k v[68:99], v[24:25], v[12:13], v[68:99]
    ds_read_b64 v[24:25], v102 offset:0
    v_exp_f32 v52, v52
    v_exp_f32 v53, v53
    v_exp_f32 v54, v54
    v_exp_f32 v55, v55
    v_exp_f32 v56, v56
    v_exp_f32 v57, v57
    v_exp_f32 v58, v58
    s_waitcnt lgkmcnt(2)
    v_smfmac_f32_32x32x32_bf16 v[120:135], v[32:35], v[44:51], v26
    v_exp_f32 v59, v59
    v_exp_f32 v60, v60
    v_exp_f32 v61, v61
    v_exp_f32 v62, v62
    v_smfmac_f32_32x32x32_bf16 v[136:151], v[28:31], v[52:59], v26
    ds_read_b128 v[28:31], v103 offset:39936
    v_exp_f32 v63, v63
    v_exp_f32 v64, v64
    v_exp_f32 v65, v65
    v_exp_f32 v66, v66
    v_exp_f32 v67, v67
    v_exp_f32 v68, v68
    v_exp_f32 v69, v69
    s_waitcnt lgkmcnt(0)
    v_smfmac_f32_32x32x32_bf16 v[136:151], v[32:35], v[60:67], v26
    ds_read_b128 v[32:35], v103 offset:40640
    v_exp_f32 v70, v70
    v_exp_f32 v71, v71
    v_exp_f32 v72, v72
    v_mfma_f32_32x32x16_bf16 v[36:51], v[20:23], v[4:7], v[152:167]
    v_exp_f32 v73, v73
    v_exp_f32 v74, v74
    v_exp_f32 v75, v75
    v_mfma_f32_32x32x16_bf16 v[52:67], v[20:23], v[8:11], v[168:183]
    ds_read_b128 v[20:23], v27 offset:3072
    v_exp_f32 v76, v76
    v_exp_f32 v77, v77
    v_exp_f32 v78, v78
    v_exp_f32 v79, v79
    v_smfmac_f32_32x32x32_bf16 v[120:135], v[28:31], v[68:75], v26
    v_exp_f32 v80, v80
    v_exp_f32 v81, v81
    v_exp_f32 v82, v82
    v_exp_f32 v83, v83
    v_mfma_f32_32x32x4bf16_1k v[36:67], v[24:25], v[12:13], v[36:67]
    ds_read_b64 v[24:25], v102 offset:3072
    v_exp_f32 v84, v84
    v_exp_f32 v85, v85
    v_exp_f32 v86, v86
    v_exp_f32 v87, v87
    v_exp_f32 v88, v88
    v_exp_f32 v89, v89
    v_exp_f32 v90, v90
    s_waitcnt lgkmcnt(2)
    v_smfmac_f32_32x32x32_bf16 v[120:135], v[32:35], v[76:83], v26
    v_exp_f32 v91, v91
    v_exp_f32 v92, v92
    v_exp_f32 v93, v93
    v_exp_f32 v94, v94
    v_smfmac_f32_32x32x32_bf16 v[136:151], v[28:31], v[84:91], v26
    ds_read_b128 v[28:31], v103 offset:0
    v_exp_f32 v95, v95
    v_exp_f32 v96, v96
    v_exp_f32 v97, v97
    v_exp_f32 v98, v98
    v_exp_f32 v99, v99
    v_exp_f32 v36, v36
    v_exp_f32 v37, v37
    s_waitcnt lgkmcnt(0)
    v_smfmac_f32_32x32x32_bf16 v[136:151], v[32:35], v[92:99], v26
    ds_read_b128 v[32:35], v103 offset:704
    v_exp_f32 v38, v38
    v_exp_f32 v39, v39
    v_exp_f32 v40, v40
    v_mfma_f32_32x32x16_bf16 v[68:83], v[20:23], v[4:7], v[152:167]
    v_exp_f32 v41, v41
    v_exp_f32 v42, v42
    v_exp_f32 v43, v43
    v_mfma_f32_32x32x16_bf16 v[84:99], v[20:23], v[8:11], v[168:183]
    s_waitcnt vmcnt(3)
    s_barrier
    s_add_u32 m0, s64, 36864
    s_add_u32 s63, s63, 12288
    buffer_load_dwordx4 v14, s[28:31], s63 offen offset:0 sc1 lds
    buffer_load_dwordx4 v14, s[28:31], s63 offen offset:1024 sc1 lds
    buffer_load_dwordx4 v14, s[28:31], s63 offen offset:2048 sc1 lds
    buffer_load_dwordx2 v[118:119], v238, s[20:23], s67 offen offset:3840
    ds_read_b128 v[20:23], v27 offset:12288
    v_exp_f32 v44, v44
    v_exp_f32 v45, v45
    v_exp_f32 v46, v46
    v_exp_f32 v47, v47
    v_smfmac_f32_32x32x32_bf16 v[120:135], v[28:31], v[36:43], v26
    v_exp_f32 v48, v48
    v_exp_f32 v49, v49
    v_exp_f32 v50, v50
    v_exp_f32 v51, v51
    v_mfma_f32_32x32x4bf16_1k v[68:99], v[24:25], v[12:13], v[68:99]
    ds_read_b64 v[24:25], v102 offset:12288
    v_exp_f32 v52, v52
    v_exp_f32 v53, v53
    v_exp_f32 v54, v54
    v_exp_f32 v55, v55
    v_exp_f32 v56, v56
    v_exp_f32 v57, v57
    v_exp_f32 v58, v58
    s_waitcnt lgkmcnt(2)
    v_smfmac_f32_32x32x32_bf16 v[120:135], v[32:35], v[44:51], v26
    v_exp_f32 v59, v59
    v_exp_f32 v60, v60
    v_exp_f32 v61, v61
    v_exp_f32 v62, v62
    v_smfmac_f32_32x32x32_bf16 v[136:151], v[28:31], v[52:59], v26
    ds_read_b128 v[28:31], v103 offset:3072
    v_exp_f32 v63, v63
    v_exp_f32 v64, v64
    v_exp_f32 v65, v65
    v_exp_f32 v66, v66
    v_exp_f32 v67, v67
    v_exp_f32 v68, v68
    v_exp_f32 v69, v69
    s_waitcnt lgkmcnt(0)
    v_smfmac_f32_32x32x32_bf16 v[136:151], v[32:35], v[60:67], v26
    ds_read_b128 v[32:35], v103 offset:3776
    v_exp_f32 v70, v70
    v_exp_f32 v71, v71
    v_exp_f32 v72, v72
    v_mfma_f32_32x32x16_bf16 v[36:51], v[20:23], v[4:7], v[152:167]
    v_exp_f32 v73, v73
    v_exp_f32 v74, v74
    v_exp_f32 v75, v75
    v_mfma_f32_32x32x16_bf16 v[52:67], v[20:23], v[8:11], v[168:183]
    ds_read_b128 v[20:23], v27 offset:15360
    v_exp_f32 v76, v76
    v_exp_f32 v77, v77
    v_exp_f32 v78, v78
    v_exp_f32 v79, v79
    v_smfmac_f32_32x32x32_bf16 v[120:135], v[28:31], v[68:75], v26
    v_exp_f32 v80, v80
    v_exp_f32 v81, v81
    v_exp_f32 v82, v82
    v_exp_f32 v83, v83
    v_mfma_f32_32x32x4bf16_1k v[36:67], v[24:25], v[12:13], v[36:67]
    ds_read_b64 v[24:25], v102 offset:15360
    v_exp_f32 v84, v84
    v_exp_f32 v85, v85
    v_exp_f32 v86, v86
    v_exp_f32 v87, v87
    v_exp_f32 v88, v88
    v_exp_f32 v89, v89
    v_exp_f32 v90, v90
    s_waitcnt lgkmcnt(2)
    v_smfmac_f32_32x32x32_bf16 v[120:135], v[32:35], v[76:83], v26
    v_exp_f32 v91, v91
    v_exp_f32 v92, v92
    v_exp_f32 v93, v93
    v_exp_f32 v94, v94
    v_smfmac_f32_32x32x32_bf16 v[136:151], v[28:31], v[84:91], v26
    ds_read_b128 v[28:31], v103 offset:12288
    v_exp_f32 v95, v95
    v_exp_f32 v96, v96
    v_exp_f32 v97, v97
    v_exp_f32 v98, v98
    v_exp_f32 v99, v99
    v_exp_f32 v36, v36
    v_exp_f32 v37, v37
    s_waitcnt lgkmcnt(0)
    v_smfmac_f32_32x32x32_bf16 v[136:151], v[32:35], v[92:99], v26
    ds_read_b128 v[32:35], v103 offset:12992
    v_exp_f32 v38, v38
    v_exp_f32 v39, v39
    v_exp_f32 v40, v40
    v_mfma_f32_32x32x16_bf16 v[68:83], v[20:23], v[4:7], v[152:167]
    v_exp_f32 v41, v41
    v_exp_f32 v42, v42
    v_exp_f32 v43, v43
    v_mfma_f32_32x32x16_bf16 v[84:99], v[20:23], v[8:11], v[168:183]
    s_barrier
    ds_read_b128 v[20:23], v27 offset:24576
    v_exp_f32 v44, v44
    v_exp_f32 v45, v45
    v_exp_f32 v46, v46
    v_exp_f32 v47, v47
    v_smfmac_f32_32x32x32_bf16 v[120:135], v[28:31], v[36:43], v26
    v_exp_f32 v48, v48
    v_exp_f32 v49, v49
    v_exp_f32 v50, v50
    v_exp_f32 v51, v51
    v_mfma_f32_32x32x4bf16_1k v[68:99], v[24:25], v[12:13], v[68:99]
    ds_read_b64 v[24:25], v102 offset:24576
    v_exp_f32 v52, v52
    v_exp_f32 v53, v53
    v_exp_f32 v54, v54
    v_exp_f32 v55, v55
    v_exp_f32 v56, v56
    v_exp_f32 v57, v57
    v_exp_f32 v58, v58
    s_waitcnt lgkmcnt(2)
    v_smfmac_f32_32x32x32_bf16 v[120:135], v[32:35], v[44:51], v26
    v_exp_f32 v59, v59
    v_exp_f32 v60, v60
    v_exp_f32 v61, v61
    v_exp_f32 v62, v62
    v_smfmac_f32_32x32x32_bf16 v[136:151], v[28:31], v[52:59], v26
    ds_read_b128 v[28:31], v103 offset:15360
    v_exp_f32 v63, v63
    v_exp_f32 v64, v64
    v_exp_f32 v65, v65
    v_exp_f32 v66, v66
    v_exp_f32 v67, v67
    v_exp_f32 v68, v68
    v_exp_f32 v69, v69
    s_waitcnt lgkmcnt(0)
    v_smfmac_f32_32x32x32_bf16 v[136:151], v[32:35], v[60:67], v26
    ds_read_b128 v[32:35], v103 offset:16064
    v_exp_f32 v70, v70
    v_exp_f32 v71, v71
    v_exp_f32 v72, v72
    v_mfma_f32_32x32x16_bf16 v[36:51], v[20:23], v[4:7], v[152:167]
    v_exp_f32 v73, v73
    v_exp_f32 v74, v74
    v_exp_f32 v75, v75
    v_mfma_f32_32x32x16_bf16 v[52:67], v[20:23], v[8:11], v[168:183]
    ds_read_b128 v[20:23], v27 offset:27648
    v_exp_f32 v76, v76
    v_exp_f32 v77, v77
    v_exp_f32 v78, v78
    v_exp_f32 v79, v79
    v_smfmac_f32_32x32x32_bf16 v[120:135], v[28:31], v[68:75], v26
    v_exp_f32 v80, v80
    v_exp_f32 v81, v81
    v_exp_f32 v82, v82
    v_exp_f32 v83, v83
    v_mfma_f32_32x32x4bf16_1k v[36:67], v[24:25], v[12:13], v[36:67]
    ds_read_b64 v[24:25], v102 offset:27648
    v_exp_f32 v84, v84
    v_exp_f32 v85, v85
    v_exp_f32 v86, v86
    v_exp_f32 v87, v87
    v_exp_f32 v88, v88
    v_exp_f32 v89, v89
    v_exp_f32 v90, v90
    s_waitcnt lgkmcnt(2)
    v_smfmac_f32_32x32x32_bf16 v[120:135], v[32:35], v[76:83], v26
    v_exp_f32 v91, v91
    v_exp_f32 v92, v92
    v_exp_f32 v93, v93
    v_exp_f32 v94, v94
    v_smfmac_f32_32x32x32_bf16 v[136:151], v[28:31], v[84:91], v26
    ds_read_b128 v[28:31], v103 offset:24576
    v_exp_f32 v95, v95
    v_exp_f32 v96, v96
    v_exp_f32 v97, v97
    v_exp_f32 v98, v98
    v_exp_f32 v99, v99
    v_exp_f32 v36, v36
    v_exp_f32 v37, v37
    s_waitcnt lgkmcnt(0)
    v_smfmac_f32_32x32x32_bf16 v[136:151], v[32:35], v[92:99], v26
    ds_read_b128 v[32:35], v103 offset:25280
    v_exp_f32 v38, v38
    v_exp_f32 v39, v39
    v_exp_f32 v40, v40
    v_mfma_f32_32x32x16_bf16 v[68:83], v[20:23], v[4:7], v[152:167]
    v_exp_f32 v41, v41
    v_exp_f32 v42, v42
    v_exp_f32 v43, v43
    v_mfma_f32_32x32x16_bf16 v[84:99], v[20:23], v[8:11], v[168:183]
    s_waitcnt vmcnt(1)
    s_barrier
    s_setprio 1
    ds_read_b128 v[20:23], v27 offset:36864
    v_exp_f32 v44, v44
    v_exp_f32 v45, v45
    v_exp_f32 v46, v46
    v_exp_f32 v47, v47
    v_smfmac_f32_32x32x32_bf16 v[120:135], v[28:31], v[36:43], v26
    v_exp_f32 v48, v48
    v_exp_f32 v49, v49
    v_exp_f32 v50, v50
    v_exp_f32 v51, v51
    v_mfma_f32_32x32x4bf16_1k v[68:99], v[24:25], v[12:13], v[68:99]
    ds_read_b64 v[24:25], v102 offset:36864
    v_exp_f32 v52, v52
    v_exp_f32 v53, v53
    v_exp_f32 v54, v54
    v_exp_f32 v55, v55
    v_exp_f32 v56, v56
    v_exp_f32 v57, v57
    v_exp_f32 v58, v58
    s_waitcnt lgkmcnt(2)
    v_smfmac_f32_32x32x32_bf16 v[120:135], v[32:35], v[44:51], v26
    v_exp_f32 v59, v59
    v_exp_f32 v60, v60
    v_exp_f32 v61, v61
    v_exp_f32 v62, v62
    v_smfmac_f32_32x32x32_bf16 v[136:151], v[28:31], v[52:59], v26
    ds_read_b128 v[28:31], v103 offset:27648
    v_exp_f32 v63, v63
    v_exp_f32 v64, v64
    v_exp_f32 v65, v65
    v_exp_f32 v66, v66
    v_exp_f32 v67, v67
    v_exp_f32 v68, v68
    v_exp_f32 v69, v69
    s_waitcnt lgkmcnt(0)
    v_smfmac_f32_32x32x32_bf16 v[136:151], v[32:35], v[60:67], v26
    ds_read_b128 v[32:35], v103 offset:28352
    v_exp_f32 v70, v70
    v_exp_f32 v71, v71
    v_exp_f32 v72, v72
    v_mfma_f32_32x32x16_bf16 v[36:51], v[20:23], v[4:7], v[152:167]
    v_exp_f32 v73, v73
    v_exp_f32 v74, v74
    v_exp_f32 v75, v75
    v_mfma_f32_32x32x16_bf16 v[52:67], v[20:23], v[8:11], v[168:183]
    ds_read_b128 v[20:23], v27 offset:39936
    v_exp_f32 v76, v76
    v_exp_f32 v77, v77
    v_exp_f32 v78, v78
    v_exp_f32 v79, v79
    v_smfmac_f32_32x32x32_bf16 v[120:135], v[28:31], v[68:75], v26
    v_exp_f32 v80, v80
    v_exp_f32 v81, v81
    v_exp_f32 v82, v82
    v_exp_f32 v83, v83
    v_mfma_f32_32x32x4bf16_1k v[36:67], v[24:25], v[12:13], v[36:67]
    ds_read_b64 v[24:25], v102 offset:39936
    v_exp_f32 v84, v84
    v_exp_f32 v85, v85
    v_exp_f32 v86, v86
    v_exp_f32 v87, v87
    v_exp_f32 v88, v88
    v_exp_f32 v89, v89
    v_exp_f32 v90, v90
    s_waitcnt lgkmcnt(2)
    v_smfmac_f32_32x32x32_bf16 v[120:135], v[32:35], v[76:83], v26
    v_exp_f32 v91, v91
    v_exp_f32 v92, v92
    v_exp_f32 v93, v93
    v_exp_f32 v94, v94
    v_smfmac_f32_32x32x32_bf16 v[136:151], v[28:31], v[84:91], v26
    ds_read_b128 v[28:31], v103 offset:36864
    v_exp_f32 v95, v95
    v_exp_f32 v96, v96
    v_exp_f32 v97, v97
    v_exp_f32 v98, v98
    v_exp_f32 v99, v99
    v_exp_f32 v36, v36
    v_exp_f32 v37, v37
    s_waitcnt lgkmcnt(0)
    v_smfmac_f32_32x32x32_bf16 v[136:151], v[32:35], v[92:99], v26
    ds_read_b128 v[32:35], v103 offset:37568
    v_exp_f32 v38, v38
    v_exp_f32 v39, v39
    v_exp_f32 v40, v40
    v_mfma_f32_32x32x16_bf16 v[68:83], v[20:23], v[4:7], v[152:167]
    v_exp_f32 v41, v41
    v_exp_f32 v42, v42
    v_exp_f32 v43, v43
    v_mfma_f32_32x32x16_bf16 v[84:99], v[20:23], v[8:11], v[168:183]
    v_exp_f32 v44, v44
    v_exp_f32 v45, v45
    v_exp_f32 v46, v46
    v_exp_f32 v47, v47
    v_smfmac_f32_32x32x32_bf16 v[120:135], v[28:31], v[36:43], v26
    v_exp_f32 v48, v48
    v_exp_f32 v49, v49
    v_exp_f32 v50, v50
    v_exp_f32 v51, v51
    s_nop 0
    v_mfma_f32_32x32x4bf16_1k v[68:99], v[24:25], v[12:13], v[68:99]
    v_exp_f32 v52, v52
    v_exp_f32 v53, v53
    v_exp_f32 v54, v54
    v_exp_f32 v55, v55
    v_exp_f32 v56, v56
    v_exp_f32 v57, v57
    v_exp_f32 v58, v58
    s_waitcnt lgkmcnt(0)
    v_smfmac_f32_32x32x32_bf16 v[120:135], v[32:35], v[44:51], v26
    v_exp_f32 v59, v59
    v_exp_f32 v60, v60
    v_exp_f32 v61, v61
    v_exp_f32 v62, v62
    v_smfmac_f32_32x32x32_bf16 v[136:151], v[28:31], v[52:59], v26
    ds_read_b128 v[28:31], v103 offset:39936
    v_exp_f32 v63, v63
    v_exp_f32 v64, v64
    v_exp_f32 v65, v65
    v_exp_f32 v66, v66
    v_exp_f32 v67, v67
    v_exp_f32 v68, v68
    v_exp_f32 v69, v69
    s_waitcnt lgkmcnt(0)
    v_smfmac_f32_32x32x32_bf16 v[136:151], v[32:35], v[60:67], v26
    ds_read_b128 v[32:35], v103 offset:40640
    v_exp_f32 v70, v70
    v_exp_f32 v71, v71
    v_exp_f32 v72, v72
    v_exp_f32 v73, v73
    v_exp_f32 v74, v74
    v_exp_f32 v75, v75
    v_exp_f32 v76, v76
    v_exp_f32 v77, v77
    v_exp_f32 v78, v78
    v_exp_f32 v79, v79
    v_smfmac_f32_32x32x32_bf16 v[120:135], v[28:31], v[68:75], v26
    v_exp_f32 v80, v80
    v_exp_f32 v81, v81
    v_exp_f32 v82, v82
    v_exp_f32 v83, v83
    v_exp_f32 v84, v84
    v_exp_f32 v85, v85
    v_exp_f32 v86, v86
    v_exp_f32 v87, v87
    v_exp_f32 v88, v88
    v_exp_f32 v89, v89
    v_exp_f32 v90, v90
    s_waitcnt lgkmcnt(0)
    v_smfmac_f32_32x32x32_bf16 v[120:135], v[32:35], v[76:83], v26
    v_exp_f32 v91, v91
    v_exp_f32 v92, v92
    v_exp_f32 v93, v93
    v_exp_f32 v94, v94
    v_smfmac_f32_32x32x32_bf16 v[136:151], v[28:31], v[84:91], v26
    v_exp_f32 v95, v95
    v_exp_f32 v96, v96
    v_exp_f32 v97, v97
    v_exp_f32 v98, v98
    v_exp_f32 v99, v99
    s_lshl_b32 s63, s56, 1
    s_and_b32 s63, s63, 6
    s_mul_i32 s63, s63, 3072
    v_smfmac_f32_32x32x32_bf16 v[136:151], v[32:35], v[92:99], v26
    s_setprio 0
    v_add_u32 v1, s63, v14
    ds_write_b128 v1, v[120:123] offset:3072
    ds_write_b128 v1, v[124:127] offset:4096
    ds_write_b128 v1, v[128:131] offset:5120
    s_cmp_eq_u32 s59, 0
    s_cbranch_scc1 L_noprep
    s_mov_b32 s70, 0x05040100
    s_mov_b32 s71, 0x07060302
    v_mov_b32 v84, 0
    v_mov_b32 v85, 0
    v_mov_b32 v86, 0
    v_mov_b32 v87, 0
    v_mov_b32 v88, 0
    v_mov_b32 v89, 0
    v_mov_b32 v90, 0
    v_mov_b32 v91, 0
    v_mov_b32 v92, 0
    v_mov_b32 v93, 0
    v_mov_b32 v94, 0
    v_mov_b32 v95, 0
    v_mov_b32 v96, 0
    v_mov_b32 v97, 0
    v_mov_b32 v98, 0
    v_mov_b32 v99, 0
    v_readlane_b32 s65, v237, 0
    v_readlane_b32 s66, v187, 0
    v_readlane_b32 s67, v191, 0
    s_and_b32 s65, s65, 0xffff
    s_lshl_b32 s69, s65, 16
    s_or_b32 s65, s65, s69
    s_lshr_b32 s68, s66, 16
    v_writelane_b32 v85, s69, 0
    v_writelane_b32 v86, s65, 0
    v_writelane_b32 v87, s65, 0
    v_writelane_b32 v90, s65, 0
    v_writelane_b32 v91, s65, 0
    v_writelane_b32 v94, s69, 0
    v_writelane_b32 v95, s65, 0
    v_writelane_b32 v99, s65, 0
    v_writelane_b32 v88, s68, 4
    v_writelane_b32 v92, s66, 4
    v_writelane_b32 v96, s67, 4
    v_writelane_b32 v97, s68, 4
    s_waitcnt vmcnt(0)
    v_perm_b32 v68, v106, v104, s70
    v_perm_b32 v69, v110, v108, s70
    v_perm_b32 v70, v106, v104, s71
    v_perm_b32 v71, v110, v108, s71
    v_perm_b32 v72, v107, v105, s70
    v_perm_b32 v73, v111, v109, s70
    v_perm_b32 v74, v107, v105, s71
    v_perm_b32 v75, v111, v109, s71
    v_perm_b32 v76, v114, v112, s70
    v_perm_b32 v77, v118, v116, s70
    v_perm_b32 v78, v114, v112, s71
    v_perm_b32 v79, v118, v116, s71
    v_perm_b32 v80, v115, v113, s70
    v_perm_b32 v81, v119, v117, s70
    v_perm_b32 v82, v115, v113, s71
    v_perm_b32 v83, v119, v117, s71
L_noprep:
    s_waitcnt lgkmcnt(0)
    s_barrier
    ds_read_b128 v[36:39], v1 offset:0
    ds_read_b128 v[40:43], v1 offset:1024
    ds_read_b128 v[44:47], v1 offset:2048
    s_mul_i32 s63, s57, 81920
    s_add_u32 s63, s63, 1081344
    s_add_u32 s64, s63, 40960
    s_and_b32 s65, s56, 3
    s_lshl_b32 s66, s58, 2
    s_add_u32 s66, s66, s65
    s_lshl_b32 s67, s66, 9
    s_add_u32 s63, s63, s67
    s_lshl_b32 s67, s66, 7
    s_add_u32 s64, s64, s67
    v_and_b32 v1, 15, v0
    v_bfe_u32 v2, v0, 4, 1
    v_lshrrev_b32 v3, 5, v0
    v_lshlrev_b32 v232, 4, v1
    v_lshl_add_u32 v232, v3, 8, v232
    v_lshl_add_u32 v232, v2, 14, v232
    v_lshlrev_b32 v233, 3, v1
    v_lshl_add_u32 v233, v2, 12, v233
    s_waitcnt lgkmcnt(0)
    v_mov_b32 v1, 60416
    v_mov_b32 v2, 1
    s_mov_b64 exec, 1
    ds_add_u32 v1, v2 offset:48
    s_mov_b64 exec, -1
    v_add_f32 v234, v144, v44
    v_add_f32 v235, v144, v44
    v_pk_add_f32 v[136:137], v[136:137], v[36:37]
    v_pk_add_f32 v[138:139], v[138:139], v[38:39]
    v_pk_add_f32 v[140:141], v[140:141], v[40:41]
    v_pk_add_f32 v[142:143], v[142:143], v[42:43]
    v_pk_add_f32 v[144:145], v[144:145], v[44:45]
    v_pk_add_f32 v[146:147], v[146:147], v[46:47]
    v_permlane32_swap_b32 v234, v235
    v_rcp_f32 v235, v235
    s_nop 0
    v_mul_f32 v136, v136, v235
    v_mul_f32 v137, v137, v235
    v_mul_f32 v138, v138, v235
    v_mul_f32 v139, v139, v235
    v_mul_f32 v140, v140, v235
    v_mul_f32 v141, v141, v235
    v_mul_f32 v142, v142, v235
    v_mul_f32 v143, v143, v235
    v_mul_f32 v144, v144, v235
    v_mul_f32 v145, v145, v235
    v_mul_f32 v146, v146, v235
    v_mul_f32 v147, v147, v235
    v_cvt_pk_bf16_f32 v224, v136, v137
    v_cvt_pk_bf16_f32 v225, v138, v139
    v_cvt_pk_bf16_f32 v226, v140, v141
    v_cvt_pk_bf16_f32 v227, v142, v143
    v_cvt_pk_bf16_f32 v228, v144, v145
    v_cvt_pk_bf16_f32 v229, v146, v147
    buffer_store_dwordx4 v[224:227], v232, s[28:31], s63 offen sc1
    s_mov_b32 exec_hi, 0
    buffer_store_dwordx2 v[228:229], v233, s[28:31], s64 offen sc1
    s_mov_b32 exec_hi, -1
    s_cmp_eq_u32 s59, 0
    s_cbranch_scc0 L_ssmtail
    s_waitcnt vmcnt(0)
    v_mov_b32 v1, 60416
    v_mov_b32 v2, 1
    s_mov_b64 exec, 1
    ds_add_u32 v1, v2 offset:36
    s_mov_b64 exec, -1
    s_waitcnt lgkmcnt(0)
    s_endpgm
L_ssmtail:
    ds_write_b128 v219, v[184:187] offset:1024
    ds_write_b128 v219, v[188:191] offset:3264
    ds_write_b128 v219, v[192:195] offset:5504
    ds_write_b128 v219, v[196:199] offset:7744
    ds_write_b128 v219, v[200:203] offset:0
    ds_write_b128 v219, v[204:207] offset:2240
    ds_write_b128 v219, v[208:211] offset:4480
    ds_write_b128 v219, v[212:215] offset:6720
    s_mov_b64 exec, 0x3f
    ds_write_b128 v220, v[84:87] offset:0
    ds_write_b128 v220, v[88:91] offset:2240
    ds_write_b128 v220, v[92:95] offset:4480
    ds_write_b128 v220, v[96:99] offset:6720
    s_mov_b64 exec, -1
    s_sub_u32 s68, s56, 4
    s_mul_i32 s63, s68, 8960
    s_add_u32 s63, s63, 24576
    s_mul_i32 s64, s68, 4608
    s_mul_i32 s67, s68, 655360
    s_lshl_b32 s66, s60, 1
    s_add_u32 s67, s67, s66
    s_add_u32 s67, s67, 1280
    v_mov_b32 v228, 0
    v_mov_b32 v229, 0
    v_mov_b32 v230, 0
    v_mov_b32 v231, 0
    v_mov_b32 v1, 60416
    s_mov_b32 s69, 200000
L_lw_21:
    ds_read_b32 v2, v1 offset:48
    s_sub_u32 s69, s69, 1
    s_waitcnt lgkmcnt(0)
    v_readfirstlane_b32 s65, v2
    s_cmp_ge_u32 s65, 8
    s_cbranch_scc1 L_lg_22
    s_sleep 1
    s_cmp_lg_u32 s69, 0
    s_cbranch_scc1 L_lw_21
L_lg_22:
    ds_write_b64 v221, v[68:69] offset:0
    ds_write_b64 v221, v[70:71] offset:4608
    ds_write_b64 v221, v[72:73] offset:9216
    ds_write_b64 v221, v[74:75] offset:13824
    ds_write_b64 v221, v[76:77] offset:512
    ds_write_b64 v221, v[78:79] offset:5120
    ds_write_b64 v221, v[80:81] offset:9728
    ds_write_b64 v221, v[82:83] offset:14336
    s_mov_b32 exec_hi, 0x0fffffff
    ds_write_b64 v251, v[228:229]
    s_mov_b32 exec_hi, -1
    v_mov_b32 v1, 60416
    v_mov_b32 v2, 1
    s_mov_b64 exec, 1
    ds_add_u32 v1, v2 offset:32
    s_mov_b64 exec, -1
    ds_read_b64 v[4:5], v216 offset:2048
    ds_read_b64 v[6:7], v216 offset:2056
    ds_read_b64 v[68:69], v216 offset:1536
    ds_read_b64 v[70:71], v216 offset:1544
    s_waitcnt vmcnt(0)
    v_mov_b32 v1, 60416
    v_mov_b32 v2, 1
    s_mov_b64 exec, 1
    ds_add_u32 v1, v2 offset:36
    s_mov_b64 exec, -1
    s_setprio 2
    v_mov_b32 v1, 60416
    s_mov_b32 s69, 200000
L_lw_23:
    ds_read_b32 v2, v1 offset:32
    s_sub_u32 s69, s69, 1
    s_waitcnt lgkmcnt(0)
    v_readfirstlane_b32 s65, v2
    s_cmp_ge_u32 s65, 4
    s_cbranch_scc1 L_lg_24
    s_sleep 1
    s_cmp_lg_u32 s69, 0
    s_cbranch_scc1 L_lw_23
L_lg_24:
    ds_read_b64 v[104:105], v216 offset:1024
    ds_read_b64 v[106:107], v216 offset:1032
    ds_read_b64 v[168:169], v216 offset:512
    ds_read_b64 v[170:171], v216 offset:520
    ds_read_b128 v[132:135], v217 offset:1984
    ds_read_b128 v[128:131], v217 offset:1472
    ds_read_b128 v[124:127], v217 offset:960
    ds_read_b128 v[120:123], v217 offset:448
    s_waitcnt lgkmcnt(3)
    v_mfma_f32_16x16x32_bf16 v[48:51], v[4:7], v[132:135], 0
    ds_read_b128 v[132:135], v217 offset:1920
    ds_read_b64 v[8:9], v216 offset:1984
    ds_read_b64 v[10:11], v216 offset:1992
    s_waitcnt lgkmcnt(5)
    v_mfma_f32_16x16x32_bf16 v[44:47], v[4:7], v[128:131], 0
    s_waitcnt lgkmcnt(4)
    v_mfma_f32_16x16x32_bf16 v[40:43], v[4:7], v[124:127], 0
    ds_read_b64 v[72:73], v216 offset:1472
    ds_read_b64 v[74:75], v216 offset:1480
    s_waitcnt lgkmcnt(5)
    v_mfma_f32_16x16x32_bf16 v[36:39], v[4:7], v[120:123], 0
    v_mfma_f32_16x16x32_bf16 v[48:51], v[68:71], v[128:131], v[48:51]
    ds_read_b128 v[128:131], v217 offset:1408
    ds_read_b64 v[108:109], v216 offset:960
    ds_read_b64 v[110:111], v216 offset:968
    v_mfma_f32_16x16x32_bf16 v[44:47], v[68:71], v[124:127], v[44:47]
    v_mfma_f32_16x16x32_bf16 v[40:43], v[68:71], v[120:123], v[40:43]
    ds_read_b64 v[172:173], v216 offset:448
    ds_read_b64 v[174:175], v216 offset:456
    v_mfma_f32_16x16x32_bf16 v[48:51], v[104:107], v[124:127], v[48:51]
    ds_read_b128 v[124:127], v217 offset:896
    v_mfma_f32_16x16x32_bf16 v[44:47], v[104:107], v[120:123], v[44:47]
    v_mfma_f32_16x16x32_bf16 v[48:51], v[168:171], v[120:123], v[48:51]
    ds_read_b128 v[120:123], v217 offset:384
    s_waitcnt lgkmcnt(9)
    v_mfma_f32_16x16x32_bf16 v[48:51], v[8:11], v[132:135], v[48:51]
    ds_read_b128 v[132:135], v217 offset:1856
    ds_read_b64 v[12:13], v216 offset:1920
    ds_read_b64 v[14:15], v216 offset:1928
    s_waitcnt lgkmcnt(9)
    v_mfma_f32_16x16x32_bf16 v[44:47], v[8:11], v[128:131], v[44:47]
    s_waitcnt lgkmcnt(4)
    v_mfma_f32_16x16x32_bf16 v[40:43], v[8:11], v[124:127], v[40:43]
    ds_read_b64 v[76:77], v216 offset:1408
    ds_read_b64 v[78:79], v216 offset:1416
    s_waitcnt lgkmcnt(5)
    v_mfma_f32_16x16x32_bf16 v[36:39], v[8:11], v[120:123], v[36:39]
    v_mfma_f32_16x16x32_bf16 v[48:51], v[72:75], v[128:131], v[48:51]
    ds_read_b128 v[128:131], v217 offset:1344
    ds_read_b64 v[112:113], v216 offset:896
    ds_read_b64 v[114:115], v216 offset:904
    v_mfma_f32_16x16x32_bf16 v[44:47], v[72:75], v[124:127], v[44:47]
    v_mfma_f32_16x16x32_bf16 v[40:43], v[72:75], v[120:123], v[40:43]
    ds_read_b64 v[176:177], v216 offset:384
    ds_read_b64 v[178:179], v216 offset:392
    v_mfma_f32_16x16x32_bf16 v[48:51], v[108:111], v[124:127], v[48:51]
    ds_read_b128 v[124:127], v217 offset:832
    v_mfma_f32_16x16x32_bf16 v[44:47], v[108:111], v[120:123], v[44:47]
    v_mfma_f32_16x16x32_bf16 v[48:51], v[172:175], v[120:123], v[48:51]
    ds_read_b128 v[120:123], v217 offset:320
    s_waitcnt lgkmcnt(9)
    v_mfma_f32_16x16x32_bf16 v[48:51], v[12:15], v[132:135], v[48:51]
    ds_read_b128 v[132:135], v217 offset:1792
    ds_read_b64 v[16:17], v216 offset:1856
    ds_read_b64 v[18:19], v216 offset:1864
    s_waitcnt lgkmcnt(9)
    v_mfma_f32_16x16x32_bf16 v[44:47], v[12:15], v[128:131], v[44:47]
    ds_read_b64 v[200:201], v216 offset:0
    ds_read_b64 v[202:203], v216 offset:8
    ds_read_b128 v[136:139], v252 offset:0
    ds_read_b128 v[140:143], v252 offset:512
    ds_read_b128 v[144:147], v252 offset:1024
    ds_read_b128 v[148:151], v252 offset:1536
    s_waitcnt lgkmcnt(10)
    v_mfma_f32_16x16x32_bf16 v[40:43], v[12:15], v[124:127], v[40:43]
    ds_read_b64 v[80:81], v216 offset:1344
    ds_read_b64 v[82:83], v216 offset:1352
    s_waitcnt lgkmcnt(11)
    v_mfma_f32_16x16x32_bf16 v[36:39], v[12:15], v[120:123], v[36:39]
    v_mfma_f32_16x16x32_bf16 v[48:51], v[76:79], v[128:131], v[48:51]
    ds_read_b128 v[128:131], v217 offset:1280
    ds_read_b64 v[116:117], v216 offset:832
    ds_read_b64 v[118:119], v216 offset:840
    v_mfma_f32_16x16x32_bf16 v[44:47], v[76:79], v[124:127], v[44:47]
    v_mfma_f32_16x16x32_bf16 v[40:43], v[76:79], v[120:123], v[40:43]
    ds_read_b64 v[180:181], v216 offset:320
    ds_read_b64 v[182:183], v216 offset:328
    v_mfma_f32_16x16x32_bf16 v[48:51], v[112:115], v[124:127], v[48:51]
    ds_read_b128 v[124:127], v217 offset:768
    v_mfma_f32_16x16x32_bf16 v[44:47], v[112:115], v[120:123], v[44:47]
    v_mfma_f32_16x16x32_bf16 v[48:51], v[176:179], v[120:123], v[48:51]
    ds_read_b128 v[120:123], v217 offset:256
    s_waitcnt lgkmcnt(15)
    v_mfma_f32_16x16x32_bf16 v[48:51], v[16:19], v[132:135], v[48:51]
    ds_read_b128 v[132:135], v217 offset:1728
    ds_read_b64 v[20:21], v216 offset:1792
    ds_read_b64 v[22:23], v216 offset:1800
    s_waitcnt lgkmcnt(9)
    v_mfma_f32_16x16x32_bf16 v[44:47], v[16:19], v[128:131], v[44:47]
    v_mfma_f32_16x16x32_bf16 v[52:55], v[240:243], v[136:139], 0
    v_mfma_f32_16x16x32_bf16 v[56:59], v[240:243], v[140:143], 0
    v_mfma_f32_16x16x32_bf16 v[60:63], v[240:243], v[144:147], 0
    v_mfma_f32_16x16x32_bf16 v[64:67], v[240:243], v[148:151], 0
    s_waitcnt lgkmcnt(4)
    v_mfma_f32_16x16x32_bf16 v[40:43], v[16:19], v[124:127], v[40:43]
    ds_read_b64 v[84:85], v216 offset:1280
    ds_read_b64 v[86:87], v216 offset:1288
    s_waitcnt lgkmcnt(5)
    v_mfma_f32_16x16x32_bf16 v[36:39], v[16:19], v[120:123], v[36:39]
    v_mfma_f32_16x16x32_bf16 v[48:51], v[80:83], v[128:131], v[48:51]
    ds_read_b128 v[128:131], v217 offset:1216
    ds_read_b64 v[152:153], v216 offset:768
    ds_read_b64 v[154:155], v216 offset:776
    v_mfma_f32_16x16x32_bf16 v[44:47], v[80:83], v[124:127], v[44:47]
    v_mfma_f32_16x16x32_bf16 v[40:43], v[80:83], v[120:123], v[40:43]
    ds_read_b64 v[184:185], v216 offset:256
    ds_read_b64 v[186:187], v216 offset:264
    v_mfma_f32_16x16x32_bf16 v[48:51], v[116:119], v[124:127], v[48:51]
    ds_read_b128 v[124:127], v217 offset:704
    v_mfma_f32_16x16x32_bf16 v[44:47], v[116:119], v[120:123], v[44:47]
    v_mfma_f32_16x16x32_bf16 v[48:51], v[180:183], v[120:123], v[48:51]
    ds_read_b128 v[120:123], v217 offset:192
    s_waitcnt lgkmcnt(9)
    v_mfma_f32_16x16x32_bf16 v[48:51], v[20:23], v[132:135], v[48:51]
    ds_read_b128 v[132:135], v217 offset:1664
    ds_read_b64 v[24:25], v216 offset:1728
    ds_read_b64 v[26:27], v216 offset:1736
    s_waitcnt lgkmcnt(9)
    v_mfma_f32_16x16x32_bf16 v[44:47], v[20:23], v[128:131], v[44:47]
    v_cvt_pk_bf16_f32 v204, v52, v53
    v_cvt_pk_bf16_f32 v205, v54, v55
    v_cvt_pk_bf16_f32 v206, v56, v57
    v_cvt_pk_bf16_f32 v207, v58, v59
    v_cvt_pk_bf16_f32 v208, v60, v61
    v_cvt_pk_bf16_f32 v209, v62, v63
    v_cvt_pk_bf16_f32 v210, v64, v65
    v_cvt_pk_bf16_f32 v211, v66, v67
    ds_read_b128 v[136:139], v217 offset:448
    ds_read_b128 v[140:143], v217 offset:960
    ds_read_b128 v[144:147], v217 offset:1472
    ds_read_b128 v[148:151], v217 offset:1984
    s_waitcnt lgkmcnt(8)
    v_mfma_f32_16x16x32_bf16 v[40:43], v[20:23], v[124:127], v[40:43]
    ds_read_b64 v[88:89], v216 offset:1216
    ds_read_b64 v[90:91], v216 offset:1224
    s_waitcnt lgkmcnt(9)
    v_mfma_f32_16x16x32_bf16 v[36:39], v[20:23], v[120:123], v[36:39]
    v_mfma_f32_16x16x32_bf16 v[48:51], v[84:87], v[128:131], v[48:51]
    ds_read_b128 v[128:131], v217 offset:1152
    ds_read_b64 v[156:157], v216 offset:704
    ds_read_b64 v[158:159], v216 offset:712
    v_mfma_f32_16x16x32_bf16 v[44:47], v[84:87], v[124:127], v[44:47]
    v_mfma_f32_16x16x32_bf16 v[40:43], v[84:87], v[120:123], v[40:43]
    ds_read_b64 v[188:189], v216 offset:192
    ds_read_b64 v[190:191], v216 offset:200
    v_mfma_f32_16x16x32_bf16 v[48:51], v[152:155], v[124:127], v[48:51]
    ds_read_b128 v[124:127], v217 offset:640
    v_mfma_f32_16x16x32_bf16 v[44:47], v[152:155], v[120:123], v[44:47]
    v_mfma_f32_16x16x32_bf16 v[48:51], v[184:187], v[120:123], v[48:51]
    ds_read_b128 v[120:123], v217 offset:128
    s_waitcnt lgkmcnt(13)
    v_mfma_f32_16x16x32_bf16 v[48:51], v[24:27], v[132:135], v[48:51]
    ds_read_b128 v[132:135], v217 offset:1600
    ds_read_b64 v[28:29], v216 offset:1664
    ds_read_b64 v[30:31], v216 offset:1672
    s_waitcnt lgkmcnt(9)
    v_mfma_f32_16x16x32_bf16 v[44:47], v[24:27], v[128:131], v[44:47]
    v_mfma_f32_16x16x32_bf16 v[52:55], v[244:247], v[136:139], 0
    v_mfma_f32_16x16x32_bf16 v[56:59], v[244:247], v[140:143], 0
    v_mfma_f32_16x16x32_bf16 v[60:63], v[244:247], v[144:147], 0
    v_mfma_f32_16x16x32_bf16 v[64:67], v[244:247], v[148:151], 0
    s_waitcnt lgkmcnt(4)
    v_mfma_f32_16x16x32_bf16 v[40:43], v[24:27], v[124:127], v[40:43]
    ds_read_b64 v[92:93], v216 offset:1152
    ds_read_b64 v[94:95], v216 offset:1160
    s_waitcnt lgkmcnt(5)
    v_mfma_f32_16x16x32_bf16 v[36:39], v[24:27], v[120:123], v[36:39]
    v_mfma_f32_16x16x32_bf16 v[48:51], v[88:91], v[128:131], v[48:51]
    ds_read_b128 v[128:131], v217 offset:1088
    ds_read_b64 v[160:161], v216 offset:640
    ds_read_b64 v[162:163], v216 offset:648
    v_mfma_f32_16x16x32_bf16 v[44:47], v[88:91], v[124:127], v[44:47]
    v_mfma_f32_16x16x32_bf16 v[40:43], v[88:91], v[120:123], v[40:43]
    ds_read_b64 v[192:193], v216 offset:128
    ds_read_b64 v[194:195], v216 offset:136
    v_mfma_f32_16x16x32_bf16 v[48:51], v[156:159], v[124:127], v[48:51]
    ds_read_b128 v[124:127], v217 offset:576
    v_mfma_f32_16x16x32_bf16 v[44:47], v[156:159], v[120:123], v[44:47]
    v_mfma_f32_16x16x32_bf16 v[48:51], v[188:191], v[120:123], v[48:51]
    ds_read_b128 v[120:123], v217 offset:64
    s_waitcnt lgkmcnt(9)
    v_mfma_f32_16x16x32_bf16 v[48:51], v[28:31], v[132:135], v[48:51]
    ds_read_b128 v[132:135], v217 offset:1536
    ds_read_b64 v[32:33], v216 offset:1600
    ds_read_b64 v[34:35], v216 offset:1608
    s_waitcnt lgkmcnt(9)
    v_mfma_f32_16x16x32_bf16 v[44:47], v[28:31], v[128:131], v[44:47]
    v_cvt_pk_bf16_f32 v212, v52, v53
    v_cvt_pk_bf16_f32 v213, v54, v55
    v_cvt_pk_bf16_f32 v214, v56, v57
    v_cvt_pk_bf16_f32 v215, v58, v59
    v_cvt_pk_bf16_f32 v232, v60, v61
    v_cvt_pk_bf16_f32 v233, v62, v63
    v_cvt_pk_bf16_f32 v234, v64, v65
    v_cvt_pk_bf16_f32 v235, v66, v67
    s_waitcnt lgkmcnt(4)
    v_mfma_f32_16x16x32_bf16 v[40:43], v[28:31], v[124:127], v[40:43]
    ds_read_b64 v[96:97], v216 offset:1088
    ds_read_b64 v[98:99], v216 offset:1096
    s_waitcnt lgkmcnt(5)
    v_mfma_f32_16x16x32_bf16 v[36:39], v[28:31], v[120:123], v[36:39]
    v_mfma_f32_16x16x32_bf16 v[48:51], v[92:95], v[128:131], v[48:51]
    ds_read_b128 v[128:131], v217 offset:1024
    ds_read_b64 v[164:165], v216 offset:576
    ds_read_b64 v[166:167], v216 offset:584
    v_mfma_f32_16x16x32_bf16 v[44:47], v[92:95], v[124:127], v[44:47]
    v_mfma_f32_16x16x32_bf16 v[40:43], v[92:95], v[120:123], v[40:43]
    ds_read_b64 v[196:197], v216 offset:64
    ds_read_b64 v[198:199], v216 offset:72
    v_mfma_f32_16x16x32_bf16 v[48:51], v[160:163], v[124:127], v[48:51]
    ds_read_b128 v[124:127], v217 offset:512
    v_mfma_f32_16x16x32_bf16 v[44:47], v[160:163], v[120:123], v[44:47]
    v_mfma_f32_16x16x32_bf16 v[48:51], v[192:195], v[120:123], v[48:51]
    ds_read_b128 v[120:123], v217 offset:0
    s_waitcnt lgkmcnt(9)
    v_mfma_f32_16x16x32_bf16 v[48:51], v[32:35], v[132:135], v[48:51]
    ds_read_b128 v[132:135], v217 offset:1984
    s_waitcnt lgkmcnt(7)
    v_mfma_f32_16x16x32_bf16 v[44:47], v[32:35], v[128:131], v[44:47]
    ds_read_b128 v[148:151], v217 offset:4032
    ds_read_b128 v[144:147], v217 offset:3520
    ds_read_b128 v[140:143], v217 offset:3008
    ds_read_b128 v[136:139], v217 offset:2496
    s_waitcnt lgkmcnt(6)
    v_mfma_f32_16x16x32_bf16 v[40:43], v[32:35], v[124:127], v[40:43]
    s_waitcnt lgkmcnt(5)
    v_mfma_f32_16x16x32_bf16 v[36:39], v[32:35], v[120:123], v[36:39]
    v_mfma_f32_16x16x32_bf16 v[48:51], v[96:99], v[128:131], v[48:51]
    ds_read_b128 v[128:131], v217 offset:1472
    v_mfma_f32_16x16x32_bf16 v[44:47], v[96:99], v[124:127], v[44:47]
    v_mfma_f32_16x16x32_bf16 v[40:43], v[96:99], v[120:123], v[40:43]
    v_mfma_f32_16x16x32_bf16 v[48:51], v[164:167], v[124:127], v[48:51]
    ds_read_b128 v[124:127], v217 offset:960
    v_mfma_f32_16x16x32_bf16 v[44:47], v[164:167], v[120:123], v[44:47]
    v_mfma_f32_16x16x32_bf16 v[48:51], v[196:199], v[120:123], v[48:51]
    ds_read_b128 v[120:123], v217 offset:448
    v_add_u32 v3, s63, v218
    v_cvt_pk_bf16_f32 v36, v36, v37
    v_cvt_pk_bf16_f32 v37, v38, v39
    ds_write_b64 v3, v[36:37] offset:0
    v_cvt_pk_bf16_f32 v40, v40, v41
    v_cvt_pk_bf16_f32 v41, v42, v43
    ds_write_b64 v3, v[40:41] offset:512
    v_cvt_pk_bf16_f32 v44, v44, v45
    v_cvt_pk_bf16_f32 v45, v46, v47
    ds_write_b64 v3, v[44:45] offset:1024
    v_cvt_pk_bf16_f32 v48, v48, v49
    v_cvt_pk_bf16_f32 v49, v50, v51
    ds_write_b64 v3, v[48:49] offset:1536
    v_mov_b32 v1, 60416
    v_mov_b32 v2, 1
    s_mov_b64 exec, 1
    ds_add_u32 v1, v2 offset:40
    s_mov_b64 exec, -1
    s_waitcnt lgkmcnt(11)
    v_mfma_f32_16x16x32_bf16 v[64:67], v[4:7], v[148:151], 0
    ds_read_b128 v[148:151], v217 offset:3968
    s_waitcnt lgkmcnt(11)
    v_mfma_f32_16x16x32_bf16 v[60:63], v[4:7], v[144:147], 0
    v_add_u32 v3, s63, v218
    ds_write_b64 v3, v[204:205] offset:2048
    ds_write_b64 v3, v[206:207] offset:2560
    ds_write_b64 v3, v[208:209] offset:3072
    ds_write_b64 v3, v[210:211] offset:3584
    s_waitcnt lgkmcnt(14)
    v_mfma_f32_16x16x32_bf16 v[56:59], v[4:7], v[140:143], 0
    s_waitcnt lgkmcnt(13)
    v_mfma_f32_16x16x32_bf16 v[52:55], v[4:7], v[136:139], 0
    s_waitcnt lgkmcnt(10)
    v_mfma_f32_16x16x32_bf16 v[52:55], v[200:203], v[120:123], v[52:55]
    v_mfma_f32_16x16x32_bf16 v[56:59], v[200:203], v[124:127], v[56:59]
    v_mfma_f32_16x16x32_bf16 v[60:63], v[200:203], v[128:131], v[60:63]
    v_mfma_f32_16x16x32_bf16 v[64:67], v[200:203], v[132:135], v[64:67]
    v_mfma_f32_16x16x32_bf16 v[64:67], v[68:71], v[144:147], v[64:67]
    ds_read_b128 v[144:147], v217 offset:3456
    v_mfma_f32_16x16x32_bf16 v[60:63], v[68:71], v[140:143], v[60:63]
    v_mfma_f32_16x16x32_bf16 v[56:59], v[68:71], v[136:139], v[56:59]
    v_mfma_f32_16x16x32_bf16 v[52:55], v[68:71], v[132:135], v[52:55]
    v_mfma_f32_16x16x32_bf16 v[64:67], v[104:107], v[140:143], v[64:67]
    ds_read_b128 v[140:143], v217 offset:2944
    v_mfma_f32_16x16x32_bf16 v[60:63], v[104:107], v[136:139], v[60:63]
    v_mfma_f32_16x16x32_bf16 v[56:59], v[104:107], v[132:135], v[56:59]
    v_mfma_f32_16x16x32_bf16 v[52:55], v[104:107], v[128:131], v[52:55]
    v_mfma_f32_16x16x32_bf16 v[64:67], v[168:171], v[136:139], v[64:67]
    ds_read_b128 v[136:139], v217 offset:2432
    v_mfma_f32_16x16x32_bf16 v[60:63], v[168:171], v[132:135], v[60:63]
    ds_read_b128 v[132:135], v217 offset:1920
    v_mfma_f32_16x16x32_bf16 v[56:59], v[168:171], v[128:131], v[56:59]
    ds_read_b128 v[128:131], v217 offset:1408
    v_mfma_f32_16x16x32_bf16 v[52:55], v[168:171], v[124:127], v[52:55]
    ds_read_b128 v[124:127], v217 offset:896
    v_mov_b32 v1, 60416
    ds_read_b32 v2, v1 offset:40
    s_waitcnt lgkmcnt(11)
    v_mfma_f32_16x16x32_bf16 v[64:67], v[8:11], v[148:151], v[64:67]
    ds_read_b128 v[148:151], v217 offset:3904
    s_waitcnt lgkmcnt(7)
    v_mfma_f32_16x16x32_bf16 v[60:63], v[8:11], v[144:147], v[60:63]
    s_waitcnt lgkmcnt(1)
    v_readfirstlane_b32 s65, v2
    s_cmp_ge_u32 s65, 4
    s_cbranch_scc1 L_ygo_25
    v_mov_b32 v1, 60416
    s_mov_b32 s69, 200000
L_lw_26:
    ds_read_b32 v2, v1 offset:40
    s_sub_u32 s69, s69, 1
    s_waitcnt lgkmcnt(0)
    v_readfirstlane_b32 s65, v2
    s_cmp_ge_u32 s65, 4
    s_cbranch_scc1 L_lg_27
    s_sleep 1
    s_cmp_lg_u32 s69, 0
    s_cbranch_scc1 L_lw_26
L_lg_27:
L_ygo_25:
    ds_read_b64 v[36:37], v223 offset:24576
    ds_read_b64 v[38:39], v223 offset:33536
    ds_read_b64 v[40:41], v223 offset:42496
    ds_read_b64 v[42:43], v223 offset:51456
    v_add_u32 v3, s63, v218
    ds_write_b64 v3, v[212:213] offset:4096
    ds_write_b64 v3, v[214:215] offset:4608
    ds_write_b64 v3, v[232:233] offset:5120
    ds_write_b64 v3, v[234:235] offset:5632
    v_mfma_f32_16x16x32_bf16 v[56:59], v[8:11], v[140:143], v[56:59]
    v_mfma_f32_16x16x32_bf16 v[52:55], v[8:11], v[136:139], v[52:55]
    v_mfma_f32_16x16x32_bf16 v[64:67], v[72:75], v[144:147], v[64:67]
    ds_read_b128 v[144:147], v217 offset:3392
    v_mfma_f32_16x16x32_bf16 v[60:63], v[72:75], v[140:143], v[60:63]
    v_mfma_f32_16x16x32_bf16 v[56:59], v[72:75], v[136:139], v[56:59]
    v_mfma_f32_16x16x32_bf16 v[52:55], v[72:75], v[132:135], v[52:55]
    v_mfma_f32_16x16x32_bf16 v[64:67], v[108:111], v[140:143], v[64:67]
    ds_read_b128 v[140:143], v217 offset:2880
    v_mfma_f32_16x16x32_bf16 v[60:63], v[108:111], v[136:139], v[60:63]
    v_mfma_f32_16x16x32_bf16 v[56:59], v[108:111], v[132:135], v[56:59]
    v_mfma_f32_16x16x32_bf16 v[52:55], v[108:111], v[128:131], v[52:55]
    v_mfma_f32_16x16x32_bf16 v[64:67], v[172:175], v[136:139], v[64:67]
    ds_read_b128 v[136:139], v217 offset:2368
    v_mfma_f32_16x16x32_bf16 v[60:63], v[172:175], v[132:135], v[60:63]
    ds_read_b128 v[132:135], v217 offset:1856
    v_mfma_f32_16x16x32_bf16 v[56:59], v[172:175], v[128:131], v[56:59]
    ds_read_b128 v[128:131], v217 offset:1344
    v_mfma_f32_16x16x32_bf16 v[52:55], v[172:175], v[124:127], v[52:55]
    ds_read_b128 v[124:127], v217 offset:832
    s_waitcnt lgkmcnt(14)
    v_mfma_f32_16x16x32_bf16 v[64:67], v[12:15], v[148:151], v[64:67]
    ds_read_b128 v[148:151], v217 offset:3840
    s_waitcnt lgkmcnt(6)
    v_mfma_f32_16x16x32_bf16 v[60:63], v[12:15], v[144:147], v[60:63]
    v_perm_b32 v44, v38, v36, s70
    v_perm_b32 v45, v42, v40, s70
    v_perm_b32 v46, v38, v36, s71
    v_perm_b32 v47, v42, v40, s71
    v_perm_b32 v48, v39, v37, s70
    v_perm_b32 v49, v43, v41, s70
    v_perm_b32 v50, v39, v37, s71
    v_perm_b32 v51, v43, v41, s71
    v_lshlrev_b32 v3, 4, v0
    v_add_u32 v3, s63, v3
    v_mov_b32 v204, 0
    v_mov_b32 v205, 0
    v_mov_b32 v206, 0
    v_mov_b32 v207, 0
    ds_write_b128 v3, v[204:207] offset:6144
    ds_write_b128 v3, v[204:207] offset:7168
    s_mov_b32 exec_hi, 0
    ds_write_b128 v3, v[204:207] offset:8192
    s_mov_b32 exec_hi, -1
    s_waitcnt lgkmcnt(8)
    v_mfma_f32_16x16x32_bf16 v[56:59], v[12:15], v[140:143], v[56:59]
    s_waitcnt lgkmcnt(7)
    v_mfma_f32_16x16x32_bf16 v[52:55], v[12:15], v[136:139], v[52:55]
    v_mfma_f32_16x16x32_bf16 v[64:67], v[76:79], v[144:147], v[64:67]
    ds_read_b128 v[144:147], v217 offset:3328
    v_mfma_f32_16x16x32_bf16 v[60:63], v[76:79], v[140:143], v[60:63]
    v_mfma_f32_16x16x32_bf16 v[56:59], v[76:79], v[136:139], v[56:59]
    s_waitcnt lgkmcnt(7)
    v_mfma_f32_16x16x32_bf16 v[52:55], v[76:79], v[132:135], v[52:55]
    v_mfma_f32_16x16x32_bf16 v[64:67], v[112:115], v[140:143], v[64:67]
    ds_read_b128 v[140:143], v217 offset:2816
    buffer_store_dwordx2 v[44:45], v222, s[24:27], s67 offen offset:0
    v_mfma_f32_16x16x32_bf16 v[60:63], v[112:115], v[136:139], v[60:63]
    v_mfma_f32_16x16x32_bf16 v[56:59], v[112:115], v[132:135], v[56:59]
    s_waitcnt lgkmcnt(7)
    v_mfma_f32_16x16x32_bf16 v[52:55], v[112:115], v[128:131], v[52:55]
    v_mfma_f32_16x16x32_bf16 v[64:67], v[176:179], v[136:139], v[64:67]
    ds_read_b128 v[136:139], v217 offset:2304
    v_mfma_f32_16x16x32_bf16 v[60:63], v[176:179], v[132:135], v[60:63]
    ds_read_b128 v[132:135], v217 offset:1792
    v_mfma_f32_16x16x32_bf16 v[56:59], v[176:179], v[128:131], v[56:59]
    ds_read_b128 v[128:131], v217 offset:1280
    s_waitcnt lgkmcnt(9)
    v_mfma_f32_16x16x32_bf16 v[52:55], v[176:179], v[124:127], v[52:55]
    ds_read_b128 v[124:127], v217 offset:768
    s_waitcnt lgkmcnt(9)
    v_mfma_f32_16x16x32_bf16 v[64:67], v[16:19], v[148:151], v[64:67]
    ds_read_b128 v[148:151], v217 offset:3776
    s_waitcnt lgkmcnt(6)
    v_mfma_f32_16x16x32_bf16 v[60:63], v[16:19], v[144:147], v[60:63]
    ds_write_b16_d16_hi v248, v236 offset:0
    ds_write_b16_d16_hi v248, v236 offset:322
    ds_write_b16_d16_hi v248, v236 offset:644
    ds_write_b16_d16_hi v248, v236 offset:966
    s_mov_b32 exec_lo, 0xfffffffe
    ds_write_b16 v248, v236 offset:64
    ds_write_b16 v248, v236 offset:386
    ds_write_b16 v248, v236 offset:708
    ds_write_b16 v248, v236 offset:1030
    s_mov_b64 exec, 1
    v_mov_b32 v3, s63
    ds_write_b16_d16_hi v3, v237 offset:6144
    ds_write_b16_d16_hi v3, v237 offset:6466
    ds_write_b16_d16_hi v3, v237 offset:6788
    ds_write_b16_d16_hi v3, v237 offset:7110
    s_mov_b64 exec, -1
    s_waitcnt lgkmcnt(15)
    v_mfma_f32_16x16x32_bf16 v[56:59], v[16:19], v[140:143], v[56:59]
    v_mfma_f32_16x16x32_bf16 v[52:55], v[16:19], v[136:139], v[52:55]
    v_mfma_f32_16x16x32_bf16 v[64:67], v[80:83], v[144:147], v[64:67]
    ds_read_b128 v[144:147], v217 offset:3264
    v_mfma_f32_16x16x32_bf16 v[60:63], v[80:83], v[140:143], v[60:63]
    v_mfma_f32_16x16x32_bf16 v[56:59], v[80:83], v[136:139], v[56:59]
    v_mfma_f32_16x16x32_bf16 v[52:55], v[80:83], v[132:135], v[52:55]
    v_mfma_f32_16x16x32_bf16 v[64:67], v[116:119], v[140:143], v[64:67]
    ds_read_b128 v[140:143], v217 offset:2752
    buffer_store_dwordx2 v[46:47], v222, s[24:27], s67 offen offset:2560
    v_mfma_f32_16x16x32_bf16 v[60:63], v[116:119], v[136:139], v[60:63]
    v_mfma_f32_16x16x32_bf16 v[56:59], v[116:119], v[132:135], v[56:59]
    s_waitcnt lgkmcnt(15)
    v_mfma_f32_16x16x32_bf16 v[52:55], v[116:119], v[128:131], v[52:55]
    v_mfma_f32_16x16x32_bf16 v[64:67], v[180:183], v[136:139], v[64:67]
    ds_read_b128 v[136:139], v217 offset:2240
    v_mfma_f32_16x16x32_bf16 v[60:63], v[180:183], v[132:135], v[60:63]
    ds_read_b128 v[132:135], v217 offset:1728
    v_mfma_f32_16x16x32_bf16 v[56:59], v[180:183], v[128:131], v[56:59]
    ds_read_b128 v[128:131], v217 offset:1216
    v_mfma_f32_16x16x32_bf16 v[52:55], v[180:183], v[124:127], v[52:55]
    ds_read_b128 v[124:127], v217 offset:704
    s_waitcnt lgkmcnt(15)
    v_mfma_f32_16x16x32_bf16 v[64:67], v[20:23], v[148:151], v[64:67]
    ds_read_b128 v[148:151], v217 offset:3712
    s_waitcnt lgkmcnt(6)
    v_mfma_f32_16x16x32_bf16 v[60:63], v[20:23], v[144:147], v[60:63]
    ds_read_b64_tr_b16 v[4:5], v249 offset:2048
    ds_read_b64_tr_b16 v[6:7], v249 offset:2560
    ds_read_b64_tr_b16 v[68:69], v249 offset:3072
    ds_read_b64_tr_b16 v[70:71], v249 offset:3584
    ds_read_b64 v[104:105], v250 offset:96
    ds_read_b64 v[106:107], v250 offset:128
    ds_read_b64 v[168:169], v250 offset:64
    ds_read_b64 v[170:171], v250 offset:96
    ds_read_b64 v[8:9], v250 offset:32
    ds_read_b64 v[10:11], v250 offset:64
    ds_read_b64 v[72:73], v250 offset:0
    ds_read_b64 v[74:75], v250 offset:32
    s_waitcnt lgkmcnt(15)
    v_mfma_f32_16x16x32_bf16 v[56:59], v[20:23], v[140:143], v[56:59]
    v_mfma_f32_16x16x32_bf16 v[52:55], v[20:23], v[136:139], v[52:55]
    v_mfma_f32_16x16x32_bf16 v[64:67], v[84:87], v[144:147], v[64:67]
    ds_read_b128 v[144:147], v217 offset:3200
    v_mfma_f32_16x16x32_bf16 v[60:63], v[84:87], v[140:143], v[60:63]
    v_mfma_f32_16x16x32_bf16 v[56:59], v[84:87], v[136:139], v[56:59]
    v_mfma_f32_16x16x32_bf16 v[52:55], v[84:87], v[132:135], v[52:55]
    v_mfma_f32_16x16x32_bf16 v[64:67], v[152:155], v[140:143], v[64:67]
    ds_read_b128 v[140:143], v217 offset:2688
    v_mfma_f32_16x16x32_bf16 v[60:63], v[152:155], v[136:139], v[60:63]
    v_mfma_f32_16x16x32_bf16 v[56:59], v[152:155], v[132:135], v[56:59]
    s_waitcnt lgkmcnt(15)
    v_mfma_f32_16x16x32_bf16 v[52:55], v[152:155], v[128:131], v[52:55]
    v_mfma_f32_16x16x32_bf16 v[64:67], v[184:187], v[136:139], v[64:67]
    ds_read_b128 v[136:139], v217 offset:2176
    v_mfma_f32_16x16x32_bf16 v[60:63], v[184:187], v[132:135], v[60:63]
    ds_read_b128 v[132:135], v217 offset:1664
    v_mfma_f32_16x16x32_bf16 v[56:59], v[184:187], v[128:131], v[56:59]
    ds_read_b128 v[128:131], v217 offset:1152
    v_mfma_f32_16x16x32_bf16 v[52:55], v[184:187], v[124:127], v[52:55]
    ds_read_b128 v[124:127], v217 offset:640
    s_waitcnt lgkmcnt(15)
    v_mfma_f32_16x16x32_bf16 v[64:67], v[24:27], v[148:151], v[64:67]
    ds_read_b128 v[148:151], v217 offset:3648
    s_waitcnt lgkmcnt(6)
    v_mfma_f32_16x16x32_bf16 v[60:63], v[24:27], v[144:147], v[60:63]
    v_mfma_f32_16x16x32_bf16 v[52:55], v[4:7], v[104:107], v[52:55]
    v_mfma_f32_16x16x32_bf16 v[56:59], v[4:7], v[168:171], v[56:59]
    v_mfma_f32_16x16x32_bf16 v[60:63], v[4:7], v[8:11], v[60:63]
    v_mfma_f32_16x16x32_bf16 v[64:67], v[4:7], v[72:75], v[64:67]
    v_mfma_f32_16x16x32_bf16 v[60:63], v[68:71], v[104:107], v[60:63]
    v_mfma_f32_16x16x32_bf16 v[64:67], v[68:71], v[168:171], v[64:67]
    ds_read_b64_tr_b16 v[108:109], v249 offset:4096
    ds_read_b64_tr_b16 v[110:111], v249 offset:4608
    ds_read_b64_tr_b16 v[172:173], v249 offset:5120
    ds_read_b64_tr_b16 v[174:175], v249 offset:5632
    ds_read_b64 v[12:13], v250 offset:1376
    ds_read_b64 v[14:15], v250 offset:1408
    ds_read_b64 v[76:77], v250 offset:1344
    ds_read_b64 v[78:79], v250 offset:1376
    ds_read_b64 v[112:113], v250 offset:1312
    ds_read_b64 v[114:115], v250 offset:1344
    ds_read_b64 v[176:177], v250 offset:1280
    ds_read_b64 v[178:179], v250 offset:1312
    s_waitcnt lgkmcnt(15)
    v_mfma_f32_16x16x32_bf16 v[56:59], v[24:27], v[140:143], v[56:59]
    v_mfma_f32_16x16x32_bf16 v[52:55], v[24:27], v[136:139], v[52:55]
    v_mfma_f32_16x16x32_bf16 v[64:67], v[88:91], v[144:147], v[64:67]
    ds_read_b128 v[144:147], v217 offset:3136
    v_mfma_f32_16x16x32_bf16 v[60:63], v[88:91], v[140:143], v[60:63]
    v_mfma_f32_16x16x32_bf16 v[56:59], v[88:91], v[136:139], v[56:59]
    v_mfma_f32_16x16x32_bf16 v[52:55], v[88:91], v[132:135], v[52:55]
    v_mfma_f32_16x16x32_bf16 v[64:67], v[156:159], v[140:143], v[64:67]
    ds_read_b128 v[140:143], v217 offset:2624
    s_add_u32 s67, s67, 5120
    buffer_store_dwordx2 v[48:49], v222, s[24:27], s67 offen offset:0
    v_mfma_f32_16x16x32_bf16 v[60:63], v[156:159], v[136:139], v[60:63]
    v_mfma_f32_16x16x32_bf16 v[56:59], v[156:159], v[132:135], v[56:59]
    s_waitcnt lgkmcnt(15)
    v_mfma_f32_16x16x32_bf16 v[52:55], v[156:159], v[128:131], v[52:55]
    v_mfma_f32_16x16x32_bf16 v[64:67], v[188:191], v[136:139], v[64:67]
    ds_read_b128 v[136:139], v217 offset:2112
    v_mfma_f32_16x16x32_bf16 v[60:63], v[188:191], v[132:135], v[60:63]
    ds_read_b128 v[132:135], v217 offset:1600
    v_mfma_f32_16x16x32_bf16 v[56:59], v[188:191], v[128:131], v[56:59]
    ds_read_b128 v[128:131], v217 offset:1088
    v_mfma_f32_16x16x32_bf16 v[52:55], v[188:191], v[124:127], v[52:55]
    ds_read_b128 v[124:127], v217 offset:576
    s_waitcnt lgkmcnt(15)
    v_mfma_f32_16x16x32_bf16 v[64:67], v[28:31], v[148:151], v[64:67]
    ds_read_b128 v[148:151], v217 offset:3584
    s_waitcnt lgkmcnt(6)
    v_mfma_f32_16x16x32_bf16 v[60:63], v[28:31], v[144:147], v[60:63]
    v_mfma_f32_16x16x32_bf16 v[52:55], v[108:111], v[12:15], v[52:55]
    v_mfma_f32_16x16x32_bf16 v[56:59], v[108:111], v[76:79], v[56:59]
    v_mfma_f32_16x16x32_bf16 v[60:63], v[108:111], v[112:115], v[60:63]
    v_mfma_f32_16x16x32_bf16 v[64:67], v[108:111], v[176:179], v[64:67]
    v_mfma_f32_16x16x32_bf16 v[60:63], v[172:175], v[12:15], v[60:63]
    v_mfma_f32_16x16x32_bf16 v[64:67], v[172:175], v[76:79], v[64:67]
    s_waitcnt lgkmcnt(5)
    v_mfma_f32_16x16x32_bf16 v[56:59], v[28:31], v[140:143], v[56:59]
    s_waitcnt lgkmcnt(4)
    v_mfma_f32_16x16x32_bf16 v[52:55], v[28:31], v[136:139], v[52:55]
    v_mfma_f32_16x16x32_bf16 v[64:67], v[92:95], v[144:147], v[64:67]
    ds_read_b128 v[144:147], v217 offset:3072
    v_mfma_f32_16x16x32_bf16 v[60:63], v[92:95], v[140:143], v[60:63]
    v_mfma_f32_16x16x32_bf16 v[56:59], v[92:95], v[136:139], v[56:59]
    s_waitcnt lgkmcnt(4)
    v_mfma_f32_16x16x32_bf16 v[52:55], v[92:95], v[132:135], v[52:55]
    v_mfma_f32_16x16x32_bf16 v[64:67], v[160:163], v[140:143], v[64:67]
    ds_read_b128 v[140:143], v217 offset:2560
    buffer_store_dwordx2 v[50:51], v222, s[24:27], s67 offen offset:2560
    v_mfma_f32_16x16x32_bf16 v[60:63], v[160:163], v[136:139], v[60:63]
    v_mfma_f32_16x16x32_bf16 v[56:59], v[160:163], v[132:135], v[56:59]
    s_waitcnt lgkmcnt(4)
    v_mfma_f32_16x16x32_bf16 v[52:55], v[160:163], v[128:131], v[52:55]
    v_mfma_f32_16x16x32_bf16 v[64:67], v[192:195], v[136:139], v[64:67]
    ds_read_b128 v[136:139], v217 offset:2048
    v_mfma_f32_16x16x32_bf16 v[60:63], v[192:195], v[132:135], v[60:63]
    ds_read_b128 v[132:135], v217 offset:1536
    v_mfma_f32_16x16x32_bf16 v[56:59], v[192:195], v[128:131], v[56:59]
    ds_read_b128 v[128:131], v217 offset:1024
    s_waitcnt lgkmcnt(6)
    v_mfma_f32_16x16x32_bf16 v[52:55], v[192:195], v[124:127], v[52:55]
    ds_read_b128 v[124:127], v217 offset:512
    s_waitcnt lgkmcnt(6)
    v_mfma_f32_16x16x32_bf16 v[64:67], v[32:35], v[148:151], v[64:67]
    s_waitcnt lgkmcnt(5)
    v_mfma_f32_16x16x32_bf16 v[60:63], v[32:35], v[144:147], v[60:63]
    s_waitcnt lgkmcnt(4)
    v_mfma_f32_16x16x32_bf16 v[56:59], v[32:35], v[140:143], v[56:59]
    s_waitcnt lgkmcnt(3)
    v_mfma_f32_16x16x32_bf16 v[52:55], v[32:35], v[136:139], v[52:55]
    v_mfma_f32_16x16x32_bf16 v[64:67], v[96:99], v[144:147], v[64:67]
    v_mfma_f32_16x16x32_bf16 v[60:63], v[96:99], v[140:143], v[60:63]
    v_mfma_f32_16x16x32_bf16 v[56:59], v[96:99], v[136:139], v[56:59]
    s_waitcnt lgkmcnt(2)
    v_mfma_f32_16x16x32_bf16 v[52:55], v[96:99], v[132:135], v[52:55]
    v_mfma_f32_16x16x32_bf16 v[64:67], v[164:167], v[140:143], v[64:67]
    v_mfma_f32_16x16x32_bf16 v[60:63], v[164:167], v[136:139], v[60:63]
    v_mfma_f32_16x16x32_bf16 v[56:59], v[164:167], v[132:135], v[56:59]
    s_waitcnt lgkmcnt(1)
    v_mfma_f32_16x16x32_bf16 v[52:55], v[164:167], v[128:131], v[52:55]
    v_mfma_f32_16x16x32_bf16 v[64:67], v[196:199], v[136:139], v[64:67]
    v_mfma_f32_16x16x32_bf16 v[60:63], v[196:199], v[132:135], v[60:63]
    v_mfma_f32_16x16x32_bf16 v[56:59], v[196:199], v[128:131], v[56:59]
    s_waitcnt lgkmcnt(0)
    v_mfma_f32_16x16x32_bf16 v[52:55], v[196:199], v[124:127], v[52:55]
    v_add_u32 v3, s64, v218
    s_nop 6
    v_cvt_pk_bf16_f32 v52, v52, v53
    v_cvt_pk_bf16_f32 v53, v54, v55
    ds_write_b64 v3, v[52:53] offset:2528
    v_cvt_pk_bf16_f32 v56, v56, v57
    v_cvt_pk_bf16_f32 v57, v58, v59
    ds_write_b64 v3, v[56:57] offset:3040
    v_cvt_pk_bf16_f32 v60, v60, v61
    v_cvt_pk_bf16_f32 v61, v62, v63
    ds_write_b64 v3, v[60:61] offset:3552
    v_cvt_pk_bf16_f32 v64, v64, v65
    v_cvt_pk_bf16_f32 v65, v66, v67
    ds_write_b64 v3, v[64:65] offset:4064
    v_mov_b32 v1, 60416
    v_mov_b32 v2, 1
    s_mov_b64 exec, 1
    ds_add_u32 v1, v2 offset:4
    s_mov_b64 exec, -1
    s_add_u32 s67, s67, 2616320
    v_mov_b32 v1, 60416
    s_mov_b32 s69, 200000
L_lw_28:
    ds_read_b32 v2, v1 offset:4
    s_sub_u32 s69, s69, 1
    s_waitcnt lgkmcnt(0)
    v_readfirstlane_b32 s65, v2
    s_cmp_ge_u32 s65, 4
    s_cbranch_scc1 L_lg_29
    s_sleep 1
    s_cmp_lg_u32 s69, 0
    s_cbranch_scc1 L_lw_28
L_lg_29:
    ds_read_b64 v[36:37], v223 offset:2528
    ds_read_b64 v[38:39], v223 offset:7136
    ds_read_b64 v[40:41], v223 offset:11744
    ds_read_b64 v[42:43], v223 offset:16352
    s_waitcnt lgkmcnt(0)
    v_perm_b32 v44, v38, v36, s70
    v_perm_b32 v45, v42, v40, s70
    v_perm_b32 v46, v38, v36, s71
    v_perm_b32 v47, v42, v40, s71
    v_perm_b32 v48, v39, v37, s70
    v_perm_b32 v49, v43, v41, s70
    v_perm_b32 v50, v39, v37, s71
    v_perm_b32 v51, v43, v41, s71
    buffer_store_dwordx2 v[44:45], v222, s[24:27], s67 offen offset:0
    buffer_store_dwordx2 v[46:47], v222, s[24:27], s67 offen offset:2560
    s_add_u32 s67, s67, 5120
    buffer_store_dwordx2 v[48:49], v222, s[24:27], s67 offen offset:0
    buffer_store_dwordx2 v[50:51], v222, s[24:27], s67 offen offset:2560
    s_endpgm
L_end:
    s_endpgm
L_codeend:
.section .rodata,"a"
.p2align 6
.amdhsa_kernel concat_heads__grouped_kv_mqa__ssm_conv_s4d__prompt_kernel
  .amdhsa_next_free_vgpr 256
  .amdhsa_next_free_sgpr 102
  .amdhsa_accum_offset 256
  .amdhsa_group_segment_fixed_size 0
  .amdhsa_kernarg_size 120
  .amdhsa_user_sgpr_count 2
  .amdhsa_user_sgpr_kernarg_segment_ptr 1
  .amdhsa_system_sgpr_workgroup_id_x 1
  .amdhsa_float_denorm_mode_32 3
.end_amdhsa_kernel
```
